```python
import torch

def _softmax(x, axis=-1):
    return torch.softmax(x, dim=axis)
def _gelu(x):
    return torch.nn.functional.gelu(x, approximate="tanh")
def _silu(x):
    return torch.nn.functional.silu(x)
def _sigmoid(x):
    return torch.sigmoid(x)
def _layernorm(x, axis=-1, eps=1e-5):
    m = x.mean(dim=axis, keepdim=True)
    v = x.var(dim=axis, keepdim=True, unbiased=False)
    return (x - m) / torch.sqrt(v + eps)
def _scatter_add(tgt, idx, src, axis=0):
    return tgt.clone().index_add_(axis, idx, src)
def _segment_sum(src, seg, n):
    out = torch.zeros((n,) + src.shape[1:], dtype=src.dtype)
    return out.index_add_(0, seg, src)
def _pad(x, pw):
    flat = tuple(v for pair in reversed(pw) for v in pair)
    return torch.nn.functional.pad(x, flat)

kernel_name = 'parallel_sum__grouped_kv_mqa__glu_gated_swiglu__prompt'

def setup_inputs():

    _w = (lambda a: (lambda t: t.to(torch.bfloat16) if t.is_floating_point() else t)(torch.as_tensor(a)))
    def _A_setup():
        B, S, D, H = 1, 2048, 448, 16
        Dh = D // H
        return {
            "x": _w((lambda *s: torch.randn(*s, dtype=torch.bfloat16) * 0.05)(B, S, D)),
            "wq": _w((lambda *s: torch.randn(*s, dtype=torch.bfloat16) * 0.05)(D, H * Dh)),
            "wk": _w((lambda *s: torch.randn(*s, dtype=torch.bfloat16) * 0.05)(D, Dh)),
            "wv": _w((lambda *s: torch.randn(*s, dtype=torch.bfloat16) * 0.05)(D, Dh)),
            "wo": _w((lambda *s: torch.randn(*s, dtype=torch.bfloat16) * 0.05)(H * Dh, D)),
        }
    _A_in = _A_setup()

    def _B_setup():
        B, S, D, F = 1, 2048, 448, 1792
        return {
            "x": _w((lambda *s: torch.randn(*s, dtype=torch.bfloat16) * 0.05)(B, S, D)),
            "w1": _w((lambda *s: torch.randn(*s, dtype=torch.bfloat16) * 0.4)(D, F) * (2.0 / D) ** 0.5),
            "w3": _w((lambda *s: torch.randn(*s, dtype=torch.bfloat16) * 0.4)(D, F) * (2.0 / D) ** 0.5),
            "w2": _w((lambda *s: torch.randn(*s, dtype=torch.bfloat16) * 0.4)(F, D) * (2.0 / F) ** 0.5),
        }
    _B_in = _B_setup()

    return {
        "A_x": _A_in["x"],
        "A_wq": _A_in["wq"],
        "A_wk": _A_in["wk"],
        "A_wv": _A_in["wv"],
        "A_wo": _A_in["wo"],
        "B_x": _B_in["x"],
        "B_w1": _B_in["w1"],
        "B_w3": _B_in["w3"],
        "B_w2": _B_in["w2"],
    }

def reference(A_x, A_wq, A_wk, A_wv, A_wo, B_x, B_w1, B_w3, B_w2):
    def _A_ref(x, wq, wk, wv, wo):
        B, S, D = x.shape
        H = 16
        Dh = D // H
        q = (lambda x, *d: x.permute(*d))((x @ wq).reshape(B, S, H, Dh), 0, 2, 1, 3)
        k = x @ wk
        v = x @ wv
        scores = torch.einsum("bhqd,bkd->bhqk", q, k) * (Dh ** -0.5)
        p = _softmax(scores, axis=-1)
        o = torch.einsum("bhqk,bkd->bhqd", p, v)
        return (lambda x, *d: x.permute(*d))(o, 0, 2, 1, 3).reshape(B, S, H * Dh) @ wo

    def _B_ref(x, w1, w3, w2):
        gate = torch.einsum("bsd,df->bsf", x, w1)
        up = torch.einsum("bsd,df->bsf", x, w3)
        h = _silu(gate) * up
        out = torch.einsum("bsf,fd->bsd", h, w2)
        return out

    x = A_x
    xn = _layernorm(x, axis=-1)
    return x + _A_ref(xn, A_wq, A_wk, A_wv, A_wo) + _B_ref(xn, B_w1, B_w3, B_w2)
```

```asm
; @launch grid=(256,1,1) block=(256,1,1) lds=163840
.amdgcn_target "amdgcn-amd-amdhsa--gfx950"
.text
.globl parallel_sum__grouped_kv_mqa__glu_gated_swiglu__prompt_kernel
.p2align 8
.type parallel_sum__grouped_kv_mqa__glu_gated_swiglu__prompt_kernel,@function
parallel_sum__grouped_kv_mqa__glu_gated_swiglu__prompt_kernel:
    s_load_dwordx2 s[4:5], s[0:1], 0
    s_cmp_ge_u32 s2, 256
    s_cbranch_scc1 L_end
    v_lshrrev_b32 v140, 6, v0
    v_and_b32 v1, 63, v0
    v_readfirstlane_b32 s46, v140
    s_lshr_b32 s64, s2, 3
    s_and_b32 s61, s2, 7
    s_and_b32 s45, s64, 1
    s_lshl1_add_u32 s44, s61, s45
    s_getpc_b64 s[62:63]
L_pc:
    s_lshl2_add_u32 s61, s45, s46
    s_lshl_b32 s61, s61, 13
    v_lshl_add_u32 v140, v1, 7, s61
    v_min_u32 v140, L_codeend-L_pc-4, v140
    global_load_dword v133, v140, s[62:63]
    s_lshr_b32 s45, s64, 1
    s_sub_u32 s61, s45, 13
    s_max_i32 s61, s61, 0
    s_lshl3_add_u32 s61, s61, 8
    s_load_dwordx2 s[8:9], s[0:1], s61
    s_load_dwordx4 s[12:15], s[0:1], 48
    s_load_dwordx4 s[20:23], s[0:1], 64
    s_load_dwordx4 s[36:39], s[0:1], 80
    s_load_dwordx2 s[24:25], s[0:1], 32
    s_lshl4_add_u32 s69, s44, s45
    s_lshl2_add_u32 s69, s69, s46
    s_mul_i32 s65, s69, 14
    v_min_u32 v132, 13, v1
    v_add_lshl_u32 v132, v132, s65, 7
    s_mov_b32 s6, 1835008
    s_mov_b32 s7, 0x20000
    s_waitcnt lgkmcnt(0)
    buffer_load_dword v132, v132, s[4:7], 0 offen
    s_load_dword s83, s[8:9], 0
    s_load_dword s83, s[12:13], 0
    s_load_dword s83, s[14:15], 0
    s_load_dword s83, s[38:39], 0
    v_lshrrev_b32 v140, 3, v1
    v_lshrrev_b32 v142, 4, v1
    v_and_b32 v143, 7, v1
    v_xor_b32 v4, v143, v142
    v_lshlrev_b32 v4, 4, v4
    v_xor_b32 v5, 64, v4
    v_mul_u32_u24 v140, 896, v140
    v_add_u32 v4, v4, v140
    v_add_u32 v5, v5, v140
    s_lshl2_add_u32 s47, s44, s46
    s_mul_i32 s48, s47, 28672
    s_add_u32 s49, s48, 6144
    s_add_u32 s50, s48, 12288
    s_add_u32 s51, s48, 18432
    s_lshl_b32 s56, s46, 12
    s_mov_b32 m0, s56
    s_nop 0
    buffer_load_dwordx4 v4, s[4:7], s48 offen offset:0 lds
    buffer_load_dwordx4 v5, s[4:7], s49 offen offset:1024 lds
    buffer_load_dwordx4 v4, s[4:7], s50 offen offset:2048 lds
    buffer_load_dwordx4 v5, s[4:7], s51 offen offset:3072 lds
    s_mul_i32 s67, s44, 14
    s_add_u32 s67, s67, s45
    s_lshl2_add_u32 s67, s67, s46
    s_mov_b32 s10, 25088
    s_mov_b32 s11, 0x20000
    s_cmp_lt_u32 s45, 14
    s_cselect_b32 s10, 401408, s10
    s_cselect_b32 s63, s67, s47
    s_cselect_b32 s61, 896, 56
    s_cselect_b32 s64, s45, 0
    s_mul_i32 s65, s63, 4
    v_min_u32 v137, 3, v1
    v_add_lshl_u32 v137, v137, s65, 7
    buffer_load_dword v137, v137, s[8:11], 0 offen
    s_add_u32 m0, s56, 16256
    s_nop 0
    buffer_load_dwordx4 v4, s[4:7], s48 offen offset:128 lds
    buffer_load_dwordx4 v5, s[4:7], s49 offen offset:1152 lds
    buffer_load_dwordx4 v4, s[4:7], s50 offen offset:2176 lds
    buffer_load_dwordx4 v5, s[4:7], s51 offen offset:3200 lds
    v_lshrrev_b32 v240, 2, v1
    v_mul_u32_u24 v240, s61, v240
    v_and_b32 v241, 3, v1
    v_lshl_add_u32 v240, v241, 4, v240
    s_lshl_b32 s0, s61, 6
    s_mul_i32 s52, s61, s46
    s_lshl_b32 s64, s64, 6
    s_lshl4_add_u32 s52, s52, s64
    s_lshl_b32 s57, s46, 10
    s_add_u32 s57, s57, 114688
    s_add_u32 m0, s57, 0
    s_nop 0
    buffer_load_dwordx4 v240, s[8:11], s52 offen lds
    s_add_u32 m0, s57, 4096
    s_add_u32 s52, s52, s0
    buffer_load_dwordx4 v240, s[8:11], s52 offen lds
    s_mov_b64 s[32:33], s[22:23]
    s_mov_b64 s[28:29], s[38:39]
    s_load_dword s60, s[28:29], 0
    s_mov_b64 s[16:17], s[14:15]
    s_mov_b32 s14, 1605632
    s_mov_b32 s15, 0x20000
    s_mov_b32 s18, 1606688
    s_mov_b32 s19, 0x20000
    s_sub_u32 s16, s16, 1056
    s_subb_u32 s17, s17, 0
    s_cmp_lt_u32 s45, 14
    s_cselect_b32 s1, 0x3e8b97f6, 1.0
    s_cselect_b32 s22, 1605632, 0
    s_cselect_b32 s26, 401408, 0
    s_cselect_b32 s34, 1835008, 0
    s_cselect_b32 s42, 16777216, 0
    s_mov_b32 s30, 16777216
    s_mov_b32 s38, 256
    s_mov_b32 s23, 0x20000
    s_mov_b32 s27, 0x20000
    s_mov_b32 s31, 0x20000
    s_mov_b32 s35, 0x20000
    s_mov_b32 s39, 0x20000
    s_mov_b32 s43, 0x20000
    s_mov_b64 s[40:41], s[28:29]
    s_mov_b32 s66, 0x3f803f80
    v_mov_b32 v12, 0
    v_mov_b32 v13, 0
    v_and_b32 v140, 31, v1
    v_lshrrev_b32 v142, 5, v1
    v_bfe_u32 v143, v1, 1, 3
    v_xor_b32 v143, v143, v142
    v_lshlrev_b32 v143, 4, v143
    v_lshl_add_u32 v144, v140, 7, s56
    v_xor_b32 v128, 0, v143
    v_add_u32 v128, v128, v144
    v_xor_b32 v129, 32, v143
    v_add_u32 v129, v129, v144
    v_xor_b32 v130, 64, v143
    v_add_u32 v130, v130, v144
    v_xor_b32 v131, 96, v143
    v_add_u32 v131, v131, v144
    v_mov_b32 v197, 0
    v_mov_b32 v198, 0
    v_mov_b32 v199, 0
    v_mov_b32 v201, 0
    v_mov_b32 v202, 0
    v_mov_b32 v203, 0
    v_lshrrev_b32 v140, 2, v1
    v_lshrrev_b32 v142, 4, v1
    v_xor_b32 v140, v140, v142
    v_and_b32 v140, 1, v140
    v_add_u32 v140, -1, v140
    v_and_b32 v204, 0x3f803f80, v140
    v_mov_b32 v205, v204
    v_mov_b32 v206, v204
    v_mov_b32 v207, v204
    v_lshlrev_b32 v241, 3, v241
    v_bfe_u32 v143, v1, 2, 2
    v_bfe_u32 v144, v1, 4, 1
    v_lshrrev_b32 v142, 5, v1
    v_mul_u32_u24 v7, 2112, v143
    v_mul_u32_u24 v140, 1056, v144
    v_add3_u32 v7, v7, v140, v241
    v_lshl_add_u32 v7, v142, 9, v7
    v_add_u32 v7, 118272, v7
    v_lshl_add_u32 v241, v144, 5, v241
    v_lshl_add_u32 v241, v143, 6, v241
    v_lshl_add_u32 v241, v142, 9, v241
    v_add_u32 v241, 114688, v241
    s_mul_i32 s65, s69, 13
    v_min_u32 v134, 12, v1
    v_add_lshl_u32 v134, v134, s65, 7
    s_add_u32 m0, s56, 32512
    s_nop 0
    buffer_load_dwordx4 v4, s[4:7], s48 offen offset:256 lds
    buffer_load_dwordx4 v5, s[4:7], s49 offen offset:1280 lds
    buffer_load_dwordx4 v4, s[4:7], s50 offen offset:2304 lds
    buffer_load_dwordx4 v5, s[4:7], s51 offen offset:3328 lds
    s_add_u32 m0, s57, 8192
    s_add_u32 s52, s52, s0
    buffer_load_dwordx4 v240, s[8:11], s52 offen lds
    buffer_load_dword v135, v134, s[12:15], 0 offen
    buffer_load_dword v136, v134, s[16:19], 0 offen offset:1056
    v_and_b32 v140, 15, v1
    v_lshrrev_b32 v142, 4, v1
    v_mul_u32_u24 v6, 14336, v142
    v_lshl_add_u32 v6, v140, 4, v6
    v_cmp_gt_u32 vcc, 14, v140
    v_mov_b32 v144, 0x40000000
    s_mul_i32 s54, s46, 3584
    v_cndmask_b32 v6, v144, v6, vcc
    s_mul_i32 s61, s45, 224
    s_add_u32 s54, s54, s61
    s_mul_i32 s58, s46, 2112
    s_mul_i32 s53, s47, 14
    s_add_u32 s53, s53, s45
    s_lshl_b32 s53, s53, 11
    s_add_u32 s53, s53, 0x100000
    s_lshl1_add_u32 s61, s47, s45
    s_lshl_b32 s61, s61, 11
    s_add_u32 s61, s61, 0x2f9000
    s_cmp_lt_u32 s45, 14
    s_cselect_b32 s53, s53, s61
    s_lshl4_add_u32 s71, s47, s45
    s_mul_i32 s71, s71, 7168
    s_add_u32 s71, s71, 0x800000
    v_cmp_eq_u32 vcc, 0, v1
    v_mov_b32 v3, 0x40000000
    v_lshlrev_b32 v2, 4, v1
    v_cndmask_b32 v3, v3, 0, vcc
    s_waitcnt lgkmcnt(0)
    s_add_u32 s60, s60, 1
    s_max_u32 s60, s60, 1
    s_or_b32 s65, s2, s46
    s_cmp_eq_u32 s65, 0
    s_cselect_b32 s65, 0, 0x40000000
    v_mov_b32 v148, s60
    v_or_b32 v149, s65, v3
    buffer_store_dword v148, v149, s[36:39], 0 offen sc1
    buffer_store_dword v148, v149, s[28:31], 0 offen offset:0 sc1
    s_lshl4_add_u32 s68, s47, s45
    s_lshl_b32 s75, s68, 11
    s_add_u32 s75, s75, 0x400000
    s_lshl_b32 s68, s68, 7
    v_lshrrev_b32 v14, 3, v1
    v_mul_u32_u24 v14, 896, v14
    v_and_b32 v140, 7, v1
    v_bfe_u32 v143, v1, 4, 1
    v_lshlrev_b32 v143, 2, v143
    v_xor_b32 v140, v140, v143
    v_lshl_add_u32 v14, v140, 4, v14
    v_add_u32 v15, 6144, v14
    s_cmp_ge_u32 s45, 7
    s_cselect_b32 s72, 1, 0
    s_mul_i32 s73, s72, 7
    s_sub_u32 s73, s45, s73
    s_lshr_b32 s61, s46, 1
    s_lshl1_add_u32 s61, s72, s61
    s_lshl2_add_u32 s61, s73, s61
    s_lshl_b32 s61, s61, 12
    s_and_b32 s62, s46, 1
    s_lshl_b32 s62, s62, 2
    v_lshrrev_b32 v140, 5, v1
    v_bfe_u32 v143, v1, 1, 3
    v_xor_b32 v143, v143, v140
    v_xor_b32 v143, s62, v143
    v_and_b32 v140, 31, v1
    v_lshl_add_u32 v140, v140, 7, s61
    v_lshl_add_u32 v156, v143, 4, v140
    v_xor_b32 v157, 32, v156
    s_mul_i32 s55, s46, 401408
    s_lshl_b32 s61, s73, 7
    s_add_u32 s55, s55, s61
    s_lshl_b32 s59, s46, 11
    v_bfe_u32 v140, v1, 1, 4
    s_lshl_b32 s61, s46, 4
    v_add_lshl_u32 v140, v140, s61, 4
    v_and_b32 v143, 1, v1
    v_add3_u32 v140, v140, v143, 14
    s_mul_i32 s61, s45, 7
    s_lshr_b32 s62, s61, 3
    s_add_u32 s61, s61, 6
    s_lshr_b32 s61, s61, 3
    s_sub_u32 s61, s61, s62
    v_mul_u32_u24 v143, s61, v143
    s_lshl_b32 s61, s44, 6
    s_add_u32 s61, s61, s62
    v_bfe_u32 v144, v1, 1, 2
    v_lshl_add_u32 v143, v144, 4, v143
    v_cmp_gt_u32 vcc, 32, v1
    v_add_u32 v143, s61, v143
    s_lshl_b32 s70, s46, 16
    v_cndmask_b32 v140, v143, v140, vcc
    v_lshlrev_b32 v140, 7, v140
    v_add_u32 v0, 0x10000, v140
    s_add_u32 s70, s70, 0x300000
    s_lshl_b32 s61, s44, 2
    s_xor_b32 s62, s46, 3
    s_add_u32 s62, s62, s61
    s_mul_i32 s62, s62, 28672
    s_add_u32 s76, s62, 0x100000
    s_xor_b32 s62, s46, 2
    s_add_u32 s62, s62, s61
    s_mul_i32 s62, s62, 28672
    s_add_u32 s77, s62, 0x100000
    s_xor_b32 s62, s46, 1
    s_add_u32 s62, s62, s61
    s_mul_i32 s62, s62, 28672
    s_add_u32 s78, s62, 0x100000
    s_xor_b32 s62, s46, 0
    s_add_u32 s62, s62, s61
    s_mul_i32 s62, s62, 28672
    s_add_u32 s79, s62, 0x100000
    s_lshr_b32 s61, s46, 1
    s_mul_i32 s62, s61, 114688
    v_add_u32 v145, s62, v2
    s_xor_b32 s62, s62, 114688
    v_add_u32 v146, s62, v2
    s_lshl_b32 s62, s44, 1
    s_add_u32 s62, s62, s72
    s_lshl_b32 s62, s62, 1
    s_add_u32 s61, s61, s62
    s_mul_i32 s80, s61, 28672
    s_lshl_b32 s82, s61, 1
    s_and_b32 s63, s46, 1
    s_add_u32 s82, s82, s63
    s_lshl_b32 s82, s82, 14
    s_add_u32 s82, s82, 0x400000
    s_mul_i32 s81, s62, 112
    s_mul_i32 s61, s46, 28
    s_add_u32 s81, s81, s61
    s_lshl_b32 s81, s81, 10
    s_add_u32 s81, s81, 0x800000
    s_lshl2_add_u32 s62, s62, s46
    s_lshl_b32 s62, s62, 9
    s_add_u32 s62, s62, 0x30000
    v_bfe_u32 v140, v1, 2, 1
    v_and_b32 v141, 3, v1
    v_lshl_add_u32 v140, v140, 4, v141
    v_lshl_add_u32 v149, v140, 7, s62
    v_bfe_u32 v140, v1, 2, 2
    v_lshrrev_b32 v142, 5, v1
    v_lshl_add_u32 v142, v142, 2, v140
    v_lshlrev_b32 v141, 3, v141
    v_lshl_add_u32 v141, v142, 7, v141
    v_bfe_u32 v142, v1, 4, 1
    v_lshl_add_u32 v141, v142, 5, v141
    v_lshrrev_b32 v140, 1, v140
    v_xor_b32 v140, s63, v140
    v_lshl_add_u32 v141, v140, 6, v141
    s_add_u32 s61, s59, 0x10000
    v_add_u32 v147, s61, v141
    v_xor_b32 v148, 64, v147
    v_add_u32 v150, s61, v2
    s_mul_i32 s74, s46, 14336
    s_lshl_b32 s61, s73, 7
    s_add_u32 s74, s74, s61
    s_add_u32 s80, s80, s61
    s_lshl_b32 s63, s63, 6
    s_add_u32 s80, s80, s63
    v_and_b32 v140, 31, v1
    v_lshrrev_b32 v141, 5, v1
    v_mul_u32_u24 v255, 896, v140
    v_lshl_add_u32 v255, v141, 4, v255
    s_mul_i32 s61, s45, 7
    v_lshl_add_u32 v142, v141, 1, s61
    v_lshlrev_b32 v140, 4, v140
    v_lshrrev_b32 v252, 1, v142
    v_lshl_add_u32 v252, v252, 9, v140
    v_and_b32 v253, 1, v142
    v_lshl_add_u32 v252, v253, 3, v252
    v_mul_u32_u24 v253, 496, v253
    v_add3_u32 v253, v253, v252, 8
    v_lshl_add_u32 v254, v141, 30, v253
    v_accvgpr_write_b32 a80, v145
    v_accvgpr_write_b32 a81, v146
    v_accvgpr_write_b32 a82, v147
    v_accvgpr_write_b32 a83, v148
    v_accvgpr_write_b32 a84, v149
    v_accvgpr_write_b32 a85, v150
    s_waitcnt vmcnt(10)
    s_barrier
    ds_read_b128 v[16:19], v128 offset:0
    ds_read_b128 v[20:23], v129 offset:0
    ds_read_b128 v[24:27], v130 offset:0
    ds_read_b128 v[28:31], v131 offset:0
    ds_read_b64_tr_b16 v[160:161], v241 offset:0
    ds_read_b64_tr_b16 v[162:163], v241 offset:256
    ds_read_b64_tr_b16 v[164:165], v241 offset:1024
    ds_read_b64_tr_b16 v[166:167], v241 offset:1280
    ds_read_b64_tr_b16 v[168:169], v241 offset:2048
    ds_read_b64_tr_b16 v[170:171], v241 offset:2304
    ds_read_b64_tr_b16 v[172:173], v241 offset:3072
    ds_read_b64_tr_b16 v[174:175], v241 offset:3328
    s_waitcnt lgkmcnt(8)
    v_dot2c_f32_bf16 v12, s66, v16
    v_dot2c_f32_bf16 v13, v16, v16
    v_dot2c_f32_bf16 v12, s66, v17
    v_dot2c_f32_bf16 v13, v17, v17
    v_dot2c_f32_bf16 v12, s66, v18
    v_dot2c_f32_bf16 v13, v18, v18
    v_dot2c_f32_bf16 v12, s66, v19
    v_dot2c_f32_bf16 v13, v19, v19
    v_dot2c_f32_bf16 v12, s66, v20
    v_dot2c_f32_bf16 v13, v20, v20
    v_dot2c_f32_bf16 v12, s66, v21
    v_dot2c_f32_bf16 v13, v21, v21
    v_dot2c_f32_bf16 v12, s66, v22
    v_dot2c_f32_bf16 v13, v22, v22
    v_dot2c_f32_bf16 v12, s66, v23
    v_dot2c_f32_bf16 v13, v23, v23
    v_dot2c_f32_bf16 v12, s66, v24
    v_dot2c_f32_bf16 v13, v24, v24
    v_dot2c_f32_bf16 v12, s66, v25
    v_dot2c_f32_bf16 v13, v25, v25
    v_dot2c_f32_bf16 v12, s66, v26
    v_dot2c_f32_bf16 v13, v26, v26
    v_dot2c_f32_bf16 v12, s66, v27
    v_dot2c_f32_bf16 v13, v27, v27
    v_dot2c_f32_bf16 v12, s66, v28
    v_dot2c_f32_bf16 v13, v28, v28
    v_dot2c_f32_bf16 v12, s66, v29
    v_dot2c_f32_bf16 v13, v29, v29
    v_dot2c_f32_bf16 v12, s66, v30
    v_dot2c_f32_bf16 v13, v30, v30
    v_dot2c_f32_bf16 v12, s66, v31
    v_dot2c_f32_bf16 v13, v31, v31
    s_waitcnt lgkmcnt(0)
    v_mfma_f32_16x16x32_bf16 v[192:195], v[204:207], v[160:163], 0
    s_waitcnt vmcnt(9)
    s_barrier
    v_mfma_f32_32x32x16_bf16 a[64:79], v[160:163], v[16:19], 0
    ds_read_b128 v[32:35], v128 offset:16384
    ds_read_b128 v[36:39], v129 offset:16384
    ds_read_b128 v[40:43], v130 offset:16384
    ds_read_b128 v[44:47], v131 offset:16384
    v_mfma_f32_16x16x32_bf16 v[192:195], v[204:207], v[164:167], v[192:195]
    s_add_u32 m0, s56, 48768
    s_nop 0
    buffer_load_dwordx4 v4, s[4:7], s48 offen offset:384 lds
    buffer_load_dwordx4 v5, s[4:7], s49 offen offset:1408 lds
    v_mfma_f32_32x32x16_bf16 a[64:79], v[164:167], v[20:23], a[64:79]
    ds_read_b64_tr_b16 v[176:177], v241 offset:4096
    ds_read_b64_tr_b16 v[178:179], v241 offset:4352
    ds_read_b64_tr_b16 v[180:181], v241 offset:5120
    ds_read_b64_tr_b16 v[182:183], v241 offset:5376
    v_mfma_f32_16x16x32_bf16 v[192:195], v[204:207], v[168:171], v[192:195]
    buffer_load_dwordx4 v4, s[4:7], s50 offen offset:2432 lds
    v_mfma_f32_32x32x16_bf16 a[64:79], v[168:171], v[24:27], a[64:79]
    ds_read_b64_tr_b16 v[184:185], v241 offset:6144
    ds_read_b64_tr_b16 v[186:187], v241 offset:6400
    ds_read_b64_tr_b16 v[188:189], v241 offset:7168
    ds_read_b64_tr_b16 v[190:191], v241 offset:7424
    buffer_load_dwordx4 v5, s[4:7], s51 offen offset:3456 lds
    v_mfma_f32_16x16x32_bf16 v[192:195], v[204:207], v[172:175], v[192:195]
    v_mfma_f32_32x32x16_bf16 a[64:79], v[172:175], v[28:31], a[64:79]
    s_add_u32 m0, s57, 12288
    s_add_u32 s52, s52, s0
    buffer_load_dwordx4 v240, s[8:11], s52 offen lds
    s_waitcnt lgkmcnt(8)
    v_dot2c_f32_bf16 v12, s66, v32
    v_dot2c_f32_bf16 v13, v32, v32
    v_dot2c_f32_bf16 v12, s66, v33
    v_dot2c_f32_bf16 v13, v33, v33
    v_dot2c_f32_bf16 v12, s66, v34
    v_dot2c_f32_bf16 v13, v34, v34
    v_dot2c_f32_bf16 v12, s66, v35
    v_dot2c_f32_bf16 v13, v35, v35
    v_dot2c_f32_bf16 v12, s66, v36
    v_dot2c_f32_bf16 v13, v36, v36
    v_dot2c_f32_bf16 v12, s66, v37
    v_dot2c_f32_bf16 v13, v37, v37
    v_dot2c_f32_bf16 v12, s66, v38
    v_dot2c_f32_bf16 v13, v38, v38
    v_dot2c_f32_bf16 v12, s66, v39
    v_dot2c_f32_bf16 v13, v39, v39
    v_dot2c_f32_bf16 v12, s66, v40
    v_dot2c_f32_bf16 v13, v40, v40
    v_dot2c_f32_bf16 v12, s66, v41
    v_dot2c_f32_bf16 v13, v41, v41
    v_dot2c_f32_bf16 v12, s66, v42
    v_dot2c_f32_bf16 v13, v42, v42
    v_dot2c_f32_bf16 v12, s66, v43
    v_dot2c_f32_bf16 v13, v43, v43
    v_dot2c_f32_bf16 v12, s66, v44
    v_dot2c_f32_bf16 v13, v44, v44
    v_dot2c_f32_bf16 v12, s66, v45
    v_dot2c_f32_bf16 v13, v45, v45
    v_dot2c_f32_bf16 v12, s66, v46
    v_dot2c_f32_bf16 v13, v46, v46
    v_dot2c_f32_bf16 v12, s66, v47
    v_dot2c_f32_bf16 v13, v47, v47
    s_waitcnt lgkmcnt(0)
    v_mfma_f32_16x16x32_bf16 v[192:195], v[204:207], v[176:179], v[192:195]
    s_waitcnt vmcnt(9)
    s_barrier
    v_mfma_f32_32x32x16_bf16 a[64:79], v[176:179], v[32:35], a[64:79]
    ds_read_b128 v[48:51], v128 offset:32768
    ds_read_b128 v[52:55], v129 offset:32768
    ds_read_b128 v[56:59], v130 offset:32768
    ds_read_b128 v[60:63], v131 offset:32768
    v_mfma_f32_16x16x32_bf16 v[192:195], v[204:207], v[180:183], v[192:195]
    s_add_u32 m0, s56, 65024
    s_nop 0
    buffer_load_dwordx4 v4, s[4:7], s48 offen offset:512 lds
    buffer_load_dwordx4 v5, s[4:7], s49 offen offset:1536 lds
    v_mfma_f32_32x32x16_bf16 a[64:79], v[180:183], v[36:39], a[64:79]
    ds_read_b64_tr_b16 v[160:161], v241 offset:8192
    ds_read_b64_tr_b16 v[162:163], v241 offset:8448
    ds_read_b64_tr_b16 v[164:165], v241 offset:9216
    ds_read_b64_tr_b16 v[166:167], v241 offset:9472
    v_mfma_f32_16x16x32_bf16 v[192:195], v[204:207], v[184:187], v[192:195]
    buffer_load_dwordx4 v4, s[4:7], s50 offen offset:2560 lds
    v_mfma_f32_32x32x16_bf16 a[64:79], v[184:187], v[40:43], a[64:79]
    ds_read_b64_tr_b16 v[168:169], v241 offset:10240
    ds_read_b64_tr_b16 v[170:171], v241 offset:10496
    ds_read_b64_tr_b16 v[172:173], v241 offset:11264
    ds_read_b64_tr_b16 v[174:175], v241 offset:11520
    buffer_load_dwordx4 v5, s[4:7], s51 offen offset:3584 lds
    v_mfma_f32_16x16x32_bf16 v[192:195], v[204:207], v[188:191], v[192:195]
    v_mfma_f32_32x32x16_bf16 a[64:79], v[188:191], v[44:47], a[64:79]
    s_add_u32 m0, s57, 16384
    s_add_u32 s52, s52, s0
    buffer_load_dwordx4 v240, s[8:11], s52 offen lds
    s_waitcnt lgkmcnt(8)
    v_dot2c_f32_bf16 v12, s66, v48
    v_dot2c_f32_bf16 v13, v48, v48
    v_dot2c_f32_bf16 v12, s66, v49
    v_dot2c_f32_bf16 v13, v49, v49
    v_dot2c_f32_bf16 v12, s66, v50
    v_dot2c_f32_bf16 v13, v50, v50
    v_dot2c_f32_bf16 v12, s66, v51
    v_dot2c_f32_bf16 v13, v51, v51
    v_dot2c_f32_bf16 v12, s66, v52
    v_dot2c_f32_bf16 v13, v52, v52
    v_dot2c_f32_bf16 v12, s66, v53
    v_dot2c_f32_bf16 v13, v53, v53
    v_dot2c_f32_bf16 v12, s66, v54
    v_dot2c_f32_bf16 v13, v54, v54
    v_dot2c_f32_bf16 v12, s66, v55
    v_dot2c_f32_bf16 v13, v55, v55
    v_dot2c_f32_bf16 v12, s66, v56
    v_dot2c_f32_bf16 v13, v56, v56
    v_dot2c_f32_bf16 v12, s66, v57
    v_dot2c_f32_bf16 v13, v57, v57
    v_dot2c_f32_bf16 v12, s66, v58
    v_dot2c_f32_bf16 v13, v58, v58
    v_dot2c_f32_bf16 v12, s66, v59
    v_dot2c_f32_bf16 v13, v59, v59
    v_dot2c_f32_bf16 v12, s66, v60
    v_dot2c_f32_bf16 v13, v60, v60
    v_dot2c_f32_bf16 v12, s66, v61
    v_dot2c_f32_bf16 v13, v61, v61
    v_dot2c_f32_bf16 v12, s66, v62
    v_dot2c_f32_bf16 v13, v62, v62
    v_dot2c_f32_bf16 v12, s66, v63
    v_dot2c_f32_bf16 v13, v63, v63
    s_waitcnt lgkmcnt(0)
    v_mfma_f32_16x16x32_bf16 v[192:195], v[204:207], v[160:163], v[192:195]
    s_waitcnt vmcnt(5)
    s_barrier
    v_mfma_f32_32x32x16_bf16 a[64:79], v[160:163], v[48:51], a[64:79]
    ds_read_b128 v[64:67], v128 offset:49152
    ds_read_b128 v[68:71], v129 offset:49152
    ds_read_b128 v[72:75], v130 offset:49152
    ds_read_b128 v[76:79], v131 offset:49152
    v_mfma_f32_16x16x32_bf16 v[192:195], v[204:207], v[164:167], v[192:195]
    s_add_u32 m0, s56, 81280
    s_nop 0
    buffer_load_dwordx4 v4, s[4:7], s48 offen offset:640 lds
    buffer_load_dwordx4 v5, s[4:7], s49 offen offset:1664 lds
    v_mfma_f32_32x32x16_bf16 a[64:79], v[164:167], v[52:55], a[64:79]
    ds_read_b64_tr_b16 v[176:177], v241 offset:12288
    ds_read_b64_tr_b16 v[178:179], v241 offset:12544
    ds_read_b64_tr_b16 v[180:181], v241 offset:13312
    ds_read_b64_tr_b16 v[182:183], v241 offset:13568
    v_mfma_f32_16x16x32_bf16 v[192:195], v[204:207], v[168:171], v[192:195]
    buffer_load_dwordx4 v4, s[4:7], s50 offen offset:2688 lds
    v_mfma_f32_32x32x16_bf16 a[64:79], v[168:171], v[56:59], a[64:79]
    ds_read_b64_tr_b16 v[184:185], v241 offset:14336
    ds_read_b64_tr_b16 v[186:187], v241 offset:14592
    ds_read_b64_tr_b16 v[188:189], v241 offset:15360
    ds_read_b64_tr_b16 v[190:191], v241 offset:15616
    buffer_load_dwordx4 v5, s[4:7], s51 offen offset:3712 lds
    v_mfma_f32_16x16x32_bf16 v[192:195], v[204:207], v[172:175], v[192:195]
    v_mfma_f32_32x32x16_bf16 a[64:79], v[172:175], v[60:63], a[64:79]
    s_add_u32 m0, s57, 20480
    s_add_u32 s52, s52, s0
    buffer_load_dwordx4 v240, s[8:11], s52 offen lds
    s_waitcnt lgkmcnt(8)
    v_dot2c_f32_bf16 v12, s66, v64
    v_dot2c_f32_bf16 v13, v64, v64
    v_dot2c_f32_bf16 v12, s66, v65
    v_dot2c_f32_bf16 v13, v65, v65
    v_dot2c_f32_bf16 v12, s66, v66
    v_dot2c_f32_bf16 v13, v66, v66
    v_dot2c_f32_bf16 v12, s66, v67
    v_dot2c_f32_bf16 v13, v67, v67
    v_dot2c_f32_bf16 v12, s66, v68
    v_dot2c_f32_bf16 v13, v68, v68
    v_dot2c_f32_bf16 v12, s66, v69
    v_dot2c_f32_bf16 v13, v69, v69
    v_dot2c_f32_bf16 v12, s66, v70
    v_dot2c_f32_bf16 v13, v70, v70
    v_dot2c_f32_bf16 v12, s66, v71
    v_dot2c_f32_bf16 v13, v71, v71
    v_dot2c_f32_bf16 v12, s66, v72
    v_dot2c_f32_bf16 v13, v72, v72
    v_dot2c_f32_bf16 v12, s66, v73
    v_dot2c_f32_bf16 v13, v73, v73
    v_dot2c_f32_bf16 v12, s66, v74
    v_dot2c_f32_bf16 v13, v74, v74
    v_dot2c_f32_bf16 v12, s66, v75
    v_dot2c_f32_bf16 v13, v75, v75
    v_dot2c_f32_bf16 v12, s66, v76
    v_dot2c_f32_bf16 v13, v76, v76
    v_dot2c_f32_bf16 v12, s66, v77
    v_dot2c_f32_bf16 v13, v77, v77
    v_dot2c_f32_bf16 v12, s66, v78
    v_dot2c_f32_bf16 v13, v78, v78
    v_dot2c_f32_bf16 v12, s66, v79
    v_dot2c_f32_bf16 v13, v79, v79
    s_waitcnt lgkmcnt(0)
    v_mfma_f32_16x16x32_bf16 v[192:195], v[204:207], v[176:179], v[192:195]
    s_waitcnt vmcnt(5)
    s_barrier
    v_mfma_f32_32x32x16_bf16 a[64:79], v[176:179], v[64:67], a[64:79]
    v_add_u32 v128, 0x10000, v128
    v_add_u32 v129, 0x10000, v129
    v_add_u32 v130, 0x10000, v130
    v_add_u32 v131, 0x10000, v131
    ds_read_b128 v[80:83], v128 offset:0
    ds_read_b128 v[84:87], v129 offset:0
    ds_read_b128 v[88:91], v130 offset:0
    ds_read_b128 v[92:95], v131 offset:0
    s_cmp_lt_u32 s73, 5
    s_cselect_b64 exec, -1, 0
    ds_read_b128 a[240:243], v156
    ds_read_b128 a[244:247], v157
    s_mov_b64 exec, -1
    v_mfma_f32_16x16x32_bf16 v[192:195], v[204:207], v[180:183], v[192:195]
    s_add_u32 m0, s56, 97536
    s_nop 0
    buffer_load_dwordx4 v4, s[4:7], s48 offen offset:768 lds
    buffer_load_dwordx4 v5, s[4:7], s49 offen offset:1792 lds
    v_mfma_f32_32x32x16_bf16 a[64:79], v[180:183], v[68:71], a[64:79]
    ds_read_b64_tr_b16 v[160:161], v241 offset:16384
    ds_read_b64_tr_b16 v[162:163], v241 offset:16640
    ds_read_b64_tr_b16 v[164:165], v241 offset:17408
    ds_read_b64_tr_b16 v[166:167], v241 offset:17664
    v_mfma_f32_16x16x32_bf16 v[192:195], v[204:207], v[184:187], v[192:195]
    buffer_load_dwordx4 v4, s[4:7], s50 offen offset:2816 lds
    buffer_load_dwordx4 v5, s[4:7], s51 offen offset:3840 lds
    v_mfma_f32_32x32x16_bf16 a[64:79], v[184:187], v[72:75], a[64:79]
    ds_read_b64_tr_b16 v[168:169], v241 offset:18432
    ds_read_b64_tr_b16 v[170:171], v241 offset:18688
    ds_read_b64_tr_b16 v[172:173], v241 offset:19456
    ds_read_b64_tr_b16 v[174:175], v241 offset:19712
    s_add_u32 m0, s57, 24576
    s_add_u32 s52, s52, s0
    buffer_load_dwordx4 v240, s[8:11], s52 offen lds
    v_mfma_f32_16x16x32_bf16 v[192:195], v[204:207], v[188:191], v[192:195]
    v_mfma_f32_32x32x16_bf16 a[64:79], v[188:191], v[76:79], a[64:79]
    buffer_load_dword v158, off, s[36:39], 0 sc1
    s_waitcnt lgkmcnt(8)
    v_dot2c_f32_bf16 v12, s66, v80
    v_dot2c_f32_bf16 v13, v80, v80
    v_dot2c_f32_bf16 v12, s66, v81
    v_dot2c_f32_bf16 v13, v81, v81
    v_dot2c_f32_bf16 v12, s66, v82
    v_dot2c_f32_bf16 v13, v82, v82
    v_dot2c_f32_bf16 v12, s66, v83
    v_dot2c_f32_bf16 v13, v83, v83
    v_dot2c_f32_bf16 v12, s66, v84
    v_dot2c_f32_bf16 v13, v84, v84
    v_dot2c_f32_bf16 v12, s66, v85
    v_dot2c_f32_bf16 v13, v85, v85
    v_dot2c_f32_bf16 v12, s66, v86
    v_dot2c_f32_bf16 v13, v86, v86
    v_dot2c_f32_bf16 v12, s66, v87
    v_dot2c_f32_bf16 v13, v87, v87
    v_dot2c_f32_bf16 v12, s66, v88
    v_dot2c_f32_bf16 v13, v88, v88
    v_dot2c_f32_bf16 v12, s66, v89
    v_dot2c_f32_bf16 v13, v89, v89
    v_dot2c_f32_bf16 v12, s66, v90
    v_dot2c_f32_bf16 v13, v90, v90
    v_dot2c_f32_bf16 v12, s66, v91
    v_dot2c_f32_bf16 v13, v91, v91
    v_dot2c_f32_bf16 v12, s66, v92
    v_dot2c_f32_bf16 v13, v92, v92
    v_dot2c_f32_bf16 v12, s66, v93
    v_dot2c_f32_bf16 v13, v93, v93
    v_dot2c_f32_bf16 v12, s66, v94
    v_dot2c_f32_bf16 v13, v94, v94
    v_dot2c_f32_bf16 v12, s66, v95
    v_dot2c_f32_bf16 v13, v95, v95
    s_waitcnt lgkmcnt(0)
    v_mfma_f32_16x16x32_bf16 v[192:195], v[204:207], v[160:163], v[192:195]
    s_waitcnt vmcnt(6)
    s_barrier
    v_mfma_f32_32x32x16_bf16 a[64:79], v[160:163], v[80:83], a[64:79]
    ds_read_b128 v[96:99], v128 offset:16384
    ds_read_b128 v[100:103], v129 offset:16384
    ds_read_b128 v[104:107], v130 offset:16384
    ds_read_b128 v[108:111], v131 offset:16384
    v_mfma_f32_16x16x32_bf16 v[192:195], v[204:207], v[164:167], v[192:195]
    s_add_u32 m0, s58, 143616
    s_nop 0
    buffer_load_dwordx4 v6, s[12:15], s54 offen lds
    v_mfma_f32_32x32x16_bf16 a[64:79], v[164:167], v[84:87], a[64:79]
    ds_read_b64_tr_b16 v[176:177], v241 offset:20480
    ds_read_b64_tr_b16 v[178:179], v241 offset:20736
    ds_read_b64_tr_b16 v[180:181], v241 offset:21504
    ds_read_b64_tr_b16 v[182:183], v241 offset:21760
    v_mfma_f32_16x16x32_bf16 v[192:195], v[204:207], v[168:171], v[192:195]
    buffer_load_dwordx4 v6, s[16:19], s54 offen offset:1056 lds
    v_mfma_f32_32x32x16_bf16 a[64:79], v[168:171], v[88:91], a[64:79]
    ds_read_b64_tr_b16 v[184:185], v241 offset:22528
    ds_read_b64_tr_b16 v[186:187], v241 offset:22784
    ds_read_b64_tr_b16 v[188:189], v241 offset:23552
    ds_read_b64_tr_b16 v[190:191], v241 offset:23808
    s_add_u32 m0, s58, 152064
    s_add_u32 s54, s54, 57344
    buffer_load_dwordx4 v6, s[12:15], s54 offen lds
    v_mfma_f32_16x16x32_bf16 v[192:195], v[204:207], v[172:175], v[192:195]
    v_mfma_f32_32x32x16_bf16 a[64:79], v[172:175], v[92:95], a[64:79]
    buffer_load_dwordx4 v6, s[16:19], s54 offen offset:1056 lds
    s_waitcnt lgkmcnt(8)
    v_dot2c_f32_bf16 v12, s66, v96
    v_dot2c_f32_bf16 v13, v96, v96
    v_dot2c_f32_bf16 v12, s66, v97
    v_dot2c_f32_bf16 v13, v97, v97
    v_dot2c_f32_bf16 v12, s66, v98
    v_dot2c_f32_bf16 v13, v98, v98
    v_dot2c_f32_bf16 v12, s66, v99
    v_dot2c_f32_bf16 v13, v99, v99
    v_dot2c_f32_bf16 v12, s66, v100
    v_dot2c_f32_bf16 v13, v100, v100
    v_dot2c_f32_bf16 v12, s66, v101
    v_dot2c_f32_bf16 v13, v101, v101
    v_dot2c_f32_bf16 v12, s66, v102
    v_dot2c_f32_bf16 v13, v102, v102
    v_dot2c_f32_bf16 v12, s66, v103
    v_dot2c_f32_bf16 v13, v103, v103
    v_dot2c_f32_bf16 v12, s66, v104
    v_dot2c_f32_bf16 v13, v104, v104
    v_dot2c_f32_bf16 v12, s66, v105
    v_dot2c_f32_bf16 v13, v105, v105
    v_dot2c_f32_bf16 v12, s66, v106
    v_dot2c_f32_bf16 v13, v106, v106
    v_dot2c_f32_bf16 v12, s66, v107
    v_dot2c_f32_bf16 v13, v107, v107
    v_dot2c_f32_bf16 v12, s66, v108
    v_dot2c_f32_bf16 v13, v108, v108
    v_dot2c_f32_bf16 v12, s66, v109
    v_dot2c_f32_bf16 v13, v109, v109
    v_dot2c_f32_bf16 v12, s66, v110
    v_dot2c_f32_bf16 v13, v110, v110
    v_dot2c_f32_bf16 v12, s66, v111
    v_dot2c_f32_bf16 v13, v111, v111
    s_waitcnt lgkmcnt(0)
    v_mfma_f32_16x16x32_bf16 v[192:195], v[204:207], v[176:179], v[192:195]
    s_waitcnt vmcnt(5)
    s_barrier
    v_mfma_f32_32x32x16_bf16 a[64:79], v[176:179], v[96:99], a[64:79]
    ds_read_b128 v[112:115], v128 offset:32768
    ds_read_b128 v[116:119], v129 offset:32768
    ds_read_b128 v[120:123], v130 offset:32768
    ds_read_b128 v[124:127], v131 offset:32768
    s_cmp_ge_u32 s73, 5
    s_cselect_b64 exec, -1, 0
    ds_read_b128 a[240:243], v156
    ds_read_b128 a[244:247], v157
    s_mov_b64 exec, -1
    v_mfma_f32_16x16x32_bf16 v[192:195], v[204:207], v[180:183], v[192:195]
    s_add_u32 m0, s58, 0
    s_add_u32 s54, s54, 57344
    buffer_load_dwordx4 v6, s[12:15], s54 offen lds
    v_mfma_f32_32x32x16_bf16 a[64:79], v[180:183], v[100:103], a[64:79]
    ds_read_b64_tr_b16 v[160:161], v241 offset:24576
    ds_read_b64_tr_b16 v[162:163], v241 offset:24832
    ds_read_b64_tr_b16 v[164:165], v241 offset:25600
    ds_read_b64_tr_b16 v[166:167], v241 offset:25856
    v_mfma_f32_16x16x32_bf16 v[192:195], v[204:207], v[184:187], v[192:195]
    buffer_load_dwordx4 v6, s[16:19], s54 offen offset:1056 lds
    v_mfma_f32_32x32x16_bf16 a[64:79], v[184:187], v[104:107], a[64:79]
    ds_read_b64_tr_b16 v[168:169], v241 offset:26624
    ds_read_b64_tr_b16 v[170:171], v241 offset:26880
    ds_read_b64_tr_b16 v[172:173], v241 offset:27648
    ds_read_b64_tr_b16 v[174:175], v241 offset:27904
    s_add_u32 m0, s58, 8448
    s_add_u32 s54, s54, 57344
    buffer_load_dwordx4 v6, s[12:15], s54 offen lds
    v_mfma_f32_16x16x32_bf16 v[192:195], v[204:207], v[188:191], v[192:195]
    v_mfma_f32_32x32x16_bf16 a[64:79], v[188:191], v[108:111], a[64:79]
    buffer_load_dwordx4 v6, s[16:19], s54 offen offset:1056 lds
    s_waitcnt vmcnt(8)
    v_readfirstlane_b32 s60, v158
    s_nop 0
    s_cmp_lg_u32 s60, 0
    s_cbranch_scc1 L_nonce_ok
    s_mov_b32 s65, 32768
L_nonce_lp:
    s_sleep 8
    buffer_load_dword v158, off, s[36:39], 0 sc1
    s_waitcnt vmcnt(0)
    v_readfirstlane_b32 s60, v158
    s_nop 0
    s_cmp_lg_u32 s60, 0
    s_cbranch_scc1 L_nonce_ok
    s_sub_u32 s65, s65, 1
    s_cmp_lg_u32 s65, 0
    s_cbranch_scc1 L_nonce_lp
L_nonce_ok:
    s_add_u32 m0, s58, 16896
    s_add_u32 s54, s54, 57344
    buffer_load_dwordx4 v6, s[12:15], s54 offen lds
    s_waitcnt lgkmcnt(8)
    v_dot2c_f32_bf16 v12, s66, v112
    v_dot2c_f32_bf16 v13, v112, v112
    v_dot2c_f32_bf16 v12, s66, v113
    v_dot2c_f32_bf16 v13, v113, v113
    v_dot2c_f32_bf16 v12, s66, v114
    v_dot2c_f32_bf16 v13, v114, v114
    v_dot2c_f32_bf16 v12, s66, v115
    v_dot2c_f32_bf16 v13, v115, v115
    v_dot2c_f32_bf16 v12, s66, v116
    v_dot2c_f32_bf16 v13, v116, v116
    v_dot2c_f32_bf16 v12, s66, v117
    v_dot2c_f32_bf16 v13, v117, v117
    v_dot2c_f32_bf16 v12, s66, v118
    v_dot2c_f32_bf16 v13, v118, v118
    v_dot2c_f32_bf16 v12, s66, v119
    v_dot2c_f32_bf16 v13, v119, v119
    v_dot2c_f32_bf16 v12, s66, v120
    v_dot2c_f32_bf16 v13, v120, v120
    v_dot2c_f32_bf16 v12, s66, v121
    v_dot2c_f32_bf16 v13, v121, v121
    v_dot2c_f32_bf16 v12, s66, v122
    v_dot2c_f32_bf16 v13, v122, v122
    v_dot2c_f32_bf16 v12, s66, v123
    v_dot2c_f32_bf16 v13, v123, v123
    v_dot2c_f32_bf16 v12, s66, v124
    v_dot2c_f32_bf16 v13, v124, v124
    v_dot2c_f32_bf16 v12, s66, v125
    v_dot2c_f32_bf16 v13, v125, v125
    v_dot2c_f32_bf16 v12, s66, v126
    v_dot2c_f32_bf16 v13, v126, v126
    v_dot2c_f32_bf16 v12, s66, v127
    v_dot2c_f32_bf16 v13, v127, v127
    s_waitcnt lgkmcnt(0)
    v_mfma_f32_16x16x32_bf16 v[192:195], v[204:207], v[160:163], v[192:195]
    s_nop 1
    v_mov_b32 v140, v12
    v_mov_b32 v142, v13
    s_nop 0
    v_permlane32_swap_b32 v140, v12
    v_mfma_f32_16x16x32_bf16 v[192:195], v[204:207], v[164:167], v[192:195]
    v_permlane32_swap_b32 v142, v13
    v_add_f32 v12, v12, v140
    v_add_f32 v13, v13, v142
    v_mul_f32 v12, 0x3b124925, v12
    v_mul_f32 v13, 0x3b124925, v13
    v_mfma_f32_16x16x32_bf16 v[192:195], v[204:207], v[168:171], v[192:195]
    v_fma_f32 v13, -v12, v12, v13
    v_max_f32 v13, 0, v13
    v_cvt_pk_bf16_f32 v140, v12, v13
    v_and_b32 v13, 0xffff0000, v140
    v_mfma_f32_16x16x32_bf16 v[192:195], v[204:207], v[172:175], v[192:195]
    v_add_f32 v13, 0x3727c5ac, v13
    v_cvt_pk_bf16_f32 v13, v13, v13
    v_and_b32 v13, 0xffff0000, v13
    v_sqrt_f32 v13, v13
    v_mfma_f32_32x32x16_bf16 a[64:79], v[160:163], v[112:115], a[64:79]
    s_waitcnt vmcnt(1)
    s_barrier
    ds_read_b64_tr_b16 a[0:1], v7 offset:25344
    ds_read_b64_tr_b16 a[2:3], v7 offset:25600
    ds_read_b64_tr_b16 a[4:5], v7 offset:25376
    ds_read_b64_tr_b16 a[6:7], v7 offset:25632
    ds_read_b64_tr_b16 a[8:9], v7 offset:25408
    ds_read_b64_tr_b16 a[10:11], v7 offset:25664
    ds_read_b64_tr_b16 a[12:13], v7 offset:25440
    ds_read_b64_tr_b16 a[14:15], v7 offset:25696
    v_lshlrev_b32 v12, 16, v140
    v_cvt_pk_bf16_f32 v13, v13, v13
    v_and_b32 v13, 0xffff0000, v13
    v_rcp_f32 v242, v13
    v_mfma_f32_32x32x16_bf16 a[64:79], v[164:167], v[116:119], a[64:79]
    ds_read_b64_tr_b16 a[16:17], v7 offset:25472
    ds_read_b64_tr_b16 a[18:19], v7 offset:25728
    ds_read_b64_tr_b16 a[20:21], v7 offset:25504
    ds_read_b64_tr_b16 a[22:23], v7 offset:25760
    ds_read_b64_tr_b16 a[24:25], v7 offset:25536
    ds_read_b64_tr_b16 a[26:27], v7 offset:25792
    v_cvt_pk_bf16_f32 v200, -v12, -v12
    v_mul_f32 v8, 0x3fb8aa3b, v242
    v_mul_f32 v242, s1, v242
    v_mul_f32 v9, -v12, v8
    v_mfma_f32_32x32x16_bf16 a[64:79], v[168:171], v[120:123], a[64:79]
    ds_read_b64_tr_b16 a[28:29], v7 offset:33792
    ds_read_b64_tr_b16 a[30:31], v7 offset:34048
    ds_read_b64_tr_b16 a[32:33], v7 offset:33824
    ds_read_b64_tr_b16 a[34:35], v7 offset:34080
    ds_read_b64_tr_b16 a[36:37], v7 offset:33856
    ds_read_b64_tr_b16 a[38:39], v7 offset:34112
    v_cvt_pk_bf16_f32 v142, v192, v192
    v_cmp_gt_u32 vcc, 32, v1
    v_and_b32 v142, 0xffff0000, v142
    v_sub_f32 v143, v192, v142
    v_cvt_pk_bf16_f32 v142, v142, v143
    v_cndmask_b32 v196, 0, v142, vcc
    v_mfma_f32_32x32x16_bf16 a[64:79], v[172:175], v[124:127], a[64:79]
    buffer_load_dwordx4 v6, s[16:19], s54 offen offset:1056 lds
    v_lshlrev_b32 v10, 16, v16
    v_and_b32 v11, 0xffff0000, v16
    v_lshlrev_b32 v4, 16, v17
    v_and_b32 v5, 0xffff0000, v17
    v_fma_f32 v10, v10, v8, v9
    v_fma_f32 v11, v11, v8, v9
    v_fma_f32 v4, v4, v8, v9
    v_fma_f32 v5, v5, v8, v9
    v_cvt_pk_bf16_f32 v16, v10, v11
    v_cvt_pk_bf16_f32 v17, v4, v5
    v_mfma_f32_32x32x16_bf16 a[64:79], v[196:199], v[200:203], a[64:79]
    s_add_u32 m0, s58, 25344
    s_add_u32 s54, s54, 57344
    buffer_load_dwordx4 v6, s[12:15], s54 offen lds
    buffer_load_dwordx4 v6, s[16:19], s54 offen offset:1056 lds
    v_lshlrev_b32 v10, 16, v18
    v_and_b32 v11, 0xffff0000, v18
    v_lshlrev_b32 v4, 16, v19
    v_and_b32 v5, 0xffff0000, v19
    v_fma_f32 v10, v10, v8, v9
    v_fma_f32 v11, v11, v8, v9
    v_fma_f32 v4, v4, v8, v9
    v_fma_f32 v5, v5, v8, v9
    v_cvt_pk_bf16_f32 v18, v10, v11
    v_cvt_pk_bf16_f32 v19, v4, v5
    s_nop 0
    s_waitcnt lgkmcnt(6)
    v_mfma_f32_32x32x16_bf16 v[128:143], a[0:3], v[16:19], 0
    ds_read_b64_tr_b16 a[40:41], v7 offset:33888
    ds_read_b64_tr_b16 a[42:43], v7 offset:34144
    s_add_u32 m0, s58, 33792
    s_add_u32 s54, s54, 57344
    buffer_load_dwordx4 v6, s[12:15], s54 offen lds
    v_lshlrev_b32 v10, 16, v20
    v_and_b32 v11, 0xffff0000, v20
    v_mfma_f32_32x32x16_bf16 v[144:159], a[4:7], v[16:19], 0
    ds_read_b64_tr_b16 a[44:45], v7 offset:33920
    ds_read_b64_tr_b16 a[46:47], v7 offset:34176
    buffer_load_dwordx4 v6, s[16:19], s54 offen offset:1056 lds
    v_lshlrev_b32 v4, 16, v21
    v_and_b32 v5, 0xffff0000, v21
    v_fma_f32 v10, v10, v8, v9
    v_mfma_f32_32x32x16_bf16 v[160:175], a[8:11], v[16:19], 0
    ds_read_b64_tr_b16 a[48:49], v7 offset:33952
    ds_read_b64_tr_b16 a[50:51], v7 offset:34208
    v_fma_f32 v11, v11, v8, v9
    v_fma_f32 v4, v4, v8, v9
    v_fma_f32 v5, v5, v8, v9
    v_cvt_pk_bf16_f32 v20, v10, v11
    v_cvt_pk_bf16_f32 v21, v4, v5
    v_lshlrev_b32 v10, 16, v22
    v_mfma_f32_32x32x16_bf16 v[176:191], a[12:15], v[16:19], 0
    ds_read_b64_tr_b16 a[52:53], v7 offset:33984
    ds_read_b64_tr_b16 a[54:55], v7 offset:34240
    v_and_b32 v11, 0xffff0000, v22
    v_lshlrev_b32 v4, 16, v23
    v_and_b32 v5, 0xffff0000, v23
    v_fma_f32 v10, v10, v8, v9
    v_fma_f32 v11, v11, v8, v9
    v_mfma_f32_32x32x16_bf16 v[192:207], a[16:19], v[16:19], 0
    v_add_u32 v7, 0xfffe3200, v7
    ds_read_b64_tr_b16 a[0:1], v7 offset:0
    ds_read_b64_tr_b16 a[2:3], v7 offset:256
    v_fma_f32 v4, v4, v8, v9
    v_fma_f32 v5, v5, v8, v9
    v_cvt_pk_bf16_f32 v22, v10, v11
    v_cvt_pk_bf16_f32 v23, v4, v5
    v_lshlrev_b32 v10, 16, v24
    v_mfma_f32_32x32x16_bf16 v[208:223], a[20:23], v[16:19], 0
    ds_read_b64_tr_b16 a[4:5], v7 offset:32
    ds_read_b64_tr_b16 a[6:7], v7 offset:288
    v_and_b32 v11, 0xffff0000, v24
    v_lshlrev_b32 v4, 16, v25
    v_and_b32 v5, 0xffff0000, v25
    v_fma_f32 v10, v10, v8, v9
    v_fma_f32 v11, v11, v8, v9
    v_mfma_f32_32x32x16_bf16 v[224:239], a[24:27], v[16:19], 0
    s_waitcnt lgkmcnt(4)
    ds_read_b64_tr_b16 a[8:9], v7 offset:64
    ds_read_b64_tr_b16 a[10:11], v7 offset:320
    v_fma_f32 v4, v4, v8, v9
    v_fma_f32 v5, v5, v8, v9
    v_cvt_pk_bf16_f32 v24, v10, v11
    v_cvt_pk_bf16_f32 v25, v4, v5
    v_mfma_f32_32x32x16_bf16 v[128:143], a[28:31], v[20:23], v[128:143]
    ds_read_b64_tr_b16 a[12:13], v7 offset:96
    ds_read_b64_tr_b16 a[14:15], v7 offset:352
    s_add_u32 m0, s58, 42240
    s_add_u32 s54, s54, 57344
    buffer_load_dwordx4 v6, s[12:15], s54 offen lds
    v_lshlrev_b32 v10, 16, v26
    v_and_b32 v11, 0xffff0000, v26
    v_mfma_f32_32x32x16_bf16 v[144:159], a[32:35], v[20:23], v[144:159]
    ds_read_b64_tr_b16 a[16:17], v7 offset:128
    ds_read_b64_tr_b16 a[18:19], v7 offset:384
    buffer_load_dwordx4 v6, s[16:19], s54 offen offset:1056 lds
    v_lshlrev_b32 v4, 16, v27
    v_and_b32 v5, 0xffff0000, v27
    v_fma_f32 v10, v10, v8, v9
    v_mfma_f32_32x32x16_bf16 v[160:175], a[36:39], v[20:23], v[160:175]
    ds_read_b64_tr_b16 a[20:21], v7 offset:160
    ds_read_b64_tr_b16 a[22:23], v7 offset:416
    v_fma_f32 v11, v11, v8, v9
    v_fma_f32 v4, v4, v8, v9
    v_fma_f32 v5, v5, v8, v9
    v_cvt_pk_bf16_f32 v26, v10, v11
    v_cvt_pk_bf16_f32 v27, v4, v5
    v_lshlrev_b32 v10, 16, v28
    v_mfma_f32_32x32x16_bf16 v[176:191], a[40:43], v[20:23], v[176:191]
    ds_read_b64_tr_b16 a[24:25], v7 offset:192
    ds_read_b64_tr_b16 a[26:27], v7 offset:448
    v_and_b32 v11, 0xffff0000, v28
    v_lshlrev_b32 v4, 16, v29
    v_and_b32 v5, 0xffff0000, v29
    v_fma_f32 v10, v10, v8, v9
    v_fma_f32 v11, v11, v8, v9
    v_mfma_f32_32x32x16_bf16 v[192:207], a[44:47], v[20:23], v[192:207]
    ds_read_b64_tr_b16 a[28:29], v7 offset:8448
    ds_read_b64_tr_b16 a[30:31], v7 offset:8704
    v_fma_f32 v4, v4, v8, v9
    v_fma_f32 v5, v5, v8, v9
    v_cvt_pk_bf16_f32 v28, v10, v11
    v_cvt_pk_bf16_f32 v29, v4, v5
    v_lshlrev_b32 v10, 16, v30
    v_and_b32 v11, 0xffff0000, v30
    v_mfma_f32_32x32x16_bf16 v[208:223], a[48:51], v[20:23], v[208:223]
    ds_read_b64_tr_b16 a[32:33], v7 offset:8480
    ds_read_b64_tr_b16 a[34:35], v7 offset:8736
    v_lshlrev_b32 v4, 16, v31
    v_and_b32 v5, 0xffff0000, v31
    v_fma_f32 v10, v10, v8, v9
    v_fma_f32 v11, v11, v8, v9
    v_fma_f32 v4, v4, v8, v9
    v_mfma_f32_32x32x16_bf16 v[224:239], a[52:55], v[20:23], v[224:239]
    s_waitcnt lgkmcnt(4)
    ds_read_b64_tr_b16 a[36:37], v7 offset:8512
    ds_read_b64_tr_b16 a[38:39], v7 offset:8768
    v_fma_f32 v5, v5, v8, v9
    v_cvt_pk_bf16_f32 v30, v10, v11
    v_cvt_pk_bf16_f32 v31, v4, v5
    v_mfma_f32_32x32x16_bf16 v[128:143], a[0:3], v[24:27], v[128:143]
    s_waitcnt vmcnt(4)
    s_barrier
    ds_read_b64_tr_b16 a[40:41], v7 offset:8544
    ds_read_b64_tr_b16 a[42:43], v7 offset:8800
    v_lshlrev_b32 v10, 16, v32
    v_and_b32 v11, 0xffff0000, v32
    v_lshlrev_b32 v4, 16, v33
    v_mfma_f32_32x32x16_bf16 v[144:159], a[4:7], v[24:27], v[144:159]
    ds_read_b64_tr_b16 a[44:45], v7 offset:8576
    ds_read_b64_tr_b16 a[46:47], v7 offset:8832
    s_add_u32 m0, s58, 50688
    s_add_u32 s54, s54, 57344
    buffer_load_dwordx4 v6, s[12:15], s54 offen lds
    v_and_b32 v5, 0xffff0000, v33
    v_fma_f32 v10, v10, v8, v9
    v_mfma_f32_32x32x16_bf16 v[160:175], a[8:11], v[24:27], v[160:175]
    ds_read_b64_tr_b16 a[48:49], v7 offset:8608
    ds_read_b64_tr_b16 a[50:51], v7 offset:8864
    buffer_load_dwordx4 v6, s[16:19], s54 offen offset:1056 lds
    v_fma_f32 v11, v11, v8, v9
    v_fma_f32 v4, v4, v8, v9
    v_fma_f32 v5, v5, v8, v9
    v_cvt_pk_bf16_f32 v32, v10, v11
    v_cvt_pk_bf16_f32 v33, v4, v5
    v_mfma_f32_32x32x16_bf16 v[176:191], a[12:15], v[24:27], v[176:191]
    ds_read_b64_tr_b16 a[52:53], v7 offset:8640
    ds_read_b64_tr_b16 a[54:55], v7 offset:8896
    s_add_u32 m0, s58, 59136
    s_add_u32 s54, s54, 57344
    buffer_load_dwordx4 v6, s[12:15], s54 offen lds
    v_lshlrev_b32 v10, 16, v34
    v_and_b32 v11, 0xffff0000, v34
    v_mfma_f32_32x32x16_bf16 v[192:207], a[16:19], v[24:27], v[192:207]
    ds_read_b64_tr_b16 a[0:1], v7 offset:16896
    ds_read_b64_tr_b16 a[2:3], v7 offset:17152
    buffer_load_dwordx4 v6, s[16:19], s54 offen offset:1056 lds
    v_lshlrev_b32 v4, 16, v35
    v_and_b32 v5, 0xffff0000, v35
    v_fma_f32 v10, v10, v8, v9
    v_fma_f32 v11, v11, v8, v9
    v_fma_f32 v4, v4, v8, v9
    v_mfma_f32_32x32x16_bf16 v[208:223], a[20:23], v[24:27], v[208:223]
    ds_read_b64_tr_b16 a[4:5], v7 offset:16928
    ds_read_b64_tr_b16 a[6:7], v7 offset:17184
    s_add_u32 m0, s58, 67584
    s_add_u32 s54, s54, 57344
    buffer_load_dwordx4 v6, s[12:15], s54 offen lds
    v_fma_f32 v5, v5, v8, v9
    v_cvt_pk_bf16_f32 v34, v10, v11
    v_mfma_f32_32x32x16_bf16 v[224:239], a[24:27], v[24:27], v[224:239]
    s_waitcnt lgkmcnt(4)
    ds_read_b64_tr_b16 a[8:9], v7 offset:16960
    ds_read_b64_tr_b16 a[10:11], v7 offset:17216
    v_cvt_pk_bf16_f32 v35, v4, v5
    v_accvgpr_read_b32 v240, a64
    v_accvgpr_read_b32 v243, a65
    v_mul_f32 v240, v242, v240
    v_mul_f32 v243, v242, v243
    v_cvt_pk_bf16_f32 v244, v240, v243
    v_mfma_f32_32x32x16_bf16 v[128:143], a[28:31], v[28:31], v[128:143]
    ds_read_b64_tr_b16 a[12:13], v7 offset:16992
    ds_read_b64_tr_b16 a[14:15], v7 offset:17248
    buffer_load_dwordx4 v6, s[16:19], s54 offen offset:1056 lds
    v_accvgpr_read_b32 v240, a66
    v_accvgpr_read_b32 v243, a67
    v_mul_f32 v240, v242, v240
    v_mul_f32 v243, v242, v243
    v_mfma_f32_32x32x16_bf16 v[144:159], a[32:35], v[28:31], v[144:159]
    ds_read_b64_tr_b16 a[16:17], v7 offset:17024
    ds_read_b64_tr_b16 a[18:19], v7 offset:17280
    v_cvt_pk_bf16_f32 v245, v240, v243
    v_accvgpr_read_b32 v240, a68
    v_accvgpr_read_b32 v243, a69
    v_lshlrev_b32 v10, 16, v36
    v_and_b32 v11, 0xffff0000, v36
    v_lshlrev_b32 v4, 16, v37
    v_and_b32 v5, 0xffff0000, v37
    v_mfma_f32_32x32x16_bf16 v[160:175], a[36:39], v[28:31], v[160:175]
    ds_read_b64_tr_b16 a[20:21], v7 offset:17056
    ds_read_b64_tr_b16 a[22:23], v7 offset:17312
    v_fma_f32 v10, v10, v8, v9
    v_fma_f32 v11, v11, v8, v9
    v_fma_f32 v4, v4, v8, v9
    v_fma_f32 v5, v5, v8, v9
    v_cvt_pk_bf16_f32 v36, v10, v11
    v_cvt_pk_bf16_f32 v37, v4, v5
    v_mfma_f32_32x32x16_bf16 v[176:191], a[40:43], v[28:31], v[176:191]
    ds_read_b64_tr_b16 a[24:25], v7 offset:17088
    ds_read_b64_tr_b16 a[26:27], v7 offset:17344
    v_lshlrev_b32 v10, 16, v38
    v_and_b32 v11, 0xffff0000, v38
    v_lshlrev_b32 v4, 16, v39
    v_and_b32 v5, 0xffff0000, v39
    v_fma_f32 v10, v10, v8, v9
    v_fma_f32 v11, v11, v8, v9
    v_fma_f32 v4, v4, v8, v9
    v_mfma_f32_32x32x16_bf16 v[192:207], a[44:47], v[28:31], v[192:207]
    ds_read_b64_tr_b16 a[28:29], v7 offset:25344
    ds_read_b64_tr_b16 a[30:31], v7 offset:25600
    v_fma_f32 v5, v5, v8, v9
    v_cvt_pk_bf16_f32 v38, v10, v11
    v_cvt_pk_bf16_f32 v39, v4, v5
    v_mul_f32 v240, v242, v240
    v_mul_f32 v243, v242, v243
    v_cvt_pk_bf16_f32 v246, v240, v243
    v_mfma_f32_32x32x16_bf16 v[208:223], a[48:51], v[28:31], v[208:223]
    ds_read_b64_tr_b16 a[32:33], v7 offset:25376
    ds_read_b64_tr_b16 a[34:35], v7 offset:25632
    v_accvgpr_read_b32 v240, a70
    v_accvgpr_read_b32 v243, a71
    v_mul_f32 v240, v242, v240
    v_mul_f32 v243, v242, v243
    v_cvt_pk_bf16_f32 v247, v240, v243
    v_accvgpr_read_b32 v240, a72
    v_accvgpr_read_b32 v243, a73
    v_mfma_f32_32x32x16_bf16 v[224:239], a[52:55], v[28:31], v[224:239]
    s_waitcnt lgkmcnt(4)
    ds_read_b64_tr_b16 a[36:37], v7 offset:25408
    ds_read_b64_tr_b16 a[38:39], v7 offset:25664
    v_mul_f32 v240, v242, v240
    v_mul_f32 v243, v242, v243
    v_mfma_f32_32x32x16_bf16 v[128:143], a[0:3], v[32:35], v[128:143]
    s_waitcnt vmcnt(6)
    s_barrier
    ds_read_b64_tr_b16 a[40:41], v7 offset:25440
    ds_read_b64_tr_b16 a[42:43], v7 offset:25696
    v_lshlrev_b32 v10, 16, v40
    v_and_b32 v11, 0xffff0000, v40
    v_mfma_f32_32x32x16_bf16 v[144:159], a[4:7], v[32:35], v[144:159]
    ds_read_b64_tr_b16 a[44:45], v7 offset:25472
    ds_read_b64_tr_b16 a[46:47], v7 offset:25728
    s_add_u32 m0, s58, 76032
    s_add_u32 s54, s54, 57344
    buffer_load_dwordx4 v6, s[12:15], s54 offen lds
    v_lshlrev_b32 v4, 16, v41
    v_and_b32 v5, 0xffff0000, v41
    v_fma_f32 v10, v10, v8, v9
    v_mfma_f32_32x32x16_bf16 v[160:175], a[8:11], v[32:35], v[160:175]
    ds_read_b64_tr_b16 a[48:49], v7 offset:25504
    ds_read_b64_tr_b16 a[50:51], v7 offset:25760
    buffer_load_dwordx4 v6, s[16:19], s54 offen offset:1056 lds
    v_fma_f32 v11, v11, v8, v9
    v_fma_f32 v4, v4, v8, v9
    v_fma_f32 v5, v5, v8, v9
    v_cvt_pk_bf16_f32 v40, v10, v11
    v_mfma_f32_32x32x16_bf16 v[176:191], a[12:15], v[32:35], v[176:191]
    ds_read_b64_tr_b16 a[52:53], v7 offset:25536
    ds_read_b64_tr_b16 a[54:55], v7 offset:25792
    s_add_u32 m0, s58, 84480
    s_add_u32 s54, s54, 57344
    buffer_load_dwordx4 v6, s[12:15], s54 offen lds
    v_cvt_pk_bf16_f32 v41, v4, v5
    v_lshlrev_b32 v10, 16, v42
    v_mfma_f32_32x32x16_bf16 v[192:207], a[16:19], v[32:35], v[192:207]
    ds_read_b64_tr_b16 a[0:1], v7 offset:33792
    ds_read_b64_tr_b16 a[2:3], v7 offset:34048
    buffer_load_dwordx4 v6, s[16:19], s54 offen offset:1056 lds
    v_and_b32 v11, 0xffff0000, v42
    v_lshlrev_b32 v4, 16, v43
    v_and_b32 v5, 0xffff0000, v43
    v_fma_f32 v10, v10, v8, v9
    v_mfma_f32_32x32x16_bf16 v[208:223], a[20:23], v[32:35], v[208:223]
    ds_read_b64_tr_b16 a[4:5], v7 offset:33824
    ds_read_b64_tr_b16 a[6:7], v7 offset:34080
    v_fma_f32 v11, v11, v8, v9
    v_fma_f32 v4, v4, v8, v9
    v_fma_f32 v5, v5, v8, v9
    v_cvt_pk_bf16_f32 v42, v10, v11
    v_cvt_pk_bf16_f32 v43, v4, v5
    v_cvt_pk_bf16_f32 v248, v240, v243
    v_accvgpr_read_b32 v240, a74
    v_mfma_f32_32x32x16_bf16 v[224:239], a[24:27], v[32:35], v[224:239]
    s_waitcnt lgkmcnt(4)
    ds_read_b64_tr_b16 a[8:9], v7 offset:33856
    ds_read_b64_tr_b16 a[10:11], v7 offset:34112
    v_accvgpr_read_b32 v243, a75
    v_mul_f32 v240, v242, v240
    v_mul_f32 v243, v242, v243
    v_cvt_pk_bf16_f32 v249, v240, v243
    v_accvgpr_read_b32 v240, a76
    v_mfma_f32_32x32x16_bf16 v[128:143], a[28:31], v[36:39], v[128:143]
    ds_read_b64_tr_b16 a[12:13], v7 offset:33888
    ds_read_b64_tr_b16 a[14:15], v7 offset:34144
    v_accvgpr_read_b32 v243, a77
    v_mul_f32 v240, v242, v240
    v_mul_f32 v243, v242, v243
    v_cvt_pk_bf16_f32 v250, v240, v243
    v_accvgpr_read_b32 v240, a78
    v_lshlrev_b32 v10, 16, v44
    v_mfma_f32_32x32x16_bf16 v[144:159], a[32:35], v[36:39], v[144:159]
    ds_read_b64_tr_b16 a[16:17], v7 offset:33920
    ds_read_b64_tr_b16 a[18:19], v7 offset:34176
    v_and_b32 v11, 0xffff0000, v44
    v_lshlrev_b32 v4, 16, v45
    v_and_b32 v5, 0xffff0000, v45
    v_fma_f32 v10, v10, v8, v9
    v_fma_f32 v11, v11, v8, v9
    v_fma_f32 v4, v4, v8, v9
    v_mfma_f32_32x32x16_bf16 v[160:175], a[36:39], v[36:39], v[160:175]
    ds_read_b64_tr_b16 a[20:21], v7 offset:33952
    ds_read_b64_tr_b16 a[22:23], v7 offset:34208
    v_fma_f32 v5, v5, v8, v9
    v_cvt_pk_bf16_f32 v44, v10, v11
    v_cvt_pk_bf16_f32 v45, v4, v5
    v_lshlrev_b32 v10, 16, v46
    v_and_b32 v11, 0xffff0000, v46
    v_lshlrev_b32 v4, 16, v47
    v_and_b32 v5, 0xffff0000, v47
    v_mfma_f32_32x32x16_bf16 v[176:191], a[40:43], v[36:39], v[176:191]
    ds_read_b64_tr_b16 a[24:25], v7 offset:33984
    ds_read_b64_tr_b16 a[26:27], v7 offset:34240
    v_fma_f32 v10, v10, v8, v9
    v_fma_f32 v11, v11, v8, v9
    v_fma_f32 v4, v4, v8, v9
    v_fma_f32 v5, v5, v8, v9
    v_cvt_pk_bf16_f32 v46, v10, v11
    v_cvt_pk_bf16_f32 v47, v4, v5
    v_mfma_f32_32x32x16_bf16 v[192:207], a[44:47], v[36:39], v[192:207]
    ds_read_b64_tr_b16 a[28:29], v7 offset:42240
    ds_read_b64_tr_b16 a[30:31], v7 offset:42496
    v_accvgpr_read_b32 v243, a79
    v_mul_f32 v240, v242, v240
    v_mul_f32 v243, v242, v243
    v_cvt_pk_bf16_f32 v251, v240, v243
    v_mfma_f32_32x32x16_bf16 v[208:223], a[48:51], v[36:39], v[208:223]
    ds_read_b64_tr_b16 a[32:33], v7 offset:42272
    ds_read_b64_tr_b16 a[34:35], v7 offset:42528
    s_cmp_ge_u32 s45, 14
    s_cselect_b32 s51, -1, 0
    s_mov_b32 s50, 0
    s_cmp_eq_u32 s45, 15
    s_cselect_b32 s62, 0x3f80, 0
    v_mov_b32 v240, s62
    v_permlane32_swap_b32 v244, v246
    v_permlane32_swap_b32 v245, v247
    v_mfma_f32_32x32x16_bf16 v[224:239], a[52:55], v[36:39], v[224:239]
    s_waitcnt lgkmcnt(4)
    ds_read_b64_tr_b16 a[36:37], v7 offset:42304
    ds_read_b64_tr_b16 a[38:39], v7 offset:42560
    v_permlane32_swap_b32 v248, v250
    v_permlane32_swap_b32 v249, v251
    v_cndmask_b32 v250, v250, v240, s[50:51]
    v_cndmask_b32 v251, v251, 0, s[50:51]
    s_cmp_lg_u32 s45, 15
    s_cbranch_scc1 L_notv
    v_and_b32 v240, 31, v1
    v_lshrrev_b32 v243, 5, v1
    v_lshlrev_b32 v240, 6, v240
    v_lshl_add_u32 v240, v243, 4, v240
    s_add_u32 s62, s56, 98304
    v_add_u32 v240, s62, v240
    ds_write_b128 v240, v[244:247] offset:0
    ds_write_b128 v240, v[248:251] offset:32
    v_lshlrev_b32 v243, 8, v243
    v_sub_u32 v240, v241, v243
    s_sub_u32 s62, s62, 114688
    v_add_u32 v240, s62, v240
    s_waitcnt lgkmcnt(0)
    ds_read_b64_tr_b16 v[244:245], v240 offset:0
    ds_read_b64_tr_b16 v[246:247], v240 offset:512
    ds_read_b64_tr_b16 v[248:249], v240 offset:1024
    ds_read_b64_tr_b16 v[250:251], v240 offset:1536
    s_waitcnt lgkmcnt(0)
L_notv:
    v_mfma_f32_32x32x16_bf16 v[128:143], a[0:3], v[40:43], v[128:143]
    s_waitcnt vmcnt(6)
    s_barrier
    ds_read_b64_tr_b16 a[40:41], v7 offset:42336
    ds_read_b64_tr_b16 a[42:43], v7 offset:42592
    s_add_u32 m0, s58, 92928
    s_add_u32 s54, s54, 57344
    buffer_load_dwordx4 v6, s[12:15], s54 offen lds
    v_mfma_f32_32x32x16_bf16 v[144:159], a[4:7], v[40:43], v[144:159]
    ds_read_b64_tr_b16 a[44:45], v7 offset:42368
    ds_read_b64_tr_b16 a[46:47], v7 offset:42624
    buffer_load_dwordx4 v6, s[16:19], s54 offen offset:1056 lds
    v_lshlrev_b32 v10, 16, v48
    v_and_b32 v11, 0xffff0000, v48
    v_lshlrev_b32 v4, 16, v49
    v_mfma_f32_32x32x16_bf16 v[160:175], a[8:11], v[40:43], v[160:175]
    ds_read_b64_tr_b16 a[48:49], v7 offset:42400
    ds_read_b64_tr_b16 a[50:51], v7 offset:42656
    buffer_store_dwordx4 v[244:247], v2, s[28:31], s53 offen offset:0 sc1
    v_and_b32 v5, 0xffff0000, v49
    v_fma_f32 v10, v10, v8, v9
    v_fma_f32 v11, v11, v8, v9
    v_mfma_f32_32x32x16_bf16 v[176:191], a[12:15], v[40:43], v[176:191]
    ds_read_b64_tr_b16 a[52:53], v7 offset:42432
    ds_read_b64_tr_b16 a[54:55], v7 offset:42688
    buffer_store_dwordx4 v[248:251], v2, s[28:31], s53 offen offset:1024 sc1
    v_fma_f32 v4, v4, v8, v9
    v_fma_f32 v5, v5, v8, v9
    v_mfma_f32_32x32x16_bf16 v[192:207], a[16:19], v[40:43], v[192:207]
    ds_read_b64_tr_b16 a[0:1], v7 offset:50688
    ds_read_b64_tr_b16 a[2:3], v7 offset:50944
    s_add_u32 m0, s58, 101376
    s_add_u32 s54, s54, 57344
    buffer_load_dwordx4 v6, s[12:15], s54 offen lds
    v_cvt_pk_bf16_f32 v48, v10, v11
    v_mfma_f32_32x32x16_bf16 v[208:223], a[20:23], v[40:43], v[208:223]
    ds_read_b64_tr_b16 a[4:5], v7 offset:50720
    ds_read_b64_tr_b16 a[6:7], v7 offset:50976
    buffer_load_dwordx4 v6, s[16:19], s54 offen offset:1056 lds
    v_cvt_pk_bf16_f32 v49, v4, v5
    v_lshlrev_b32 v10, 16, v50
    v_and_b32 v11, 0xffff0000, v50
    v_mfma_f32_32x32x16_bf16 v[224:239], a[24:27], v[40:43], v[224:239]
    s_waitcnt lgkmcnt(4)
    ds_read_b64_tr_b16 a[8:9], v7 offset:50752
    ds_read_b64_tr_b16 a[10:11], v7 offset:51008
    v_lshlrev_b32 v4, 16, v51
    v_and_b32 v5, 0xffff0000, v51
    v_fma_f32 v10, v10, v8, v9
    v_fma_f32 v11, v11, v8, v9
    v_mfma_f32_32x32x16_bf16 v[128:143], a[28:31], v[44:47], v[128:143]
    ds_read_b64_tr_b16 a[12:13], v7 offset:50784
    ds_read_b64_tr_b16 a[14:15], v7 offset:51040
    s_add_u32 m0, s58, 109824
    s_add_u32 s54, s54, 57344
    buffer_load_dwordx4 v6, s[12:15], s54 offen lds
    v_mfma_f32_32x32x16_bf16 v[144:159], a[32:35], v[44:47], v[144:159]
    ds_read_b64_tr_b16 a[16:17], v7 offset:50816
    ds_read_b64_tr_b16 a[18:19], v7 offset:51072
    buffer_load_dwordx4 v6, s[16:19], s54 offen offset:1056 lds
    v_fma_f32 v4, v4, v8, v9
    v_fma_f32 v5, v5, v8, v9
    v_cvt_pk_bf16_f32 v50, v10, v11
    v_mfma_f32_32x32x16_bf16 v[160:175], a[36:39], v[44:47], v[160:175]
    ds_read_b64_tr_b16 a[20:21], v7 offset:50848
    ds_read_b64_tr_b16 a[22:23], v7 offset:51104
    v_cvt_pk_bf16_f32 v51, v4, v5
    v_lshlrev_b32 v10, 16, v52
    v_and_b32 v11, 0xffff0000, v52
    v_lshlrev_b32 v4, 16, v53
    v_and_b32 v5, 0xffff0000, v53
    v_mfma_f32_32x32x16_bf16 v[176:191], a[40:43], v[44:47], v[176:191]
    ds_read_b64_tr_b16 a[24:25], v7 offset:50880
    ds_read_b64_tr_b16 a[26:27], v7 offset:51136
    v_fma_f32 v10, v10, v8, v9
    v_fma_f32 v11, v11, v8, v9
    v_fma_f32 v4, v4, v8, v9
    v_fma_f32 v5, v5, v8, v9
    v_cvt_pk_bf16_f32 v52, v10, v11
    v_mfma_f32_32x32x16_bf16 v[192:207], a[44:47], v[44:47], v[192:207]
    ds_read_b64_tr_b16 a[28:29], v7 offset:59136
    ds_read_b64_tr_b16 a[30:31], v7 offset:59392
    v_cvt_pk_bf16_f32 v53, v4, v5
    v_lshlrev_b32 v10, 16, v54
    v_and_b32 v11, 0xffff0000, v54
    v_lshlrev_b32 v4, 16, v55
    v_mfma_f32_32x32x16_bf16 v[208:223], a[48:51], v[44:47], v[208:223]
    ds_read_b64_tr_b16 a[32:33], v7 offset:59168
    ds_read_b64_tr_b16 a[34:35], v7 offset:59424
    v_and_b32 v5, 0xffff0000, v55
    v_fma_f32 v10, v10, v8, v9
    v_fma_f32 v11, v11, v8, v9
    v_fma_f32 v4, v4, v8, v9
    v_fma_f32 v5, v5, v8, v9
    v_mfma_f32_32x32x16_bf16 v[224:239], a[52:55], v[44:47], v[224:239]
    s_waitcnt lgkmcnt(4)
    ds_read_b64_tr_b16 a[36:37], v7 offset:59200
    ds_read_b64_tr_b16 a[38:39], v7 offset:59456
    v_cvt_pk_bf16_f32 v54, v10, v11
    v_cvt_pk_bf16_f32 v55, v4, v5
    v_mfma_f32_32x32x16_bf16 v[128:143], a[0:3], v[48:51], v[128:143]
    s_waitcnt vmcnt(10)
    s_barrier
    ds_read_b64_tr_b16 a[40:41], v7 offset:59232
    ds_read_b64_tr_b16 a[42:43], v7 offset:59488
    v_lshlrev_b32 v10, 16, v56
    v_mfma_f32_32x32x16_bf16 v[144:159], a[4:7], v[48:51], v[144:159]
    ds_read_b64_tr_b16 a[44:45], v7 offset:59264
    ds_read_b64_tr_b16 a[46:47], v7 offset:59520
    s_add_u32 m0, s58, 118272
    s_add_u32 s54, s54, 57344
    buffer_load_dwordx4 v6, s[12:15], s54 offen lds
    v_mfma_f32_32x32x16_bf16 v[160:175], a[8:11], v[48:51], v[160:175]
    ds_read_b64_tr_b16 a[48:49], v7 offset:59296
    ds_read_b64_tr_b16 a[50:51], v7 offset:59552
    buffer_load_dwordx4 v6, s[16:19], s54 offen offset:1056 lds
    v_and_b32 v11, 0xffff0000, v56
    v_lshlrev_b32 v4, 16, v57
    v_and_b32 v5, 0xffff0000, v57
    v_mfma_f32_32x32x16_bf16 v[176:191], a[12:15], v[48:51], v[176:191]
    ds_read_b64_tr_b16 a[52:53], v7 offset:59328
    ds_read_b64_tr_b16 a[54:55], v7 offset:59584
    s_add_u32 m0, s58, 126720
    s_add_u32 s54, s54, 57344
    buffer_load_dwordx4 v6, s[12:15], s54 offen lds
    v_mfma_f32_32x32x16_bf16 v[192:207], a[16:19], v[48:51], v[192:207]
    v_add_u32 v7, 0xe700, v7
    ds_read_b64_tr_b16 a[0:1], v7 offset:8448
    ds_read_b64_tr_b16 a[2:3], v7 offset:8704
    v_fma_f32 v10, v10, v8, v9
    v_fma_f32 v11, v11, v8, v9
    v_fma_f32 v4, v4, v8, v9
    v_fma_f32 v5, v5, v8, v9
    v_mfma_f32_32x32x16_bf16 v[208:223], a[20:23], v[48:51], v[208:223]
    ds_read_b64_tr_b16 a[4:5], v7 offset:8480
    ds_read_b64_tr_b16 a[6:7], v7 offset:8736
    buffer_load_dwordx4 v6, s[16:19], s54 offen offset:1056 lds
    v_cvt_pk_bf16_f32 v56, v10, v11
    v_cvt_pk_bf16_f32 v57, v4, v5
    v_mfma_f32_32x32x16_bf16 v[224:239], a[24:27], v[48:51], v[224:239]
    s_waitcnt lgkmcnt(4)
    ds_read_b64_tr_b16 a[8:9], v7 offset:8512
    ds_read_b64_tr_b16 a[10:11], v7 offset:8768
    v_lshlrev_b32 v10, 16, v58
    v_and_b32 v11, 0xffff0000, v58
    v_lshlrev_b32 v4, 16, v59
    v_and_b32 v5, 0xffff0000, v59
    v_mfma_f32_32x32x16_bf16 v[128:143], a[28:31], v[52:55], v[128:143]
    ds_read_b64_tr_b16 a[12:13], v7 offset:8544
    ds_read_b64_tr_b16 a[14:15], v7 offset:8800
    v_fma_f32 v10, v10, v8, v9
    v_fma_f32 v11, v11, v8, v9
    v_fma_f32 v4, v4, v8, v9
    v_fma_f32 v5, v5, v8, v9
    v_mfma_f32_32x32x16_bf16 v[144:159], a[32:35], v[52:55], v[144:159]
    ds_read_b64_tr_b16 a[16:17], v7 offset:8576
    ds_read_b64_tr_b16 a[18:19], v7 offset:8832
    v_cvt_pk_bf16_f32 v58, v10, v11
    v_cvt_pk_bf16_f32 v59, v4, v5
    v_lshlrev_b32 v10, 16, v60
    v_and_b32 v11, 0xffff0000, v60
    v_lshlrev_b32 v4, 16, v61
    v_mfma_f32_32x32x16_bf16 v[160:175], a[36:39], v[52:55], v[160:175]
    ds_read_b64_tr_b16 a[20:21], v7 offset:8608
    ds_read_b64_tr_b16 a[22:23], v7 offset:8864
    v_and_b32 v5, 0xffff0000, v61
    v_fma_f32 v10, v10, v8, v9
    v_fma_f32 v11, v11, v8, v9
    v_fma_f32 v4, v4, v8, v9
    v_mfma_f32_32x32x16_bf16 v[176:191], a[40:43], v[52:55], v[176:191]
    ds_read_b64_tr_b16 a[24:25], v7 offset:8640
    ds_read_b64_tr_b16 a[26:27], v7 offset:8896
    v_fma_f32 v5, v5, v8, v9
    v_cvt_pk_bf16_f32 v60, v10, v11
    v_cvt_pk_bf16_f32 v61, v4, v5
    v_lshlrev_b32 v10, 16, v62
    v_and_b32 v11, 0xffff0000, v62
    v_mfma_f32_32x32x16_bf16 v[192:207], a[44:47], v[52:55], v[192:207]
    ds_read_b64_tr_b16 a[28:29], v7 offset:16896
    ds_read_b64_tr_b16 a[30:31], v7 offset:17152
    v_lshlrev_b32 v4, 16, v63
    v_and_b32 v5, 0xffff0000, v63
    v_fma_f32 v10, v10, v8, v9
    v_fma_f32 v11, v11, v8, v9
    v_mfma_f32_32x32x16_bf16 v[208:223], a[48:51], v[52:55], v[208:223]
    ds_read_b64_tr_b16 a[32:33], v7 offset:16928
    ds_read_b64_tr_b16 a[34:35], v7 offset:17184
    v_fma_f32 v4, v4, v8, v9
    v_fma_f32 v5, v5, v8, v9
    v_cvt_pk_bf16_f32 v62, v10, v11
    v_cvt_pk_bf16_f32 v63, v4, v5
    v_mov_b32 v240, s60
    v_mfma_f32_32x32x16_bf16 v[224:239], a[52:55], v[52:55], v[224:239]
    s_waitcnt lgkmcnt(4)
    ds_read_b64_tr_b16 a[36:37], v7 offset:16960
    ds_read_b64_tr_b16 a[38:39], v7 offset:17216
    v_mfma_f32_32x32x16_bf16 v[128:143], a[0:3], v[56:59], v[128:143]
    s_waitcnt vmcnt(10)
    s_barrier
    ds_read_b64_tr_b16 a[40:41], v7 offset:16992
    ds_read_b64_tr_b16 a[42:43], v7 offset:17248
    v_lshlrev_b32 v10, 16, v64
    v_mfma_f32_32x32x16_bf16 v[144:159], a[4:7], v[56:59], v[144:159]
    ds_read_b64_tr_b16 a[44:45], v7 offset:17024
    ds_read_b64_tr_b16 a[46:47], v7 offset:17280
    s_add_u32 m0, s58, 135168
    s_add_u32 s54, s54, 57344
    buffer_load_dwordx4 v6, s[12:15], s54 offen lds
    v_and_b32 v11, 0xffff0000, v64
    v_mfma_f32_32x32x16_bf16 v[160:175], a[8:11], v[56:59], v[160:175]
    ds_read_b64_tr_b16 a[48:49], v7 offset:17056
    ds_read_b64_tr_b16 a[50:51], v7 offset:17312
    buffer_load_dwordx4 v6, s[16:19], s54 offen offset:1056 lds
    v_lshlrev_b32 v4, 16, v65
    v_and_b32 v5, 0xffff0000, v65
    v_fma_f32 v10, v10, v8, v9
    v_mfma_f32_32x32x16_bf16 v[176:191], a[12:15], v[56:59], v[176:191]
    ds_read_b64_tr_b16 a[52:53], v7 offset:17088
    ds_read_b64_tr_b16 a[54:55], v7 offset:17344
    s_waitcnt vmcnt(10)
    s_add_u32 s61, s68, 0x10000
    buffer_store_dword v240, v3, s[28:31], s61 offen sc1
    v_fma_f32 v11, v11, v8, v9
    v_mfma_f32_32x32x16_bf16 v[192:207], a[16:19], v[56:59], v[192:207]
    ds_read_b64_tr_b16 a[0:1], v7 offset:25344
    ds_read_b64_tr_b16 a[2:3], v7 offset:25600
    s_add_u32 m0, s58, 143616
    s_add_u32 s54, s54, 57344
    buffer_load_dwordx4 v6, s[12:15], s54 offen lds
    v_fma_f32 v4, v4, v8, v9
    v_mfma_f32_32x32x16_bf16 v[208:223], a[20:23], v[56:59], v[208:223]
    ds_read_b64_tr_b16 a[4:5], v7 offset:25376
    ds_read_b64_tr_b16 a[6:7], v7 offset:25632
    buffer_load_dwordx4 v6, s[16:19], s54 offen offset:1056 lds
    v_fma_f32 v5, v5, v8, v9
    v_cvt_pk_bf16_f32 v64, v10, v11
    v_cvt_pk_bf16_f32 v65, v4, v5
    v_mfma_f32_32x32x16_bf16 v[224:239], a[24:27], v[56:59], v[224:239]
    s_waitcnt lgkmcnt(4)
    ds_read_b64_tr_b16 a[8:9], v7 offset:25408
    ds_read_b64_tr_b16 a[10:11], v7 offset:25664
    v_lshlrev_b32 v10, 16, v66
    v_and_b32 v11, 0xffff0000, v66
    v_lshlrev_b32 v4, 16, v67
    v_and_b32 v5, 0xffff0000, v67
    v_mfma_f32_32x32x16_bf16 v[128:143], a[28:31], v[60:63], v[128:143]
    ds_read_b64_tr_b16 a[12:13], v7 offset:25440
    ds_read_b64_tr_b16 a[14:15], v7 offset:25696
    s_add_u32 m0, s58, 152064
    s_add_u32 s54, s54, 57344
    buffer_load_dwordx4 v6, s[12:15], s54 offen lds
    v_fma_f32 v10, v10, v8, v9
    v_mfma_f32_32x32x16_bf16 v[144:159], a[32:35], v[60:63], v[144:159]
    ds_read_b64_tr_b16 a[16:17], v7 offset:25472
    ds_read_b64_tr_b16 a[18:19], v7 offset:25728
    buffer_load_dwordx4 v6, s[16:19], s54 offen offset:1056 lds
    v_fma_f32 v11, v11, v8, v9
    v_fma_f32 v4, v4, v8, v9
    v_fma_f32 v5, v5, v8, v9
    v_mfma_f32_32x32x16_bf16 v[160:175], a[36:39], v[60:63], v[160:175]
    ds_read_b64_tr_b16 a[20:21], v7 offset:25504
    ds_read_b64_tr_b16 a[22:23], v7 offset:25760
    v_cvt_pk_bf16_f32 v66, v10, v11
    v_cvt_pk_bf16_f32 v67, v4, v5
    v_lshlrev_b32 v10, 16, v68
    v_and_b32 v11, 0xffff0000, v68
    v_lshlrev_b32 v4, 16, v69
    v_mfma_f32_32x32x16_bf16 v[176:191], a[40:43], v[60:63], v[176:191]
    ds_read_b64_tr_b16 a[24:25], v7 offset:25536
    ds_read_b64_tr_b16 a[26:27], v7 offset:25792
    v_and_b32 v5, 0xffff0000, v69
    v_fma_f32 v10, v10, v8, v9
    v_fma_f32 v11, v11, v8, v9
    v_fma_f32 v4, v4, v8, v9
    v_fma_f32 v5, v5, v8, v9
    v_mfma_f32_32x32x16_bf16 v[192:207], a[44:47], v[60:63], v[192:207]
    ds_read_b64_tr_b16 a[28:29], v7 offset:33792
    ds_read_b64_tr_b16 a[30:31], v7 offset:34048
    v_cvt_pk_bf16_f32 v68, v10, v11
    v_cvt_pk_bf16_f32 v69, v4, v5
    v_lshlrev_b32 v10, 16, v70
    v_and_b32 v11, 0xffff0000, v70
    v_lshlrev_b32 v4, 16, v71
    v_mfma_f32_32x32x16_bf16 v[208:223], a[48:51], v[60:63], v[208:223]
    ds_read_b64_tr_b16 a[32:33], v7 offset:33824
    ds_read_b64_tr_b16 a[34:35], v7 offset:34080
    v_and_b32 v5, 0xffff0000, v71
    v_fma_f32 v10, v10, v8, v9
    v_fma_f32 v11, v11, v8, v9
    v_fma_f32 v4, v4, v8, v9
    v_fma_f32 v5, v5, v8, v9
    v_mfma_f32_32x32x16_bf16 v[224:239], a[52:55], v[60:63], v[224:239]
    s_waitcnt lgkmcnt(4)
    ds_read_b64_tr_b16 a[36:37], v7 offset:33856
    ds_read_b64_tr_b16 a[38:39], v7 offset:34112
    v_cvt_pk_bf16_f32 v70, v10, v11
    v_cvt_pk_bf16_f32 v71, v4, v5
    v_mfma_f32_32x32x16_bf16 v[128:143], a[0:3], v[64:67], v[128:143]
    s_waitcnt vmcnt(11)
    s_barrier
    ds_read_b64_tr_b16 a[40:41], v7 offset:33888
    ds_read_b64_tr_b16 a[42:43], v7 offset:34144
    v_mfma_f32_32x32x16_bf16 v[144:159], a[4:7], v[64:67], v[144:159]
    ds_read_b64_tr_b16 a[44:45], v7 offset:33920
    ds_read_b64_tr_b16 a[46:47], v7 offset:34176
    s_add_u32 m0, s58, 0
    s_add_u32 s54, s54, 57344
    buffer_load_dwordx4 v6, s[12:15], s54 offen lds
    v_lshlrev_b32 v10, 16, v72
    v_mfma_f32_32x32x16_bf16 v[160:175], a[8:11], v[64:67], v[160:175]
    ds_read_b64_tr_b16 a[48:49], v7 offset:33952
    ds_read_b64_tr_b16 a[50:51], v7 offset:34208
    buffer_load_dwordx4 v6, s[16:19], s54 offen offset:1056 lds
    v_and_b32 v11, 0xffff0000, v72
    v_lshlrev_b32 v4, 16, v73
    v_mfma_f32_32x32x16_bf16 v[176:191], a[12:15], v[64:67], v[176:191]
    ds_read_b64_tr_b16 a[52:53], v7 offset:33984
    ds_read_b64_tr_b16 a[54:55], v7 offset:34240
    s_add_u32 m0, s58, 8448
    s_add_u32 s54, s54, 57344
    buffer_load_dwordx4 v6, s[12:15], s54 offen lds
    v_mfma_f32_32x32x16_bf16 v[192:207], a[16:19], v[64:67], v[192:207]
    ds_read_b64_tr_b16 a[0:1], v7 offset:42240
    ds_read_b64_tr_b16 a[2:3], v7 offset:42496
    buffer_load_dwordx4 v6, s[16:19], s54 offen offset:1056 lds
    v_and_b32 v5, 0xffff0000, v73
    v_fma_f32 v10, v10, v8, v9
    v_mfma_f32_32x32x16_bf16 v[208:223], a[20:23], v[64:67], v[208:223]
    ds_read_b64_tr_b16 a[4:5], v7 offset:42272
    ds_read_b64_tr_b16 a[6:7], v7 offset:42528
    v_fma_f32 v11, v11, v8, v9
    v_fma_f32 v4, v4, v8, v9
    v_fma_f32 v5, v5, v8, v9
    v_cvt_pk_bf16_f32 v72, v10, v11
    v_cvt_pk_bf16_f32 v73, v4, v5
    v_mfma_f32_32x32x16_bf16 v[224:239], a[24:27], v[64:67], v[224:239]
    s_waitcnt lgkmcnt(4)
    ds_read_b64_tr_b16 a[8:9], v7 offset:42304
    ds_read_b64_tr_b16 a[10:11], v7 offset:42560
    v_lshlrev_b32 v10, 16, v74
    v_and_b32 v11, 0xffff0000, v74
    v_lshlrev_b32 v4, 16, v75
    v_mfma_f32_32x32x16_bf16 v[128:143], a[28:31], v[68:71], v[128:143]
    ds_read_b64_tr_b16 a[12:13], v7 offset:42336
    ds_read_b64_tr_b16 a[14:15], v7 offset:42592
    v_and_b32 v5, 0xffff0000, v75
    v_fma_f32 v10, v10, v8, v9
    v_fma_f32 v11, v11, v8, v9
    v_fma_f32 v4, v4, v8, v9
    v_mfma_f32_32x32x16_bf16 v[144:159], a[32:35], v[68:71], v[144:159]
    ds_read_b64_tr_b16 a[16:17], v7 offset:42368
    ds_read_b64_tr_b16 a[18:19], v7 offset:42624
    v_fma_f32 v5, v5, v8, v9
    v_cvt_pk_bf16_f32 v74, v10, v11
    v_cvt_pk_bf16_f32 v75, v4, v5
    v_lshlrev_b32 v10, 16, v76
    v_mfma_f32_32x32x16_bf16 v[160:175], a[36:39], v[68:71], v[160:175]
    ds_read_b64_tr_b16 a[20:21], v7 offset:42400
    ds_read_b64_tr_b16 a[22:23], v7 offset:42656
    v_and_b32 v11, 0xffff0000, v76
    v_lshlrev_b32 v4, 16, v77
    v_and_b32 v5, 0xffff0000, v77
    v_fma_f32 v10, v10, v8, v9
    v_fma_f32 v11, v11, v8, v9
    v_mfma_f32_32x32x16_bf16 v[176:191], a[40:43], v[68:71], v[176:191]
    ds_read_b64_tr_b16 a[24:25], v7 offset:42432
    ds_read_b64_tr_b16 a[26:27], v7 offset:42688
    v_fma_f32 v4, v4, v8, v9
    v_fma_f32 v5, v5, v8, v9
    v_cvt_pk_bf16_f32 v76, v10, v11
    v_cvt_pk_bf16_f32 v77, v4, v5
    v_mfma_f32_32x32x16_bf16 v[192:207], a[44:47], v[68:71], v[192:207]
    ds_read_b64_tr_b16 a[28:29], v7 offset:50688
    ds_read_b64_tr_b16 a[30:31], v7 offset:50944
    v_lshlrev_b32 v10, 16, v78
    v_and_b32 v11, 0xffff0000, v78
    v_lshlrev_b32 v4, 16, v79
    v_and_b32 v5, 0xffff0000, v79
    v_mfma_f32_32x32x16_bf16 v[208:223], a[48:51], v[68:71], v[208:223]
    ds_read_b64_tr_b16 a[32:33], v7 offset:50720
    ds_read_b64_tr_b16 a[34:35], v7 offset:50976
    v_fma_f32 v10, v10, v8, v9
    v_fma_f32 v11, v11, v8, v9
    v_fma_f32 v4, v4, v8, v9
    v_fma_f32 v5, v5, v8, v9
    v_mfma_f32_32x32x16_bf16 v[224:239], a[52:55], v[68:71], v[224:239]
    s_waitcnt lgkmcnt(4)
    ds_read_b64_tr_b16 a[36:37], v7 offset:50752
    ds_read_b64_tr_b16 a[38:39], v7 offset:51008
    v_cvt_pk_bf16_f32 v78, v10, v11
    v_cvt_pk_bf16_f32 v79, v4, v5
    v_mfma_f32_32x32x16_bf16 v[128:143], a[0:3], v[72:75], v[128:143]
    s_waitcnt vmcnt(11)
    s_barrier
    ds_read_b64_tr_b16 a[40:41], v7 offset:50784
    ds_read_b64_tr_b16 a[42:43], v7 offset:51040
    s_add_u32 m0, s58, 16896
    s_add_u32 s54, s54, 57344
    buffer_load_dwordx4 v6, s[12:15], s54 offen lds
    v_mfma_f32_32x32x16_bf16 v[144:159], a[4:7], v[72:75], v[144:159]
    ds_read_b64_tr_b16 a[44:45], v7 offset:50816
    ds_read_b64_tr_b16 a[46:47], v7 offset:51072
    buffer_load_dwordx4 v6, s[16:19], s54 offen offset:1056 lds
    v_lshlrev_b32 v10, 16, v80
    v_and_b32 v11, 0xffff0000, v80
    v_lshlrev_b32 v4, 16, v81
    v_mfma_f32_32x32x16_bf16 v[160:175], a[8:11], v[72:75], v[160:175]
    ds_read_b64_tr_b16 a[48:49], v7 offset:50848
    ds_read_b64_tr_b16 a[50:51], v7 offset:51104
    s_mov_b32 s48, 0x40053526
    v_and_b32 v5, 0xffff0000, v81
    v_fma_f32 v10, v10, v8, v9
    v_fma_f32 v11, v11, v8, v9
    v_fma_f32 v4, v4, v8, v9
    v_fma_f32 v5, v5, v8, v9
    v_mfma_f32_32x32x16_bf16 v[176:191], a[12:15], v[72:75], v[176:191]
    ds_read_b64_tr_b16 a[52:53], v7 offset:50880
    ds_read_b64_tr_b16 a[54:55], v7 offset:51136
    s_mov_b32 s49, s48
    v_cvt_pk_bf16_f32 v80, v10, v11
    v_cvt_pk_bf16_f32 v81, v4, v5
    v_lshlrev_b32 v10, 16, v82
    v_and_b32 v11, 0xffff0000, v82
    v_mfma_f32_32x32x16_bf16 v[192:207], a[16:19], v[72:75], v[192:207]
    ds_read_b64_tr_b16 a[0:1], v7 offset:59136
    ds_read_b64_tr_b16 a[2:3], v7 offset:59392
    s_cmp_lt_u32 s45, 14
    s_cselect_b32 s83, s60, 0
    v_lshlrev_b32 v4, 16, v83
    v_and_b32 v5, 0xffff0000, v83
    v_fma_f32 v10, v10, v8, v9
    v_mfma_f32_32x32x16_bf16 v[208:223], a[20:23], v[72:75], v[208:223]
    ds_read_b64_tr_b16 a[4:5], v7 offset:59168
    ds_read_b64_tr_b16 a[6:7], v7 offset:59424
    s_add_u32 m0, s58, 25344
    s_add_u32 s54, s54, 57344
    buffer_load_dwordx4 v6, s[12:15], s54 offen lds
    v_fma_f32 v11, v11, v8, v9
    v_mfma_f32_32x32x16_bf16 v[224:239], a[24:27], v[72:75], v[224:239]
    s_waitcnt lgkmcnt(4)
    ds_read_b64_tr_b16 a[8:9], v7 offset:59200
    ds_read_b64_tr_b16 a[10:11], v7 offset:59456
    v_fma_f32 v4, v4, v8, v9
    v_fma_f32 v5, v5, v8, v9
    v_cvt_pk_bf16_f32 v82, v10, v11
    v_cvt_pk_bf16_f32 v83, v4, v5
    v_lshlrev_b32 v10, 16, v84
    v_mfma_f32_32x32x16_bf16 v[128:143], a[28:31], v[76:79], v[128:143]
    ds_read_b64_tr_b16 a[12:13], v7 offset:59232
    ds_read_b64_tr_b16 a[14:15], v7 offset:59488
    buffer_load_dwordx4 v6, s[16:19], s54 offen offset:1056 lds
    v_and_b32 v11, 0xffff0000, v84
    v_lshlrev_b32 v4, 16, v85
    v_and_b32 v5, 0xffff0000, v85
    v_mfma_f32_32x32x16_bf16 v[144:159], a[32:35], v[76:79], v[144:159]
    ds_read_b64_tr_b16 a[16:17], v7 offset:59264
    ds_read_b64_tr_b16 a[18:19], v7 offset:59520
    s_add_u32 m0, s58, 33792
    s_add_u32 s54, s54, 57344
    buffer_load_dwordx4 v6, s[12:15], s54 offen lds
    v_fma_f32 v10, v10, v8, v9
    v_mfma_f32_32x32x16_bf16 v[160:175], a[36:39], v[76:79], v[160:175]
    ds_read_b64_tr_b16 a[20:21], v7 offset:59296
    ds_read_b64_tr_b16 a[22:23], v7 offset:59552
    buffer_load_dwordx4 v6, s[16:19], s54 offen offset:1056 lds
    v_fma_f32 v11, v11, v8, v9
    v_fma_f32 v4, v4, v8, v9
    v_fma_f32 v5, v5, v8, v9
    v_mfma_f32_32x32x16_bf16 v[176:191], a[40:43], v[76:79], v[176:191]
    ds_read_b64_tr_b16 a[24:25], v7 offset:59328
    ds_read_b64_tr_b16 a[26:27], v7 offset:59584
    v_cvt_pk_bf16_f32 v84, v10, v11
    v_cvt_pk_bf16_f32 v85, v4, v5
    v_lshlrev_b32 v10, 16, v86
    v_and_b32 v11, 0xffff0000, v86
    v_lshlrev_b32 v4, 16, v87
    v_and_b32 v5, 0xffff0000, v87
    v_mfma_f32_32x32x16_bf16 v[192:207], a[44:47], v[76:79], v[192:207]
    v_add_u32 v7, 0xe700, v7
    ds_read_b64_tr_b16 a[28:29], v7 offset:8448
    ds_read_b64_tr_b16 a[30:31], v7 offset:8704
    v_fma_f32 v10, v10, v8, v9
    v_fma_f32 v11, v11, v8, v9
    v_fma_f32 v4, v4, v8, v9
    v_fma_f32 v5, v5, v8, v9
    v_mfma_f32_32x32x16_bf16 v[208:223], a[48:51], v[76:79], v[208:223]
    ds_read_b64_tr_b16 a[32:33], v7 offset:8480
    ds_read_b64_tr_b16 a[34:35], v7 offset:8736
    v_cvt_pk_bf16_f32 v86, v10, v11
    v_cvt_pk_bf16_f32 v87, v4, v5
    s_mul_i32 s65, s67, 14
    v_min_u32 v20, 13, v1
    v_add_lshl_u32 v20, v20, s65, 7
    v_mfma_f32_32x32x16_bf16 v[224:239], a[52:55], v[76:79], v[224:239]
    s_waitcnt lgkmcnt(4)
    ds_read_b64_tr_b16 a[36:37], v7 offset:8512
    ds_read_b64_tr_b16 a[38:39], v7 offset:8768
    s_mul_i32 s65, s67, 4
    v_min_u32 v21, 3, v1
    v_add_lshl_u32 v21, v21, s65, 7
    v_mfma_f32_32x32x16_bf16 v[128:143], a[0:3], v[80:83], v[128:143]
    s_waitcnt vmcnt(12)
    s_barrier
    ds_read_b64_tr_b16 a[40:41], v7 offset:8544
    ds_read_b64_tr_b16 a[42:43], v7 offset:8800
    v_lshlrev_b32 v10, 16, v88
    v_mfma_f32_32x32x16_bf16 v[144:159], a[4:7], v[80:83], v[144:159]
    ds_read_b64_tr_b16 a[44:45], v7 offset:8576
    ds_read_b64_tr_b16 a[46:47], v7 offset:8832
    s_add_u32 m0, s58, 42240
    s_add_u32 s54, s54, 57344
    buffer_load_dwordx4 v6, s[12:15], s54 offen lds
    v_and_b32 v11, 0xffff0000, v88
    v_mfma_f32_32x32x16_bf16 v[160:175], a[8:11], v[80:83], v[160:175]
    ds_read_b64_tr_b16 a[48:49], v7 offset:8608
    ds_read_b64_tr_b16 a[50:51], v7 offset:8864
    buffer_load_dwordx4 v6, s[16:19], s54 offen offset:1056 lds
    v_lshlrev_b32 v4, 16, v89
    v_and_b32 v5, 0xffff0000, v89
    v_mfma_f32_32x32x16_bf16 v[176:191], a[12:15], v[80:83], v[176:191]
    ds_read_b64_tr_b16 a[52:53], v7 offset:8640
    ds_read_b64_tr_b16 a[54:55], v7 offset:8896
    buffer_load_dword v20, v20, s[20:23], 0 offen
    v_fma_f32 v10, v10, v8, v9
    v_fma_f32 v11, v11, v8, v9
    v_fma_f32 v4, v4, v8, v9
    v_mfma_f32_32x32x16_bf16 v[192:207], a[16:19], v[80:83], v[192:207]
    ds_read_b64_tr_b16 a[0:1], v7 offset:16896
    ds_read_b64_tr_b16 a[2:3], v7 offset:17152
    buffer_load_dword v21, v21, s[24:27], 0 offen
    v_fma_f32 v5, v5, v8, v9
    v_cvt_pk_bf16_f32 v88, v10, v11
    v_cvt_pk_bf16_f32 v89, v4, v5
    v_mfma_f32_32x32x16_bf16 v[208:223], a[20:23], v[80:83], v[208:223]
    ds_read_b64_tr_b16 a[4:5], v7 offset:16928
    ds_read_b64_tr_b16 a[6:7], v7 offset:17184
    s_add_u32 m0, s58, 50688
    s_add_u32 s54, s54, 57344
    buffer_load_dwordx4 v6, s[12:15], s54 offen lds
    v_lshlrev_b32 v10, 16, v90
    v_mfma_f32_32x32x16_bf16 v[224:239], a[24:27], v[80:83], v[224:239]
    s_waitcnt lgkmcnt(4)
    ds_read_b64_tr_b16 a[8:9], v7 offset:16960
    ds_read_b64_tr_b16 a[10:11], v7 offset:17216
    v_and_b32 v11, 0xffff0000, v90
    v_lshlrev_b32 v4, 16, v91
    v_and_b32 v5, 0xffff0000, v91
    v_mfma_f32_32x32x16_bf16 v[128:143], a[28:31], v[84:87], v[128:143]
    ds_read_b64_tr_b16 a[12:13], v7 offset:16992
    ds_read_b64_tr_b16 a[14:15], v7 offset:17248
    buffer_load_dwordx4 v6, s[16:19], s54 offen offset:1056 lds
    v_fma_f32 v10, v10, v8, v9
    v_fma_f32 v11, v11, v8, v9
    v_fma_f32 v4, v4, v8, v9
    v_mfma_f32_32x32x16_bf16 v[144:159], a[32:35], v[84:87], v[144:159]
    ds_read_b64_tr_b16 a[16:17], v7 offset:17024
    ds_read_b64_tr_b16 a[18:19], v7 offset:17280
    v_fma_f32 v5, v5, v8, v9
    v_cvt_pk_bf16_f32 v90, v10, v11
    v_cvt_pk_bf16_f32 v91, v4, v5
    v_lshlrev_b32 v10, 16, v92
    v_and_b32 v11, 0xffff0000, v92
    v_mfma_f32_32x32x16_bf16 v[160:175], a[36:39], v[84:87], v[160:175]
    ds_read_b64_tr_b16 a[20:21], v7 offset:17056
    ds_read_b64_tr_b16 a[22:23], v7 offset:17312
    v_lshlrev_b32 v4, 16, v93
    v_and_b32 v5, 0xffff0000, v93
    v_fma_f32 v10, v10, v8, v9
    v_fma_f32 v11, v11, v8, v9
    v_fma_f32 v4, v4, v8, v9
    v_mfma_f32_32x32x16_bf16 v[176:191], a[40:43], v[84:87], v[176:191]
    ds_read_b64_tr_b16 a[24:25], v7 offset:17088
    ds_read_b64_tr_b16 a[26:27], v7 offset:17344
    v_fma_f32 v5, v5, v8, v9
    v_cvt_pk_bf16_f32 v92, v10, v11
    v_cvt_pk_bf16_f32 v93, v4, v5
    v_lshlrev_b32 v10, 16, v94
    v_mfma_f32_32x32x16_bf16 v[192:207], a[44:47], v[84:87], v[192:207]
    ds_read_b64_tr_b16 a[28:29], v7 offset:25344
    ds_read_b64_tr_b16 a[30:31], v7 offset:25600
    v_and_b32 v11, 0xffff0000, v94
    v_lshlrev_b32 v4, 16, v95
    v_and_b32 v5, 0xffff0000, v95
    v_fma_f32 v10, v10, v8, v9
    v_fma_f32 v11, v11, v8, v9
    v_mfma_f32_32x32x16_bf16 v[208:223], a[48:51], v[84:87], v[208:223]
    ds_read_b64_tr_b16 a[32:33], v7 offset:25376
    ds_read_b64_tr_b16 a[34:35], v7 offset:25632
    v_fma_f32 v4, v4, v8, v9
    v_fma_f32 v5, v5, v8, v9
    v_cvt_pk_bf16_f32 v94, v10, v11
    v_cvt_pk_bf16_f32 v95, v4, v5
    v_mov_b32 v16, -1
    v_mfma_f32_32x32x16_bf16 v[224:239], a[52:55], v[84:87], v[224:239]
    s_waitcnt lgkmcnt(4)
    ds_read_b64_tr_b16 a[36:37], v7 offset:25408
    ds_read_b64_tr_b16 a[38:39], v7 offset:25664
    v_mov_b32 v17, -1
    v_mov_b32 v18, -1
    v_mov_b32 v19, -1
    v_mfma_f32_32x32x16_bf16 v[128:143], a[0:3], v[88:91], v[128:143]
    s_waitcnt vmcnt(14)
    s_barrier
    ds_read_b64_tr_b16 a[40:41], v7 offset:25440
    ds_read_b64_tr_b16 a[42:43], v7 offset:25696
    v_mfma_f32_32x32x16_bf16 v[144:159], a[4:7], v[88:91], v[144:159]
    ds_read_b64_tr_b16 a[44:45], v7 offset:25472
    ds_read_b64_tr_b16 a[46:47], v7 offset:25728
    buffer_load_dword v12, v0, s[28:31], 0 offen sc1
    v_lshlrev_b32 v10, 16, v96
    v_and_b32 v11, 0xffff0000, v96
    v_mfma_f32_32x32x16_bf16 v[160:175], a[8:11], v[88:91], v[160:175]
    ds_read_b64_tr_b16 a[48:49], v7 offset:25504
    ds_read_b64_tr_b16 a[50:51], v7 offset:25760
    buffer_store_dwordx4 v[16:19], v2, s[28:31], s75 offen offset:0 sc1
    v_lshlrev_b32 v4, 16, v97
    v_and_b32 v5, 0xffff0000, v97
    v_mfma_f32_32x32x16_bf16 v[176:191], a[12:15], v[88:91], v[176:191]
    ds_read_b64_tr_b16 a[52:53], v7 offset:25536
    ds_read_b64_tr_b16 a[54:55], v7 offset:25792
    buffer_store_dwordx4 v[16:19], v2, s[28:31], s75 offen offset:1024 sc1
    v_fma_f32 v10, v10, v8, v9
    v_fma_f32 v11, v11, v8, v9
    v_mfma_f32_32x32x16_bf16 v[192:207], a[16:19], v[88:91], v[192:207]
    ds_read_b64_tr_b16 a[0:1], v7 offset:33792
    ds_read_b64_tr_b16 a[2:3], v7 offset:34048
    v_fma_f32 v4, v4, v8, v9
    v_fma_f32 v5, v5, v8, v9
    v_cvt_pk_bf16_f32 v96, v10, v11
    v_cvt_pk_bf16_f32 v97, v4, v5
    v_mfma_f32_32x32x16_bf16 v[208:223], a[20:23], v[88:91], v[208:223]
    ds_read_b64_tr_b16 a[4:5], v7 offset:33824
    ds_read_b64_tr_b16 a[6:7], v7 offset:34080
    v_lshlrev_b32 v10, 16, v98
    v_and_b32 v11, 0xffff0000, v98
    v_lshlrev_b32 v4, 16, v99
    v_and_b32 v5, 0xffff0000, v99
    v_mfma_f32_32x32x16_bf16 v[224:239], a[24:27], v[88:91], v[224:239]
    s_waitcnt lgkmcnt(4)
    ds_read_b64_tr_b16 a[8:9], v7 offset:33856
    ds_read_b64_tr_b16 a[10:11], v7 offset:34112
    v_fma_f32 v10, v10, v8, v9
    v_fma_f32 v11, v11, v8, v9
    v_fma_f32 v4, v4, v8, v9
    v_mfma_f32_32x32x16_bf16 v[128:143], a[28:31], v[92:95], v[128:143]
    ds_read_b64_tr_b16 a[12:13], v7 offset:33888
    ds_read_b64_tr_b16 a[14:15], v7 offset:34144
    v_fma_f32 v5, v5, v8, v9
    v_cvt_pk_bf16_f32 v98, v10, v11
    v_cvt_pk_bf16_f32 v99, v4, v5
    v_lshlrev_b32 v10, 16, v100
    v_mfma_f32_32x32x16_bf16 v[144:159], a[32:35], v[92:95], v[144:159]
    ds_read_b64_tr_b16 a[16:17], v7 offset:33920
    ds_read_b64_tr_b16 a[18:19], v7 offset:34176
    v_and_b32 v11, 0xffff0000, v100
    v_lshlrev_b32 v4, 16, v101
    v_and_b32 v5, 0xffff0000, v101
    v_fma_f32 v10, v10, v8, v9
    v_mfma_f32_32x32x16_bf16 v[160:175], a[36:39], v[92:95], v[160:175]
    ds_read_b64_tr_b16 a[20:21], v7 offset:33952
    ds_read_b64_tr_b16 a[22:23], v7 offset:34208
    v_fma_f32 v11, v11, v8, v9
    v_fma_f32 v4, v4, v8, v9
    v_fma_f32 v5, v5, v8, v9
    v_cvt_pk_bf16_f32 v100, v10, v11
    v_mfma_f32_32x32x16_bf16 v[176:191], a[40:43], v[92:95], v[176:191]
    ds_read_b64_tr_b16 a[24:25], v7 offset:33984
    ds_read_b64_tr_b16 a[26:27], v7 offset:34240
    v_cvt_pk_bf16_f32 v101, v4, v5
    v_lshlrev_b32 v10, 16, v102
    v_and_b32 v11, 0xffff0000, v102
    v_lshlrev_b32 v4, 16, v103
    v_mfma_f32_32x32x16_bf16 v[192:207], a[44:47], v[92:95], v[192:207]
    v_add_u32 v7, 0xfffe3200, v7
    ds_read_b64_tr_b16 a[28:29], v7 offset:0
    ds_read_b64_tr_b16 a[30:31], v7 offset:256
    v_and_b32 v5, 0xffff0000, v103
    v_fma_f32 v10, v10, v8, v9
    v_fma_f32 v11, v11, v8, v9
    v_mfma_f32_32x32x16_bf16 v[208:223], a[48:51], v[92:95], v[208:223]
    ds_read_b64_tr_b16 a[32:33], v7 offset:32
    ds_read_b64_tr_b16 a[34:35], v7 offset:288
    v_fma_f32 v4, v4, v8, v9
    v_fma_f32 v5, v5, v8, v9
    v_cvt_pk_bf16_f32 v102, v10, v11
    v_cvt_pk_bf16_f32 v103, v4, v5
    v_mfma_f32_32x32x16_bf16 v[224:239], a[52:55], v[92:95], v[224:239]
    s_waitcnt lgkmcnt(4)
    ds_read_b64_tr_b16 a[36:37], v7 offset:64
    ds_read_b64_tr_b16 a[38:39], v7 offset:320
    v_mfma_f32_32x32x16_bf16 v[128:143], a[0:3], v[96:99], v[128:143]
    s_waitcnt vmcnt(13)
    s_barrier
    ds_read_b64_tr_b16 a[40:41], v7 offset:96
    ds_read_b64_tr_b16 a[42:43], v7 offset:352
    v_mfma_f32_32x32x16_bf16 v[144:159], a[4:7], v[96:99], v[144:159]
    ds_read_b64_tr_b16 a[44:45], v7 offset:128
    ds_read_b64_tr_b16 a[46:47], v7 offset:384
    v_lshlrev_b32 v10, 16, v104
    v_and_b32 v11, 0xffff0000, v104
    v_lshlrev_b32 v4, 16, v105
    v_and_b32 v5, 0xffff0000, v105
    v_mfma_f32_32x32x16_bf16 v[160:175], a[8:11], v[96:99], v[160:175]
    ds_read_b64_tr_b16 a[48:49], v7 offset:160
    ds_read_b64_tr_b16 a[50:51], v7 offset:416
    v_fma_f32 v10, v10, v8, v9
    v_fma_f32 v11, v11, v8, v9
    v_fma_f32 v4, v4, v8, v9
    v_fma_f32 v5, v5, v8, v9
    v_mfma_f32_32x32x16_bf16 v[176:191], a[12:15], v[96:99], v[176:191]
    ds_read_b64_tr_b16 a[52:53], v7 offset:192
    ds_read_b64_tr_b16 a[54:55], v7 offset:448
    v_cvt_pk_bf16_f32 v104, v10, v11
    v_cvt_pk_bf16_f32 v105, v4, v5
    v_lshlrev_b32 v10, 16, v106
    v_and_b32 v11, 0xffff0000, v106
    v_mfma_f32_32x32x16_bf16 v[192:207], a[16:19], v[96:99], v[192:207]
    ds_read_b64_tr_b16 a[0:1], v7 offset:8448
    ds_read_b64_tr_b16 a[2:3], v7 offset:8704
    v_lshlrev_b32 v4, 16, v107
    v_and_b32 v5, 0xffff0000, v107
    v_fma_f32 v10, v10, v8, v9
    v_fma_f32 v11, v11, v8, v9
    v_mfma_f32_32x32x16_bf16 v[208:223], a[20:23], v[96:99], v[208:223]
    ds_read_b64_tr_b16 a[4:5], v7 offset:8480
    ds_read_b64_tr_b16 a[6:7], v7 offset:8736
    v_fma_f32 v4, v4, v8, v9
    v_fma_f32 v5, v5, v8, v9
    v_cvt_pk_bf16_f32 v106, v10, v11
    v_cvt_pk_bf16_f32 v107, v4, v5
    v_mfma_f32_32x32x16_bf16 v[224:239], a[24:27], v[96:99], v[224:239]
    s_waitcnt lgkmcnt(4)
    ds_read_b64_tr_b16 a[8:9], v7 offset:8512
    ds_read_b64_tr_b16 a[10:11], v7 offset:8768
    v_lshlrev_b32 v10, 16, v108
    v_and_b32 v11, 0xffff0000, v108
    v_lshlrev_b32 v4, 16, v109
    v_mfma_f32_32x32x16_bf16 v[128:143], a[28:31], v[100:103], v[128:143]
    ds_read_b64_tr_b16 a[12:13], v7 offset:8544
    ds_read_b64_tr_b16 a[14:15], v7 offset:8800
    v_and_b32 v5, 0xffff0000, v109
    v_fma_f32 v10, v10, v8, v9
    v_fma_f32 v11, v11, v8, v9
    v_fma_f32 v4, v4, v8, v9
    v_mfma_f32_32x32x16_bf16 v[144:159], a[32:35], v[100:103], v[144:159]
    ds_read_b64_tr_b16 a[16:17], v7 offset:8576
    ds_read_b64_tr_b16 a[18:19], v7 offset:8832
    v_fma_f32 v5, v5, v8, v9
    v_cvt_pk_bf16_f32 v108, v10, v11
    v_cvt_pk_bf16_f32 v109, v4, v5
    v_lshlrev_b32 v10, 16, v110
    v_mfma_f32_32x32x16_bf16 v[160:175], a[36:39], v[100:103], v[160:175]
    ds_read_b64_tr_b16 a[20:21], v7 offset:8608
    ds_read_b64_tr_b16 a[22:23], v7 offset:8864
    v_and_b32 v11, 0xffff0000, v110
    v_lshlrev_b32 v4, 16, v111
    v_and_b32 v5, 0xffff0000, v111
    v_fma_f32 v10, v10, v8, v9
    v_mfma_f32_32x32x16_bf16 v[176:191], a[40:43], v[100:103], v[176:191]
    ds_read_b64_tr_b16 a[24:25], v7 offset:8640
    ds_read_b64_tr_b16 a[26:27], v7 offset:8896
    v_fma_f32 v11, v11, v8, v9
    v_fma_f32 v4, v4, v8, v9
    v_fma_f32 v5, v5, v8, v9
    v_cvt_pk_bf16_f32 v110, v10, v11
    v_mfma_f32_32x32x16_bf16 v[192:207], a[44:47], v[100:103], v[192:207]
    ds_read_b64_tr_b16 a[28:29], v7 offset:16896
    ds_read_b64_tr_b16 a[30:31], v7 offset:17152
    v_cvt_pk_bf16_f32 v111, v4, v5
    v_mfma_f32_32x32x16_bf16 v[208:223], a[48:51], v[100:103], v[208:223]
    ds_read_b64_tr_b16 a[32:33], v7 offset:16928
    ds_read_b64_tr_b16 a[34:35], v7 offset:17184
    v_mfma_f32_32x32x16_bf16 v[224:239], a[52:55], v[100:103], v[224:239]
    s_waitcnt lgkmcnt(4)
    ds_read_b64_tr_b16 a[36:37], v7 offset:16960
    ds_read_b64_tr_b16 a[38:39], v7 offset:17216
    s_waitcnt vmcnt(2)
    v_cmp_ne_u32 vcc, s60, v12
    s_nop 0
    s_cmp_eq_u64 vcc, 0
    s_cbranch_scc1 L_pq_ok
    s_mov_b32 s65, 32768
L_pq_lp:
    s_sleep 2
    buffer_load_dword v12, v0, s[28:31], 0 offen sc1
    s_waitcnt vmcnt(0)
    v_cmp_ne_u32 vcc, s60, v12
    s_nop 0
    s_cmp_eq_u64 vcc, 0
    s_cbranch_scc1 L_pq_ok
    s_sub_u32 s65, s65, 1
    s_cmp_lg_u32 s65, 0
    s_cbranch_scc1 L_pq_lp
L_pq_ok:
    v_mfma_f32_32x32x16_bf16 v[128:143], a[0:3], v[104:107], v[128:143]
    s_barrier
    ds_read_b64_tr_b16 a[40:41], v7 offset:16992
    ds_read_b64_tr_b16 a[42:43], v7 offset:17248
    buffer_load_dwordx4 a[128:131], v2, s[28:31], s70 offen offset:0 sc1
    v_mfma_f32_32x32x16_bf16 v[144:159], a[4:7], v[104:107], v[144:159]
    ds_read_b64_tr_b16 a[44:45], v7 offset:17024
    ds_read_b64_tr_b16 a[46:47], v7 offset:17280
    buffer_load_dwordx4 a[132:135], v2, s[28:31], s70 offen offset:1024 sc1
    v_lshlrev_b32 v10, 16, v112
    v_and_b32 v11, 0xffff0000, v112
    v_lshlrev_b32 v4, 16, v113
    v_mfma_f32_32x32x16_bf16 v[160:175], a[8:11], v[104:107], v[160:175]
    ds_read_b64_tr_b16 a[48:49], v7 offset:17056
    ds_read_b64_tr_b16 a[50:51], v7 offset:17312
    buffer_load_dwordx4 a[136:139], v2, s[28:31], s70 offen offset:2048 sc1
    v_and_b32 v5, 0xffff0000, v113
    v_fma_f32 v10, v10, v8, v9
    v_mfma_f32_32x32x16_bf16 v[176:191], a[12:15], v[104:107], v[176:191]
    ds_read_b64_tr_b16 a[52:53], v7 offset:17088
    ds_read_b64_tr_b16 a[54:55], v7 offset:17344
    buffer_load_dwordx4 a[140:143], v2, s[28:31], s70 offen offset:3072 sc1
    s_add_u32 s70, s70, 4096
    v_fma_f32 v11, v11, v8, v9
    v_fma_f32 v4, v4, v8, v9
    v_mfma_f32_32x32x16_bf16 v[192:207], a[16:19], v[104:107], v[192:207]
    ds_read_b64_tr_b16 a[0:1], v7 offset:25344
    ds_read_b64_tr_b16 a[2:3], v7 offset:25600
    buffer_load_dwordx2 a[96:97], v252, s[28:31], s76 offen offset:0 sc1
    v_fma_f32 v5, v5, v8, v9
    v_cvt_pk_bf16_f32 v112, v10, v11
    v_mfma_f32_32x32x16_bf16 v[208:223], a[20:23], v[104:107], v[208:223]
    ds_read_b64_tr_b16 a[4:5], v7 offset:25376
    ds_read_b64_tr_b16 a[6:7], v7 offset:25632
    buffer_load_dwordx2 a[98:99], v253, s[28:31], s76 offen offset:0 sc1
    v_cvt_pk_bf16_f32 v113, v4, v5
    v_lshlrev_b32 v10, 16, v114
    v_and_b32 v11, 0xffff0000, v114
    v_mfma_f32_32x32x16_bf16 v[224:239], a[24:27], v[104:107], v[224:239]
    s_waitcnt lgkmcnt(4)
    ds_read_b64_tr_b16 a[8:9], v7 offset:25408
    ds_read_b64_tr_b16 a[10:11], v7 offset:25664
    v_lshlrev_b32 v4, 16, v115
    v_and_b32 v5, 0xffff0000, v115
    v_fma_f32 v10, v10, v8, v9
    v_mfma_f32_32x32x16_bf16 v[128:143], a[28:31], v[108:111], v[128:143]
    ds_read_b64_tr_b16 a[12:13], v7 offset:25440
    ds_read_b64_tr_b16 a[14:15], v7 offset:25696
    buffer_load_dwordx2 a[100:101], v252, s[28:31], s76 offen offset:1024 sc1
    v_fma_f32 v11, v11, v8, v9
    v_fma_f32 v4, v4, v8, v9
    v_fma_f32 v5, v5, v8, v9
    v_mfma_f32_32x32x16_bf16 v[144:159], a[32:35], v[108:111], v[144:159]
    ds_read_b64_tr_b16 a[16:17], v7 offset:25472
    ds_read_b64_tr_b16 a[18:19], v7 offset:25728
    buffer_load_dwordx2 a[102:103], v254, s[28:31], s76 offen offset:1024 sc1
    v_cvt_pk_bf16_f32 v114, v10, v11
    v_cvt_pk_bf16_f32 v115, v4, v5
    v_mfma_f32_32x32x16_bf16 v[160:175], a[36:39], v[108:111], v[160:175]
    ds_read_b64_tr_b16 a[20:21], v7 offset:25504
    ds_read_b64_tr_b16 a[22:23], v7 offset:25760
    v_lshlrev_b32 v10, 16, v116
    v_and_b32 v11, 0xffff0000, v116
    v_lshlrev_b32 v4, 16, v117
    v_and_b32 v5, 0xffff0000, v117
    v_fma_f32 v10, v10, v8, v9
    v_mfma_f32_32x32x16_bf16 v[176:191], a[40:43], v[108:111], v[176:191]
    ds_read_b64_tr_b16 a[24:25], v7 offset:25536
    ds_read_b64_tr_b16 a[26:27], v7 offset:25792
    v_fma_f32 v11, v11, v8, v9
    v_fma_f32 v4, v4, v8, v9
    v_fma_f32 v5, v5, v8, v9
    v_cvt_pk_bf16_f32 v116, v10, v11
    v_mfma_f32_32x32x16_bf16 v[192:207], a[44:47], v[108:111], v[192:207]
    ds_read_b64_tr_b16 a[28:29], v7 offset:33792
    ds_read_b64_tr_b16 a[30:31], v7 offset:34048
    v_cvt_pk_bf16_f32 v117, v4, v5
    v_lshlrev_b32 v10, 16, v118
    v_and_b32 v11, 0xffff0000, v118
    v_lshlrev_b32 v4, 16, v119
    v_and_b32 v5, 0xffff0000, v119
    v_mfma_f32_32x32x16_bf16 v[208:223], a[48:51], v[108:111], v[208:223]
    ds_read_b64_tr_b16 a[32:33], v7 offset:33824
    ds_read_b64_tr_b16 a[34:35], v7 offset:34080
    v_fma_f32 v10, v10, v8, v9
    v_fma_f32 v11, v11, v8, v9
    v_fma_f32 v4, v4, v8, v9
    v_fma_f32 v5, v5, v8, v9
    v_mfma_f32_32x32x16_bf16 v[224:239], a[52:55], v[108:111], v[224:239]
    s_waitcnt lgkmcnt(4)
    ds_read_b64_tr_b16 a[36:37], v7 offset:33856
    ds_read_b64_tr_b16 a[38:39], v7 offset:34112
    v_cvt_pk_bf16_f32 v118, v10, v11
    v_cvt_pk_bf16_f32 v119, v4, v5
    v_mfma_f32_32x32x16_bf16 v[128:143], a[0:3], v[112:115], v[128:143]
    s_barrier
    ds_read_b64_tr_b16 a[40:41], v7 offset:33888
    ds_read_b64_tr_b16 a[42:43], v7 offset:34144
    buffer_load_dwordx2 a[104:105], v252, s[28:31], s77 offen offset:0 sc1
    v_mfma_f32_32x32x16_bf16 v[144:159], a[4:7], v[112:115], v[144:159]
    ds_read_b64_tr_b16 a[44:45], v7 offset:33920
    ds_read_b64_tr_b16 a[46:47], v7 offset:34176
    buffer_load_dwordx2 a[106:107], v253, s[28:31], s77 offen offset:0 sc1
    v_lshlrev_b32 v10, 16, v120
    v_and_b32 v11, 0xffff0000, v120
    v_lshlrev_b32 v4, 16, v121
    v_mfma_f32_32x32x16_bf16 v[160:175], a[8:11], v[112:115], v[160:175]
    ds_read_b64_tr_b16 a[48:49], v7 offset:33952
    ds_read_b64_tr_b16 a[50:51], v7 offset:34208
    buffer_load_dwordx2 a[108:109], v252, s[28:31], s77 offen offset:1024 sc1
    v_and_b32 v5, 0xffff0000, v121
    v_fma_f32 v10, v10, v8, v9
    v_mfma_f32_32x32x16_bf16 v[176:191], a[12:15], v[112:115], v[176:191]
    ds_read_b64_tr_b16 a[52:53], v7 offset:33984
    ds_read_b64_tr_b16 a[54:55], v7 offset:34240
    buffer_load_dwordx2 a[110:111], v254, s[28:31], s77 offen offset:1024 sc1
    v_fma_f32 v11, v11, v8, v9
    v_fma_f32 v4, v4, v8, v9
    v_fma_f32 v5, v5, v8, v9
    v_mfma_f32_32x32x16_bf16 v[192:207], a[16:19], v[112:115], v[192:207]
    ds_read_b64_tr_b16 a[0:1], v7 offset:42240
    ds_read_b64_tr_b16 a[2:3], v7 offset:42496
    buffer_load_dwordx4 a[144:147], v2, s[28:31], s70 offen offset:0 sc1
    v_cvt_pk_bf16_f32 v120, v10, v11
    v_cvt_pk_bf16_f32 v121, v4, v5
    v_mfma_f32_32x32x16_bf16 v[208:223], a[20:23], v[112:115], v[208:223]
    ds_read_b64_tr_b16 a[4:5], v7 offset:42272
    ds_read_b64_tr_b16 a[6:7], v7 offset:42528
    buffer_load_dwordx4 a[148:151], v2, s[28:31], s70 offen offset:1024 sc1
    v_lshlrev_b32 v10, 16, v122
    v_and_b32 v11, 0xffff0000, v122
    v_lshlrev_b32 v4, 16, v123
    v_mfma_f32_32x32x16_bf16 v[224:239], a[24:27], v[112:115], v[224:239]
    s_waitcnt lgkmcnt(4)
    ds_read_b64_tr_b16 a[8:9], v7 offset:42304
    ds_read_b64_tr_b16 a[10:11], v7 offset:42560
    v_and_b32 v5, 0xffff0000, v123
    v_fma_f32 v10, v10, v8, v9
    v_fma_f32 v11, v11, v8, v9
    v_mfma_f32_32x32x16_bf16 v[128:143], a[28:31], v[116:119], v[128:143]
    ds_read_b64_tr_b16 a[12:13], v7 offset:42336
    ds_read_b64_tr_b16 a[14:15], v7 offset:42592
    buffer_load_dwordx4 a[152:155], v2, s[28:31], s70 offen offset:2048 sc1
    v_fma_f32 v4, v4, v8, v9
    v_fma_f32 v5, v5, v8, v9
    v_cvt_pk_bf16_f32 v122, v10, v11
    v_mfma_f32_32x32x16_bf16 v[144:159], a[32:35], v[116:119], v[144:159]
    ds_read_b64_tr_b16 a[16:17], v7 offset:42368
    ds_read_b64_tr_b16 a[18:19], v7 offset:42624
    buffer_load_dwordx4 a[156:159], v2, s[28:31], s70 offen offset:3072 sc1
    s_add_u32 s70, s70, 4096
    v_cvt_pk_bf16_f32 v123, v4, v5
    v_mfma_f32_32x32x16_bf16 v[160:175], a[36:39], v[116:119], v[160:175]
    ds_read_b64_tr_b16 a[20:21], v7 offset:42400
    ds_read_b64_tr_b16 a[22:23], v7 offset:42656
    v_lshlrev_b32 v10, 16, v124
    v_and_b32 v11, 0xffff0000, v124
    v_lshlrev_b32 v4, 16, v125
    v_and_b32 v5, 0xffff0000, v125
    v_fma_f32 v10, v10, v8, v9
    v_mfma_f32_32x32x16_bf16 v[176:191], a[40:43], v[116:119], v[176:191]
    ds_read_b64_tr_b16 a[24:25], v7 offset:42432
    ds_read_b64_tr_b16 a[26:27], v7 offset:42688
    v_fma_f32 v11, v11, v8, v9
    v_fma_f32 v4, v4, v8, v9
    v_fma_f32 v5, v5, v8, v9
    v_cvt_pk_bf16_f32 v124, v10, v11
    v_mfma_f32_32x32x16_bf16 v[192:207], a[44:47], v[116:119], v[192:207]
    ds_read_b64_tr_b16 a[28:29], v7 offset:50688
    ds_read_b64_tr_b16 a[30:31], v7 offset:50944
    v_cvt_pk_bf16_f32 v125, v4, v5
    v_lshlrev_b32 v10, 16, v126
    v_and_b32 v11, 0xffff0000, v126
    v_lshlrev_b32 v4, 16, v127
    v_and_b32 v5, 0xffff0000, v127
    v_mfma_f32_32x32x16_bf16 v[208:223], a[48:51], v[116:119], v[208:223]
    ds_read_b64_tr_b16 a[32:33], v7 offset:50720
    ds_read_b64_tr_b16 a[34:35], v7 offset:50976
    v_fma_f32 v10, v10, v8, v9
    v_fma_f32 v11, v11, v8, v9
    v_fma_f32 v4, v4, v8, v9
    v_fma_f32 v5, v5, v8, v9
    v_mfma_f32_32x32x16_bf16 v[224:239], a[52:55], v[116:119], v[224:239]
    s_waitcnt lgkmcnt(4)
    ds_read_b64_tr_b16 a[36:37], v7 offset:50752
    ds_read_b64_tr_b16 a[38:39], v7 offset:51008
    v_cvt_pk_bf16_f32 v126, v10, v11
    v_cvt_pk_bf16_f32 v127, v4, v5
    v_mfma_f32_32x32x16_bf16 v[128:143], a[0:3], v[120:123], v[128:143]
    s_barrier
    ds_read_b64_tr_b16 a[40:41], v7 offset:50784
    ds_read_b64_tr_b16 a[42:43], v7 offset:51040
    buffer_load_dwordx2 a[112:113], v252, s[28:31], s78 offen offset:0 sc1
    v_mfma_f32_32x32x16_bf16 v[144:159], a[4:7], v[120:123], v[144:159]
    ds_read_b64_tr_b16 a[44:45], v7 offset:50816
    ds_read_b64_tr_b16 a[46:47], v7 offset:51072
    buffer_load_dwordx2 a[114:115], v253, s[28:31], s78 offen offset:0 sc1
    v_mfma_f32_32x32x16_bf16 v[160:175], a[8:11], v[120:123], v[160:175]
    ds_read_b64_tr_b16 a[48:49], v7 offset:50848
    ds_read_b64_tr_b16 a[50:51], v7 offset:51104
    v_mfma_f32_32x32x16_bf16 v[176:191], a[12:15], v[120:123], v[176:191]
    ds_read_b64_tr_b16 a[52:53], v7 offset:50880
    ds_read_b64_tr_b16 a[54:55], v7 offset:51136
    v_mfma_f32_32x32x16_bf16 v[192:207], a[16:19], v[120:123], v[192:207]
    buffer_load_dwordx2 a[116:117], v252, s[28:31], s78 offen offset:1024 sc1
    v_mfma_f32_32x32x16_bf16 v[208:223], a[20:23], v[120:123], v[208:223]
    buffer_load_dwordx2 a[118:119], v254, s[28:31], s78 offen offset:1024 sc1
    v_mfma_f32_32x32x16_bf16 v[224:239], a[24:27], v[120:123], v[224:239]
    s_waitcnt lgkmcnt(0)
    v_mfma_f32_32x32x16_bf16 v[128:143], a[28:31], v[124:127], v[128:143]
    buffer_load_dwordx2 a[120:121], v252, s[28:31], s79 offen offset:0 sc1
    v_mfma_f32_32x32x16_bf16 v[144:159], a[32:35], v[124:127], v[144:159]
    buffer_load_dwordx2 a[122:123], v253, s[28:31], s79 offen offset:0 sc1
    v_mfma_f32_32x32x16_bf16 v[160:175], a[36:39], v[124:127], v[160:175]
    buffer_load_dwordx2 a[124:125], v252, s[28:31], s79 offen offset:1024 sc1
    v_mfma_f32_32x32x16_bf16 v[176:191], a[40:43], v[124:127], v[176:191]
    buffer_load_dwordx2 a[126:127], v254, s[28:31], s79 offen offset:1024 sc1
    v_mfma_f32_32x32x16_bf16 v[192:207], a[44:47], v[124:127], v[192:207]
    v_mfma_f32_32x32x16_bf16 v[208:223], a[48:51], v[124:127], v[208:223]
    v_mfma_f32_32x32x16_bf16 v[224:239], a[52:55], v[124:127], v[224:239]
    s_barrier
    v_accvgpr_read_b32 v4, a80
    v_accvgpr_read_b32 v5, a81
    v_accvgpr_read_b32 v6, a82
    v_accvgpr_read_b32 v7, a83
    v_accvgpr_read_b32 v8, a84
    v_accvgpr_read_b32 v9, a85
    s_add_u32 m0, s59, 98304
    s_nop 0
    buffer_load_dwordx4 v14, s[20:23], s55 offen lds
    buffer_load_dwordx4 v15, s[20:23], s55 offen offset:1024 lds
    v_exp_f32 v64, -v128
    v_exp_f32 v65, -v129
    v_exp_f32 v66, -v130
    v_exp_f32 v67, -v131
    v_exp_f32 v68, -v132
    v_exp_f32 v69, -v133
    v_exp_f32 v70, -v134
    v_exp_f32 v71, -v135
    v_pk_mul_f32 v[136:137], v[128:129], v[136:137]
    v_pk_mul_f32 v[138:139], v[130:131], v[138:139]
    v_pk_mul_f32 v[140:141], v[132:133], v[140:141]
    v_pk_mul_f32 v[142:143], v[134:135], v[142:143]
    v_pk_fma_f32 v[64:65], v[64:65], s[48:49], s[48:49]
    v_pk_fma_f32 v[66:67], v[66:67], s[48:49], s[48:49]
    v_pk_fma_f32 v[68:69], v[68:69], s[48:49], s[48:49]
    v_pk_fma_f32 v[70:71], v[70:71], s[48:49], s[48:49]
    v_rcp_f32 v64, v64
    v_rcp_f32 v65, v65
    v_rcp_f32 v66, v66
    v_rcp_f32 v67, v67
    v_rcp_f32 v68, v68
    v_rcp_f32 v69, v69
    v_rcp_f32 v70, v70
    v_rcp_f32 v71, v71
    v_pk_mul_f32 v[136:137], v[136:137], v[64:65]
    v_pk_mul_f32 v[138:139], v[138:139], v[66:67]
    v_pk_mul_f32 v[140:141], v[140:141], v[68:69]
    v_pk_mul_f32 v[142:143], v[142:143], v[70:71]
    v_cvt_pk_bf16_f32 v80, v136, v137
    v_cvt_pk_bf16_f32 v81, v138, v139
    v_cvt_pk_bf16_f32 v82, v140, v141
    v_cvt_pk_bf16_f32 v83, v142, v143
    buffer_store_dwordx4 v[80:83], v2, s[28:31], s71 offen offset:0 sc1
    s_add_u32 m0, s59, 106496
    s_add_u32 s55, s55, 14336
    buffer_load_dwordx4 v14, s[20:23], s55 offen lds
    buffer_load_dwordx4 v15, s[20:23], s55 offen offset:1024 lds
    v_exp_f32 v64, -v144
    v_exp_f32 v65, -v145
    v_exp_f32 v66, -v146
    v_exp_f32 v67, -v147
    v_exp_f32 v68, -v148
    v_exp_f32 v69, -v149
    v_exp_f32 v70, -v150
    v_exp_f32 v71, -v151
    v_pk_mul_f32 v[152:153], v[144:145], v[152:153]
    v_pk_mul_f32 v[154:155], v[146:147], v[154:155]
    v_pk_mul_f32 v[156:157], v[148:149], v[156:157]
    v_pk_mul_f32 v[158:159], v[150:151], v[158:159]
    v_pk_fma_f32 v[64:65], v[64:65], s[48:49], s[48:49]
    v_pk_fma_f32 v[66:67], v[66:67], s[48:49], s[48:49]
    v_pk_fma_f32 v[68:69], v[68:69], s[48:49], s[48:49]
    v_pk_fma_f32 v[70:71], v[70:71], s[48:49], s[48:49]
    v_rcp_f32 v64, v64
    v_rcp_f32 v65, v65
    v_rcp_f32 v66, v66
    v_rcp_f32 v67, v67
    v_rcp_f32 v68, v68
    v_rcp_f32 v69, v69
    v_rcp_f32 v70, v70
    v_rcp_f32 v71, v71
    v_pk_mul_f32 v[152:153], v[152:153], v[64:65]
    v_pk_mul_f32 v[154:155], v[154:155], v[66:67]
    v_pk_mul_f32 v[156:157], v[156:157], v[68:69]
    v_pk_mul_f32 v[158:159], v[158:159], v[70:71]
    v_cvt_pk_bf16_f32 v84, v152, v153
    v_cvt_pk_bf16_f32 v85, v154, v155
    v_cvt_pk_bf16_f32 v86, v156, v157
    v_cvt_pk_bf16_f32 v87, v158, v159
    buffer_store_dwordx4 v[84:87], v2, s[28:31], s71 offen offset:1024 sc1
    s_add_u32 m0, s59, 114688
    s_add_u32 s55, s55, 14336
    buffer_load_dwordx4 v14, s[20:23], s55 offen lds
    buffer_load_dwordx4 v15, s[20:23], s55 offen offset:1024 lds
    v_exp_f32 v64, -v160
    v_exp_f32 v65, -v161
    v_exp_f32 v66, -v162
    v_exp_f32 v67, -v163
    v_exp_f32 v68, -v164
    v_exp_f32 v69, -v165
    v_exp_f32 v70, -v166
    v_exp_f32 v71, -v167
    v_pk_mul_f32 v[168:169], v[160:161], v[168:169]
    v_pk_mul_f32 v[170:171], v[162:163], v[170:171]
    v_pk_mul_f32 v[172:173], v[164:165], v[172:173]
    v_pk_mul_f32 v[174:175], v[166:167], v[174:175]
    v_pk_fma_f32 v[64:65], v[64:65], s[48:49], s[48:49]
    v_pk_fma_f32 v[66:67], v[66:67], s[48:49], s[48:49]
    v_pk_fma_f32 v[68:69], v[68:69], s[48:49], s[48:49]
    v_pk_fma_f32 v[70:71], v[70:71], s[48:49], s[48:49]
    v_rcp_f32 v64, v64
    v_rcp_f32 v65, v65
    v_rcp_f32 v66, v66
    v_rcp_f32 v67, v67
    v_rcp_f32 v68, v68
    v_rcp_f32 v69, v69
    v_rcp_f32 v70, v70
    v_rcp_f32 v71, v71
    v_pk_mul_f32 v[168:169], v[168:169], v[64:65]
    v_pk_mul_f32 v[170:171], v[170:171], v[66:67]
    v_pk_mul_f32 v[172:173], v[172:173], v[68:69]
    v_pk_mul_f32 v[174:175], v[174:175], v[70:71]
    v_cvt_pk_bf16_f32 v80, v168, v169
    v_cvt_pk_bf16_f32 v81, v170, v171
    v_cvt_pk_bf16_f32 v82, v172, v173
    v_cvt_pk_bf16_f32 v83, v174, v175
    buffer_store_dwordx4 v[80:83], v2, s[28:31], s71 offen offset:2048 sc1
    s_add_u32 m0, s59, 122880
    s_add_u32 s55, s55, 14336
    buffer_load_dwordx4 v14, s[20:23], s55 offen lds
    buffer_load_dwordx4 v15, s[20:23], s55 offen offset:1024 lds
    v_exp_f32 v64, -v176
    v_exp_f32 v65, -v177
    v_exp_f32 v66, -v178
    v_exp_f32 v67, -v179
    v_exp_f32 v68, -v180
    v_exp_f32 v69, -v181
    v_exp_f32 v70, -v182
    v_exp_f32 v71, -v183
    v_pk_mul_f32 v[184:185], v[176:177], v[184:185]
    v_pk_mul_f32 v[186:187], v[178:179], v[186:187]
    v_pk_mul_f32 v[188:189], v[180:181], v[188:189]
    v_pk_mul_f32 v[190:191], v[182:183], v[190:191]
    v_pk_fma_f32 v[64:65], v[64:65], s[48:49], s[48:49]
    v_pk_fma_f32 v[66:67], v[66:67], s[48:49], s[48:49]
    v_pk_fma_f32 v[68:69], v[68:69], s[48:49], s[48:49]
    v_pk_fma_f32 v[70:71], v[70:71], s[48:49], s[48:49]
    v_rcp_f32 v64, v64
    v_rcp_f32 v65, v65
    v_rcp_f32 v66, v66
    v_rcp_f32 v67, v67
    v_rcp_f32 v68, v68
    v_rcp_f32 v69, v69
    v_rcp_f32 v70, v70
    v_rcp_f32 v71, v71
    v_pk_mul_f32 v[184:185], v[184:185], v[64:65]
    v_pk_mul_f32 v[186:187], v[186:187], v[66:67]
    v_pk_mul_f32 v[188:189], v[188:189], v[68:69]
    v_pk_mul_f32 v[190:191], v[190:191], v[70:71]
    v_cvt_pk_bf16_f32 v84, v184, v185
    v_cvt_pk_bf16_f32 v85, v186, v187
    v_cvt_pk_bf16_f32 v86, v188, v189
    v_cvt_pk_bf16_f32 v87, v190, v191
    buffer_store_dwordx4 v[84:87], v2, s[28:31], s71 offen offset:3072 sc1
    s_add_u32 m0, s59, 131072
    s_add_u32 s55, s55, 14336
    buffer_load_dwordx4 v14, s[20:23], s55 offen lds
    buffer_load_dwordx4 v15, s[20:23], s55 offen offset:1024 lds
    v_exp_f32 v64, -v192
    v_exp_f32 v65, -v193
    v_exp_f32 v66, -v194
    v_exp_f32 v67, -v195
    v_exp_f32 v68, -v196
    v_exp_f32 v69, -v197
    v_exp_f32 v70, -v198
    v_exp_f32 v71, -v199
    v_pk_mul_f32 v[200:201], v[192:193], v[200:201]
    v_pk_mul_f32 v[202:203], v[194:195], v[202:203]
    v_pk_mul_f32 v[204:205], v[196:197], v[204:205]
    v_pk_mul_f32 v[206:207], v[198:199], v[206:207]
    v_pk_fma_f32 v[64:65], v[64:65], s[48:49], s[48:49]
    v_pk_fma_f32 v[66:67], v[66:67], s[48:49], s[48:49]
    v_pk_fma_f32 v[68:69], v[68:69], s[48:49], s[48:49]
    v_pk_fma_f32 v[70:71], v[70:71], s[48:49], s[48:49]
    v_rcp_f32 v64, v64
    v_rcp_f32 v65, v65
    v_rcp_f32 v66, v66
    v_rcp_f32 v67, v67
    v_rcp_f32 v68, v68
    v_rcp_f32 v69, v69
    v_rcp_f32 v70, v70
    v_rcp_f32 v71, v71
    v_pk_mul_f32 v[200:201], v[200:201], v[64:65]
    v_pk_mul_f32 v[202:203], v[202:203], v[66:67]
    v_pk_mul_f32 v[204:205], v[204:205], v[68:69]
    v_pk_mul_f32 v[206:207], v[206:207], v[70:71]
    v_cvt_pk_bf16_f32 v80, v200, v201
    v_cvt_pk_bf16_f32 v81, v202, v203
    v_cvt_pk_bf16_f32 v82, v204, v205
    v_cvt_pk_bf16_f32 v83, v206, v207
    s_add_u32 s71, s71, 4096
    buffer_store_dwordx4 v[80:83], v2, s[28:31], s71 offen offset:0 sc1
    v_exp_f32 v64, -v208
    v_exp_f32 v65, -v209
    v_exp_f32 v66, -v210
    v_exp_f32 v67, -v211
    v_exp_f32 v68, -v212
    v_exp_f32 v69, -v213
    v_exp_f32 v70, -v214
    v_exp_f32 v71, -v215
    v_pk_mul_f32 v[216:217], v[208:209], v[216:217]
    v_pk_mul_f32 v[218:219], v[210:211], v[218:219]
    v_pk_mul_f32 v[220:221], v[212:213], v[220:221]
    v_pk_mul_f32 v[222:223], v[214:215], v[222:223]
    v_pk_fma_f32 v[64:65], v[64:65], s[48:49], s[48:49]
    v_pk_fma_f32 v[66:67], v[66:67], s[48:49], s[48:49]
    v_pk_fma_f32 v[68:69], v[68:69], s[48:49], s[48:49]
    v_pk_fma_f32 v[70:71], v[70:71], s[48:49], s[48:49]
    v_rcp_f32 v64, v64
    v_rcp_f32 v65, v65
    v_rcp_f32 v66, v66
    v_rcp_f32 v67, v67
    v_rcp_f32 v68, v68
    v_rcp_f32 v69, v69
    v_rcp_f32 v70, v70
    v_rcp_f32 v71, v71
    v_pk_mul_f32 v[216:217], v[216:217], v[64:65]
    v_pk_mul_f32 v[218:219], v[218:219], v[66:67]
    v_pk_mul_f32 v[220:221], v[220:221], v[68:69]
    v_pk_mul_f32 v[222:223], v[222:223], v[70:71]
    v_cvt_pk_bf16_f32 v84, v216, v217
    v_cvt_pk_bf16_f32 v85, v218, v219
    v_cvt_pk_bf16_f32 v86, v220, v221
    v_cvt_pk_bf16_f32 v87, v222, v223
    buffer_store_dwordx4 v[84:87], v2, s[28:31], s71 offen offset:1024 sc1
    v_exp_f32 v64, -v224
    v_exp_f32 v65, -v225
    v_exp_f32 v66, -v226
    v_exp_f32 v67, -v227
    v_exp_f32 v68, -v228
    v_exp_f32 v69, -v229
    v_exp_f32 v70, -v230
    v_exp_f32 v71, -v231
    v_pk_mul_f32 v[232:233], v[224:225], v[232:233]
    v_pk_mul_f32 v[234:235], v[226:227], v[234:235]
    v_pk_mul_f32 v[236:237], v[228:229], v[236:237]
    v_pk_mul_f32 v[238:239], v[230:231], v[238:239]
    v_pk_fma_f32 v[64:65], v[64:65], s[48:49], s[48:49]
    v_pk_fma_f32 v[66:67], v[66:67], s[48:49], s[48:49]
    v_pk_fma_f32 v[68:69], v[68:69], s[48:49], s[48:49]
    v_pk_fma_f32 v[70:71], v[70:71], s[48:49], s[48:49]
    v_rcp_f32 v64, v64
    v_rcp_f32 v65, v65
    v_rcp_f32 v66, v66
    v_rcp_f32 v67, v67
    v_rcp_f32 v68, v68
    v_rcp_f32 v69, v69
    v_rcp_f32 v70, v70
    v_rcp_f32 v71, v71
    v_pk_mul_f32 v[232:233], v[232:233], v[64:65]
    v_pk_mul_f32 v[234:235], v[234:235], v[66:67]
    v_pk_mul_f32 v[236:237], v[236:237], v[68:69]
    v_pk_mul_f32 v[238:239], v[238:239], v[70:71]
    v_cvt_pk_bf16_f32 v80, v232, v233
    v_cvt_pk_bf16_f32 v81, v234, v235
    v_cvt_pk_bf16_f32 v82, v236, v237
    v_cvt_pk_bf16_f32 v83, v238, v239
    buffer_store_dwordx4 v[80:83], v2, s[28:31], s71 offen offset:2048 sc1
    s_cmp_ge_u32 s45, 14
    s_cbranch_scc1 L_p2q
    s_waitcnt vmcnt(17)
    v_mfma_f32_32x32x16_bf16 v[16:31], a[128:131], a[96:99], 0
    v_mfma_f32_32x32x16_bf16 v[16:31], a[132:135], a[100:103], v[16:31]
    s_nop 9
    v_mfma_f32_32x32x16_bf16 v[32:47], a[128:131], a[104:107], 0
    s_add_u32 m0, s59, 139264
    s_add_u32 s55, s55, 14336
    buffer_load_dwordx4 v14, s[20:23], s55 offen lds
    v_exp_f32 v16, v16
    v_exp_f32 v17, v17
    v_exp_f32 v18, v18
    v_exp_f32 v19, v19
    v_cvt_pk_bf16_f32 v48, v16, v17
    v_exp_f32 v20, v20
    v_exp_f32 v21, v21
    v_mfma_f32_32x32x16_bf16 v[32:47], a[132:135], a[108:111], v[32:47]
    buffer_load_dwordx4 v15, s[20:23], s55 offen offset:1024 lds
    v_cvt_pk_bf16_f32 v49, v18, v19
    v_exp_f32 v22, v22
    v_exp_f32 v23, v23
    v_cvt_pk_bf16_f32 v50, v20, v21
    v_cvt_pk_bf16_f32 v51, v22, v23
    v_exp_f32 v24, v24
    v_exp_f32 v25, v25
    v_exp_f32 v26, v26
    v_mfma_f32_32x32x16_bf16 a[32:47], a[136:139], v[48:51], 0
    buffer_load_dwordx4 a[160:163], v2, s[28:31], s70 offen offset:0 sc1
    v_exp_f32 v27, v27
    v_cvt_pk_bf16_f32 v52, v24, v25
    v_exp_f32 v28, v28
    v_exp_f32 v29, v29
    v_cvt_pk_bf16_f32 v53, v26, v27
    v_exp_f32 v30, v30
    v_exp_f32 v31, v31
    v_cvt_pk_bf16_f32 v54, v28, v29
    v_cvt_pk_bf16_f32 v55, v30, v31
    v_mfma_f32_32x32x16_bf16 v[16:31], a[128:131], a[112:115], 0
    s_add_u32 m0, s59, 147456
    s_add_u32 s55, s55, 14336
    buffer_load_dwordx4 v14, s[20:23], s55 offen lds
    v_exp_f32 v32, v32
    v_exp_f32 v33, v33
    v_exp_f32 v34, v34
    v_exp_f32 v35, v35
    v_mfma_f32_32x32x16_bf16 a[32:47], a[140:143], v[52:55], a[32:47]
    buffer_load_dwordx4 v15, s[20:23], s55 offen offset:1024 lds
    v_cvt_pk_bf16_f32 v56, v32, v33
    v_exp_f32 v36, v36
    v_exp_f32 v37, v37
    v_cvt_pk_bf16_f32 v57, v34, v35
    v_exp_f32 v38, v38
    v_exp_f32 v39, v39
    v_cvt_pk_bf16_f32 v58, v36, v37
    v_mfma_f32_32x32x16_bf16 v[16:31], a[132:135], a[116:119], v[16:31]
    buffer_load_dwordx4 a[164:167], v2, s[28:31], s70 offen offset:1024 sc1
    v_cvt_pk_bf16_f32 v59, v38, v39
    v_exp_f32 v40, v40
    v_exp_f32 v41, v41
    v_exp_f32 v42, v42
    v_exp_f32 v43, v43
    v_cvt_pk_bf16_f32 v60, v40, v41
    v_mfma_f32_32x32x16_bf16 a[16:31], a[136:139], v[56:59], 0
    v_exp_f32 v44, v44
    v_exp_f32 v45, v45
    v_cvt_pk_bf16_f32 v61, v42, v43
    v_exp_f32 v46, v46
    v_exp_f32 v47, v47
    v_cvt_pk_bf16_f32 v62, v44, v45
    v_cvt_pk_bf16_f32 v63, v46, v47
    v_mfma_f32_32x32x16_bf16 v[32:47], a[128:131], a[120:123], 0
    s_add_u32 m0, s59, 155648
    s_add_u32 s55, s55, 14336
    buffer_load_dwordx4 v14, s[20:23], s55 offen lds
    v_exp_f32 v16, v16
    v_exp_f32 v17, v17
    v_exp_f32 v18, v18
    v_exp_f32 v19, v19
    v_mfma_f32_32x32x16_bf16 a[16:31], a[140:143], v[60:63], a[16:31]
    buffer_load_dwordx4 v15, s[20:23], s55 offen offset:1024 lds
    v_cvt_pk_bf16_f32 v48, v16, v17
    v_exp_f32 v20, v20
    v_exp_f32 v21, v21
    v_cvt_pk_bf16_f32 v49, v18, v19
    v_exp_f32 v22, v22
    v_exp_f32 v23, v23
    v_cvt_pk_bf16_f32 v50, v20, v21
    v_mfma_f32_32x32x16_bf16 v[32:47], a[132:135], a[124:127], v[32:47]
    buffer_load_dwordx4 a[168:171], v2, s[28:31], s70 offen offset:2048 sc1
    v_cvt_pk_bf16_f32 v51, v22, v23
    v_exp_f32 v24, v24
    v_exp_f32 v25, v25
    v_exp_f32 v26, v26
    v_exp_f32 v27, v27
    v_cvt_pk_bf16_f32 v52, v24, v25
    v_mfma_f32_32x32x16_bf16 a[0:15], a[136:139], v[48:51], 0
    v_exp_f32 v28, v28
    v_exp_f32 v29, v29
    v_cvt_pk_bf16_f32 v53, v26, v27
    v_exp_f32 v30, v30
    v_exp_f32 v31, v31
    v_cvt_pk_bf16_f32 v54, v28, v29
    v_cvt_pk_bf16_f32 v55, v30, v31
    v_mfma_f32_32x32x16_bf16 v[16:31], a[144:147], a[96:99], 0
    s_add_u32 m0, s59, 0
    s_add_u32 s55, s55, 14336
    buffer_load_dwordx4 v14, s[20:23], s55 offen lds
    v_exp_f32 v32, v32
    v_exp_f32 v33, v33
    v_exp_f32 v34, v34
    v_exp_f32 v35, v35
    v_mfma_f32_32x32x16_bf16 a[0:15], a[140:143], v[52:55], a[0:15]
    buffer_load_dwordx4 v15, s[20:23], s55 offen offset:1024 lds
    v_cvt_pk_bf16_f32 v56, v32, v33
    v_exp_f32 v36, v36
    v_exp_f32 v37, v37
    v_cvt_pk_bf16_f32 v57, v34, v35
    v_exp_f32 v38, v38
    v_exp_f32 v39, v39
    v_cvt_pk_bf16_f32 v58, v36, v37
    v_mfma_f32_32x32x16_bf16 v[16:31], a[148:151], a[100:103], v[16:31]
    buffer_load_dwordx4 a[172:175], v2, s[28:31], s70 offen offset:3072 sc1
    s_add_u32 s70, s70, 4096
    v_cvt_pk_bf16_f32 v59, v38, v39
    v_exp_f32 v40, v40
    v_exp_f32 v41, v41
    v_exp_f32 v42, v42
    v_exp_f32 v43, v43
    v_mfma_f32_32x32x16_bf16 v[64:79], a[136:139], v[56:59], 0
    v_cvt_pk_bf16_f32 v60, v40, v41
    v_exp_f32 v44, v44
    v_exp_f32 v45, v45
    v_cvt_pk_bf16_f32 v61, v42, v43
    v_exp_f32 v46, v46
    v_exp_f32 v47, v47
    v_cvt_pk_bf16_f32 v62, v44, v45
    v_cvt_pk_bf16_f32 v63, v46, v47
    v_mfma_f32_32x32x16_bf16 v[32:47], a[144:147], a[104:107], 0
    s_waitcnt vmcnt(12)
    v_mov_b32 v12, s60
    s_add_u32 s61, s68, 0x30000
    v_exp_f32 v16, v16
    v_exp_f32 v17, v17
    v_exp_f32 v18, v18
    v_exp_f32 v19, v19
    v_mfma_f32_32x32x16_bf16 v[64:79], a[140:143], v[60:63], v[64:79]
    buffer_store_dword v12, v3, s[28:31], s61 offen sc1
    v_cvt_pk_bf16_f32 v48, v16, v17
    v_exp_f32 v20, v20
    v_exp_f32 v21, v21
    v_cvt_pk_bf16_f32 v49, v18, v19
    v_exp_f32 v22, v22
    v_exp_f32 v23, v23
    v_cvt_pk_bf16_f32 v50, v20, v21
    v_mfma_f32_32x32x16_bf16 v[32:47], a[148:151], a[108:111], v[32:47]
    buffer_load_dwordx4 a[128:131], v2, s[28:31], s70 offen offset:0 sc1
    v_cvt_pk_bf16_f32 v51, v22, v23
    v_exp_f32 v24, v24
    v_exp_f32 v25, v25
    v_exp_f32 v26, v26
    v_exp_f32 v27, v27
    v_cvt_pk_bf16_f32 v52, v24, v25
    v_mfma_f32_32x32x16_bf16 a[32:47], a[152:155], v[48:51], a[32:47]
    v_exp_f32 v28, v28
    v_exp_f32 v29, v29
    v_cvt_pk_bf16_f32 v53, v26, v27
    v_exp_f32 v30, v30
    v_exp_f32 v31, v31
    v_cvt_pk_bf16_f32 v54, v28, v29
    v_cvt_pk_bf16_f32 v55, v30, v31
    v_mfma_f32_32x32x16_bf16 v[16:31], a[144:147], a[112:115], 0
    s_add_u32 m0, s59, 8192
    s_add_u32 s55, s55, 14336
    buffer_load_dwordx4 v14, s[20:23], s55 offen lds
    v_exp_f32 v32, v32
    v_exp_f32 v33, v33
    v_exp_f32 v34, v34
    v_exp_f32 v35, v35
    v_mfma_f32_32x32x16_bf16 a[32:47], a[156:159], v[52:55], a[32:47]
    buffer_load_dwordx4 v15, s[20:23], s55 offen offset:1024 lds
    v_cvt_pk_bf16_f32 v56, v32, v33
    v_exp_f32 v36, v36
    v_exp_f32 v37, v37
    v_cvt_pk_bf16_f32 v57, v34, v35
    v_exp_f32 v38, v38
    v_exp_f32 v39, v39
    v_cvt_pk_bf16_f32 v58, v36, v37
    v_mfma_f32_32x32x16_bf16 v[16:31], a[148:151], a[116:119], v[16:31]
    buffer_load_dwordx4 a[132:135], v2, s[28:31], s70 offen offset:1024 sc1
    v_cvt_pk_bf16_f32 v59, v38, v39
    v_exp_f32 v40, v40
    v_exp_f32 v41, v41
    v_exp_f32 v42, v42
    v_exp_f32 v43, v43
    v_cvt_pk_bf16_f32 v60, v40, v41
    v_mfma_f32_32x32x16_bf16 a[16:31], a[152:155], v[56:59], a[16:31]
    v_exp_f32 v44, v44
    v_exp_f32 v45, v45
    v_cvt_pk_bf16_f32 v61, v42, v43
    v_exp_f32 v46, v46
    v_exp_f32 v47, v47
    v_cvt_pk_bf16_f32 v62, v44, v45
    v_cvt_pk_bf16_f32 v63, v46, v47
    v_mfma_f32_32x32x16_bf16 v[32:47], a[144:147], a[120:123], 0
    s_add_u32 m0, s59, 16384
    s_add_u32 s55, s55, 14336
    buffer_load_dwordx4 v14, s[20:23], s55 offen lds
    v_exp_f32 v16, v16
    v_exp_f32 v17, v17
    v_exp_f32 v18, v18
    v_exp_f32 v19, v19
    v_mfma_f32_32x32x16_bf16 a[16:31], a[156:159], v[60:63], a[16:31]
    buffer_load_dwordx4 v15, s[20:23], s55 offen offset:1024 lds
    v_cvt_pk_bf16_f32 v48, v16, v17
    v_exp_f32 v20, v20
    v_exp_f32 v21, v21
    v_cvt_pk_bf16_f32 v49, v18, v19
    v_exp_f32 v22, v22
    v_exp_f32 v23, v23
    v_cvt_pk_bf16_f32 v50, v20, v21
    v_mfma_f32_32x32x16_bf16 v[32:47], a[148:151], a[124:127], v[32:47]
    buffer_load_dwordx4 a[136:139], v2, s[28:31], s70 offen offset:2048 sc1
    v_cvt_pk_bf16_f32 v51, v22, v23
    v_exp_f32 v24, v24
    v_exp_f32 v25, v25
    v_exp_f32 v26, v26
    v_exp_f32 v27, v27
    v_cvt_pk_bf16_f32 v52, v24, v25
    v_mfma_f32_32x32x16_bf16 a[0:15], a[152:155], v[48:51], a[0:15]
    v_exp_f32 v28, v28
    v_exp_f32 v29, v29
    v_cvt_pk_bf16_f32 v53, v26, v27
    v_exp_f32 v30, v30
    v_exp_f32 v31, v31
    v_cvt_pk_bf16_f32 v54, v28, v29
    v_cvt_pk_bf16_f32 v55, v30, v31
    s_waitcnt vmcnt(8)
    v_mfma_f32_32x32x16_bf16 v[16:31], a[160:163], a[96:99], 0
    s_add_u32 m0, s59, 24576
    s_add_u32 s55, s55, 14336
    buffer_load_dwordx4 v14, s[20:23], s55 offen lds
    v_exp_f32 v32, v32
    v_exp_f32 v33, v33
    v_exp_f32 v34, v34
    v_exp_f32 v35, v35
    v_mfma_f32_32x32x16_bf16 a[0:15], a[156:159], v[52:55], a[0:15]
    buffer_load_dwordx4 v15, s[20:23], s55 offen offset:1024 lds
    v_cvt_pk_bf16_f32 v56, v32, v33
    v_exp_f32 v36, v36
    v_exp_f32 v37, v37
    v_cvt_pk_bf16_f32 v57, v34, v35
    v_exp_f32 v38, v38
    v_exp_f32 v39, v39
    v_cvt_pk_bf16_f32 v58, v36, v37
    v_mfma_f32_32x32x16_bf16 v[16:31], a[164:167], a[100:103], v[16:31]
    buffer_load_dwordx4 a[140:143], v2, s[28:31], s70 offen offset:3072 sc1
    s_add_u32 s70, s70, 4096
    v_cvt_pk_bf16_f32 v59, v38, v39
    v_exp_f32 v40, v40
    v_exp_f32 v41, v41
    v_exp_f32 v42, v42
    v_exp_f32 v43, v43
    v_mfma_f32_32x32x16_bf16 v[64:79], a[152:155], v[56:59], v[64:79]
    v_cvt_pk_bf16_f32 v60, v40, v41
    v_exp_f32 v44, v44
    v_exp_f32 v45, v45
    v_cvt_pk_bf16_f32 v61, v42, v43
    v_exp_f32 v46, v46
    v_exp_f32 v47, v47
    v_cvt_pk_bf16_f32 v62, v44, v45
    v_cvt_pk_bf16_f32 v63, v46, v47
    v_mfma_f32_32x32x16_bf16 v[32:47], a[160:163], a[104:107], 0
    s_add_u32 m0, s59, 32768
    s_add_u32 s55, s55, 14336
    buffer_load_dwordx4 v14, s[20:23], s55 offen lds
    v_exp_f32 v16, v16
    v_exp_f32 v17, v17
    v_exp_f32 v18, v18
    v_exp_f32 v19, v19
    v_mfma_f32_32x32x16_bf16 v[64:79], a[156:159], v[60:63], v[64:79]
    buffer_load_dwordx4 v15, s[20:23], s55 offen offset:1024 lds
    v_cvt_pk_bf16_f32 v48, v16, v17
    v_exp_f32 v20, v20
    v_exp_f32 v21, v21
    v_cvt_pk_bf16_f32 v49, v18, v19
    v_exp_f32 v22, v22
    v_exp_f32 v23, v23
    v_cvt_pk_bf16_f32 v50, v20, v21
    v_mfma_f32_32x32x16_bf16 v[32:47], a[164:167], a[108:111], v[32:47]
    buffer_load_dwordx4 a[144:147], v2, s[28:31], s70 offen offset:0 sc1
    v_cvt_pk_bf16_f32 v51, v22, v23
    v_exp_f32 v24, v24
    v_exp_f32 v25, v25
    v_exp_f32 v26, v26
    v_exp_f32 v27, v27
    v_cvt_pk_bf16_f32 v52, v24, v25
    v_mfma_f32_32x32x16_bf16 a[32:47], a[168:171], v[48:51], a[32:47]
    v_exp_f32 v28, v28
    v_exp_f32 v29, v29
    v_cvt_pk_bf16_f32 v53, v26, v27
    v_exp_f32 v30, v30
    v_exp_f32 v31, v31
    v_cvt_pk_bf16_f32 v54, v28, v29
    v_cvt_pk_bf16_f32 v55, v30, v31
    v_mfma_f32_32x32x16_bf16 v[16:31], a[160:163], a[112:115], 0
    s_add_u32 m0, s59, 40960
    s_add_u32 s55, s55, 14336
    buffer_load_dwordx4 v14, s[20:23], s55 offen lds
    v_exp_f32 v32, v32
    v_exp_f32 v33, v33
    v_exp_f32 v34, v34
    v_exp_f32 v35, v35
    v_mfma_f32_32x32x16_bf16 a[32:47], a[172:175], v[52:55], a[32:47]
    buffer_load_dwordx4 v15, s[20:23], s55 offen offset:1024 lds
    v_cvt_pk_bf16_f32 v56, v32, v33
    v_exp_f32 v36, v36
    v_exp_f32 v37, v37
    v_cvt_pk_bf16_f32 v57, v34, v35
    v_exp_f32 v38, v38
    v_exp_f32 v39, v39
    v_cvt_pk_bf16_f32 v58, v36, v37
    v_mfma_f32_32x32x16_bf16 v[16:31], a[164:167], a[116:119], v[16:31]
    buffer_load_dwordx4 a[148:151], v2, s[28:31], s70 offen offset:1024 sc1
    v_cvt_pk_bf16_f32 v59, v38, v39
    v_exp_f32 v40, v40
    v_exp_f32 v41, v41
    v_exp_f32 v42, v42
    v_exp_f32 v43, v43
    v_cvt_pk_bf16_f32 v60, v40, v41
    v_mfma_f32_32x32x16_bf16 a[16:31], a[168:171], v[56:59], a[16:31]
    v_exp_f32 v44, v44
    v_exp_f32 v45, v45
    v_cvt_pk_bf16_f32 v61, v42, v43
    v_exp_f32 v46, v46
    v_exp_f32 v47, v47
    v_cvt_pk_bf16_f32 v62, v44, v45
    v_cvt_pk_bf16_f32 v63, v46, v47
    v_mfma_f32_32x32x16_bf16 v[32:47], a[160:163], a[120:123], 0
    s_add_u32 m0, s59, 49152
    s_add_u32 s55, s55, 14336
    buffer_load_dwordx4 v14, s[20:23], s55 offen lds
    v_exp_f32 v16, v16
    v_exp_f32 v17, v17
    v_exp_f32 v18, v18
    v_exp_f32 v19, v19
    v_mfma_f32_32x32x16_bf16 a[16:31], a[172:175], v[60:63], a[16:31]
    buffer_load_dwordx4 v15, s[20:23], s55 offen offset:1024 lds
    v_cvt_pk_bf16_f32 v48, v16, v17
    v_exp_f32 v20, v20
    v_exp_f32 v21, v21
    v_cvt_pk_bf16_f32 v49, v18, v19
    v_exp_f32 v22, v22
    v_exp_f32 v23, v23
    v_cvt_pk_bf16_f32 v50, v20, v21
    v_mfma_f32_32x32x16_bf16 v[32:47], a[164:167], a[124:127], v[32:47]
    buffer_load_dwordx4 a[152:155], v2, s[28:31], s70 offen offset:2048 sc1
    v_cvt_pk_bf16_f32 v51, v22, v23
    v_exp_f32 v24, v24
    v_exp_f32 v25, v25
    v_exp_f32 v26, v26
    v_exp_f32 v27, v27
    v_cvt_pk_bf16_f32 v52, v24, v25
    v_mfma_f32_32x32x16_bf16 a[0:15], a[168:171], v[48:51], a[0:15]
    v_exp_f32 v28, v28
    v_exp_f32 v29, v29
    v_cvt_pk_bf16_f32 v53, v26, v27
    v_exp_f32 v30, v30
    v_exp_f32 v31, v31
    v_cvt_pk_bf16_f32 v54, v28, v29
    v_cvt_pk_bf16_f32 v55, v30, v31
    s_waitcnt vmcnt(9)
    v_mfma_f32_32x32x16_bf16 v[16:31], a[128:131], a[96:99], 0
    s_add_u32 m0, s59, 57344
    s_add_u32 s55, s55, 14336
    buffer_load_dwordx4 v14, s[20:23], s55 offen lds
    v_exp_f32 v32, v32
    v_exp_f32 v33, v33
    v_exp_f32 v34, v34
    v_exp_f32 v35, v35
    v_mfma_f32_32x32x16_bf16 a[0:15], a[172:175], v[52:55], a[0:15]
    buffer_load_dwordx4 v15, s[20:23], s55 offen offset:1024 lds
    v_cvt_pk_bf16_f32 v56, v32, v33
    v_exp_f32 v36, v36
    v_exp_f32 v37, v37
    v_cvt_pk_bf16_f32 v57, v34, v35
    v_exp_f32 v38, v38
    v_exp_f32 v39, v39
    v_cvt_pk_bf16_f32 v58, v36, v37
    v_mfma_f32_32x32x16_bf16 v[16:31], a[132:135], a[100:103], v[16:31]
    buffer_load_dwordx4 a[156:159], v2, s[28:31], s70 offen offset:3072 sc1
    s_add_u32 s70, s70, 4096
    v_cvt_pk_bf16_f32 v59, v38, v39
    v_exp_f32 v40, v40
    v_exp_f32 v41, v41
    v_exp_f32 v42, v42
    v_exp_f32 v43, v43
    v_mfma_f32_32x32x16_bf16 v[64:79], a[168:171], v[56:59], v[64:79]
    v_cvt_pk_bf16_f32 v60, v40, v41
    v_exp_f32 v44, v44
    v_exp_f32 v45, v45
    v_cvt_pk_bf16_f32 v61, v42, v43
    v_exp_f32 v46, v46
    v_exp_f32 v47, v47
    v_cvt_pk_bf16_f32 v62, v44, v45
    v_cvt_pk_bf16_f32 v63, v46, v47
    v_mfma_f32_32x32x16_bf16 v[32:47], a[128:131], a[104:107], 0
    s_add_u32 m0, s59, 65536
    s_add_u32 s55, s55, 14336
    buffer_load_dwordx4 v14, s[20:23], s55 offen lds
    v_exp_f32 v16, v16
    v_exp_f32 v17, v17
    v_exp_f32 v18, v18
    v_exp_f32 v19, v19
    v_mfma_f32_32x32x16_bf16 v[64:79], a[172:175], v[60:63], v[64:79]
    buffer_load_dwordx4 v15, s[20:23], s55 offen offset:1024 lds
    v_cvt_pk_bf16_f32 v48, v16, v17
    v_exp_f32 v20, v20
    v_exp_f32 v21, v21
    v_cvt_pk_bf16_f32 v49, v18, v19
    v_exp_f32 v22, v22
    v_exp_f32 v23, v23
    v_cvt_pk_bf16_f32 v50, v20, v21
    v_mfma_f32_32x32x16_bf16 v[32:47], a[132:135], a[108:111], v[32:47]
    buffer_load_dwordx4 a[160:163], v2, s[28:31], s70 offen offset:0 sc1
    v_cvt_pk_bf16_f32 v51, v22, v23
    v_exp_f32 v24, v24
    v_exp_f32 v25, v25
    v_exp_f32 v26, v26
    v_exp_f32 v27, v27
    v_cvt_pk_bf16_f32 v52, v24, v25
    v_mfma_f32_32x32x16_bf16 a[32:47], a[136:139], v[48:51], a[32:47]
    v_exp_f32 v28, v28
    v_exp_f32 v29, v29
    v_cvt_pk_bf16_f32 v53, v26, v27
    v_exp_f32 v30, v30
    v_exp_f32 v31, v31
    v_cvt_pk_bf16_f32 v54, v28, v29
    v_cvt_pk_bf16_f32 v55, v30, v31
    v_mfma_f32_32x32x16_bf16 v[16:31], a[128:131], a[112:115], 0
    s_add_u32 m0, s59, 73728
    s_add_u32 s55, s55, 14336
    buffer_load_dwordx4 v14, s[20:23], s55 offen lds
    v_exp_f32 v32, v32
    v_exp_f32 v33, v33
    v_exp_f32 v34, v34
    v_exp_f32 v35, v35
    v_mfma_f32_32x32x16_bf16 a[32:47], a[140:143], v[52:55], a[32:47]
    buffer_load_dwordx4 v15, s[20:23], s55 offen offset:1024 lds
    v_cvt_pk_bf16_f32 v56, v32, v33
    v_exp_f32 v36, v36
    v_exp_f32 v37, v37
    v_cvt_pk_bf16_f32 v57, v34, v35
    v_exp_f32 v38, v38
    v_exp_f32 v39, v39
    v_cvt_pk_bf16_f32 v58, v36, v37
    v_mfma_f32_32x32x16_bf16 v[16:31], a[132:135], a[116:119], v[16:31]
    buffer_load_dwordx4 a[164:167], v2, s[28:31], s70 offen offset:1024 sc1
    v_cvt_pk_bf16_f32 v59, v38, v39
    v_exp_f32 v40, v40
    v_exp_f32 v41, v41
    v_exp_f32 v42, v42
    v_exp_f32 v43, v43
    v_cvt_pk_bf16_f32 v60, v40, v41
    v_mfma_f32_32x32x16_bf16 a[16:31], a[136:139], v[56:59], a[16:31]
    v_exp_f32 v44, v44
    v_exp_f32 v45, v45
    v_cvt_pk_bf16_f32 v61, v42, v43
    v_exp_f32 v46, v46
    v_exp_f32 v47, v47
    v_cvt_pk_bf16_f32 v62, v44, v45
    v_cvt_pk_bf16_f32 v63, v46, v47
    v_mfma_f32_32x32x16_bf16 v[32:47], a[128:131], a[120:123], 0
    s_add_u32 m0, s59, 81920
    s_add_u32 s55, s55, 14336
    buffer_load_dwordx4 v14, s[20:23], s55 offen lds
    v_exp_f32 v16, v16
    v_exp_f32 v17, v17
    v_exp_f32 v18, v18
    v_exp_f32 v19, v19
    v_mfma_f32_32x32x16_bf16 a[16:31], a[140:143], v[60:63], a[16:31]
    buffer_load_dwordx4 v15, s[20:23], s55 offen offset:1024 lds
    v_cvt_pk_bf16_f32 v48, v16, v17
    v_exp_f32 v20, v20
    v_exp_f32 v21, v21
    v_cvt_pk_bf16_f32 v49, v18, v19
    v_exp_f32 v22, v22
    v_exp_f32 v23, v23
    v_cvt_pk_bf16_f32 v50, v20, v21
    v_mfma_f32_32x32x16_bf16 v[32:47], a[132:135], a[124:127], v[32:47]
    buffer_load_dwordx4 a[168:171], v2, s[28:31], s70 offen offset:2048 sc1
    v_cvt_pk_bf16_f32 v51, v22, v23
    v_exp_f32 v24, v24
    v_exp_f32 v25, v25
    v_exp_f32 v26, v26
    v_exp_f32 v27, v27
    v_cvt_pk_bf16_f32 v52, v24, v25
    v_mfma_f32_32x32x16_bf16 a[0:15], a[136:139], v[48:51], a[0:15]
    v_exp_f32 v28, v28
    v_exp_f32 v29, v29
    v_cvt_pk_bf16_f32 v53, v26, v27
    v_exp_f32 v30, v30
    v_exp_f32 v31, v31
    v_cvt_pk_bf16_f32 v54, v28, v29
    v_cvt_pk_bf16_f32 v55, v30, v31
    s_waitcnt vmcnt(9)
    v_mfma_f32_32x32x16_bf16 v[16:31], a[144:147], a[96:99], 0
    s_add_u32 m0, s59, 90112
    s_add_u32 s55, s55, 14336
    buffer_load_dwordx4 v14, s[20:23], s55 offen lds
    v_exp_f32 v32, v32
    v_exp_f32 v33, v33
    v_exp_f32 v34, v34
    v_exp_f32 v35, v35
    v_mfma_f32_32x32x16_bf16 a[0:15], a[140:143], v[52:55], a[0:15]
    buffer_load_dwordx4 v15, s[20:23], s55 offen offset:1024 lds
    v_cvt_pk_bf16_f32 v56, v32, v33
    v_exp_f32 v36, v36
    v_exp_f32 v37, v37
    v_cvt_pk_bf16_f32 v57, v34, v35
    v_exp_f32 v38, v38
    v_exp_f32 v39, v39
    v_cvt_pk_bf16_f32 v58, v36, v37
    v_mfma_f32_32x32x16_bf16 v[16:31], a[148:151], a[100:103], v[16:31]
    buffer_load_dwordx4 a[172:175], v2, s[28:31], s70 offen offset:3072 sc1
    s_add_u32 s70, s70, 4096
    v_cvt_pk_bf16_f32 v59, v38, v39
    v_exp_f32 v40, v40
    v_exp_f32 v41, v41
    v_exp_f32 v42, v42
    v_exp_f32 v43, v43
    v_mfma_f32_32x32x16_bf16 v[64:79], a[136:139], v[56:59], v[64:79]
    v_cvt_pk_bf16_f32 v60, v40, v41
    v_exp_f32 v44, v44
    v_exp_f32 v45, v45
    v_cvt_pk_bf16_f32 v61, v42, v43
    v_exp_f32 v46, v46
    v_exp_f32 v47, v47
    v_cvt_pk_bf16_f32 v62, v44, v45
    v_cvt_pk_bf16_f32 v63, v46, v47
    v_mfma_f32_32x32x16_bf16 v[32:47], a[144:147], a[104:107], 0
    v_exp_f32 v16, v16
    v_exp_f32 v17, v17
    v_exp_f32 v18, v18
    v_exp_f32 v19, v19
    v_cvt_pk_bf16_f32 v48, v16, v17
    v_exp_f32 v20, v20
    v_mfma_f32_32x32x16_bf16 v[64:79], a[140:143], v[60:63], v[64:79]
    v_exp_f32 v21, v21
    v_cvt_pk_bf16_f32 v49, v18, v19
    v_exp_f32 v22, v22
    v_exp_f32 v23, v23
    v_cvt_pk_bf16_f32 v50, v20, v21
    v_cvt_pk_bf16_f32 v51, v22, v23
    v_mfma_f32_32x32x16_bf16 v[32:47], a[148:151], a[108:111], v[32:47]
    buffer_load_dwordx4 a[128:131], v2, s[28:31], s70 offen offset:0 sc1
    v_exp_f32 v24, v24
    v_exp_f32 v25, v25
    v_exp_f32 v26, v26
    v_exp_f32 v27, v27
    v_cvt_pk_bf16_f32 v52, v24, v25
    v_mfma_f32_32x32x16_bf16 a[32:47], a[152:155], v[48:51], a[32:47]
    v_exp_f32 v28, v28
    v_exp_f32 v29, v29
    v_cvt_pk_bf16_f32 v53, v26, v27
    v_exp_f32 v30, v30
    v_exp_f32 v31, v31
    v_cvt_pk_bf16_f32 v54, v28, v29
    v_cvt_pk_bf16_f32 v55, v30, v31
    v_mfma_f32_32x32x16_bf16 v[16:31], a[144:147], a[112:115], 0
    v_exp_f32 v32, v32
    v_exp_f32 v33, v33
    v_exp_f32 v34, v34
    v_exp_f32 v35, v35
    v_cvt_pk_bf16_f32 v56, v32, v33
    v_exp_f32 v36, v36
    v_mfma_f32_32x32x16_bf16 a[32:47], a[156:159], v[52:55], a[32:47]
    v_exp_f32 v37, v37
    v_cvt_pk_bf16_f32 v57, v34, v35
    v_exp_f32 v38, v38
    v_exp_f32 v39, v39
    v_cvt_pk_bf16_f32 v58, v36, v37
    v_cvt_pk_bf16_f32 v59, v38, v39
    v_mfma_f32_32x32x16_bf16 v[16:31], a[148:151], a[116:119], v[16:31]
    buffer_load_dwordx4 a[132:135], v2, s[28:31], s70 offen offset:1024 sc1
    v_exp_f32 v40, v40
    v_exp_f32 v41, v41
    v_exp_f32 v42, v42
    v_exp_f32 v43, v43
    v_cvt_pk_bf16_f32 v60, v40, v41
    v_mfma_f32_32x32x16_bf16 a[16:31], a[152:155], v[56:59], a[16:31]
    v_exp_f32 v44, v44
    v_exp_f32 v45, v45
    v_cvt_pk_bf16_f32 v61, v42, v43
    v_exp_f32 v46, v46
    v_exp_f32 v47, v47
    v_cvt_pk_bf16_f32 v62, v44, v45
    v_cvt_pk_bf16_f32 v63, v46, v47
    v_mfma_f32_32x32x16_bf16 v[32:47], a[144:147], a[120:123], 0
    buffer_load_dword v12, v8, s[40:43], 0 offen sc1
    v_exp_f32 v16, v16
    v_exp_f32 v17, v17
    v_exp_f32 v18, v18
    v_exp_f32 v19, v19
    v_cvt_pk_bf16_f32 v48, v16, v17
    v_mfma_f32_32x32x16_bf16 a[16:31], a[156:159], v[60:63], a[16:31]
    v_exp_f32 v20, v20
    v_exp_f32 v21, v21
    v_cvt_pk_bf16_f32 v49, v18, v19
    v_exp_f32 v22, v22
    v_exp_f32 v23, v23
    v_cvt_pk_bf16_f32 v50, v20, v21
    v_cvt_pk_bf16_f32 v51, v22, v23
    v_mfma_f32_32x32x16_bf16 v[32:47], a[148:151], a[124:127], v[32:47]
    buffer_load_dwordx4 a[136:139], v2, s[28:31], s70 offen offset:2048 sc1
    v_exp_f32 v24, v24
    v_exp_f32 v25, v25
    v_exp_f32 v26, v26
    v_exp_f32 v27, v27
    v_cvt_pk_bf16_f32 v52, v24, v25
    v_mfma_f32_32x32x16_bf16 a[0:15], a[152:155], v[48:51], a[0:15]
    v_exp_f32 v28, v28
    v_exp_f32 v29, v29
    v_cvt_pk_bf16_f32 v53, v26, v27
    v_exp_f32 v30, v30
    v_exp_f32 v31, v31
    v_cvt_pk_bf16_f32 v54, v28, v29
    v_cvt_pk_bf16_f32 v55, v30, v31
    s_waitcnt vmcnt(4)
    v_mfma_f32_32x32x16_bf16 v[16:31], a[160:163], a[96:99], 0
    v_exp_f32 v32, v32
    v_exp_f32 v33, v33
    v_exp_f32 v34, v34
    v_exp_f32 v35, v35
    v_cvt_pk_bf16_f32 v56, v32, v33
    v_mfma_f32_32x32x16_bf16 a[0:15], a[156:159], v[52:55], a[0:15]
    v_exp_f32 v36, v36
    v_exp_f32 v37, v37
    v_cvt_pk_bf16_f32 v57, v34, v35
    v_exp_f32 v38, v38
    v_exp_f32 v39, v39
    v_cvt_pk_bf16_f32 v58, v36, v37
    v_cvt_pk_bf16_f32 v59, v38, v39
    v_mfma_f32_32x32x16_bf16 v[16:31], a[164:167], a[100:103], v[16:31]
    buffer_load_dwordx4 a[140:143], v2, s[28:31], s70 offen offset:3072 sc1
    s_add_u32 s70, s70, 4096
    v_exp_f32 v40, v40
    v_exp_f32 v41, v41
    v_exp_f32 v42, v42
    v_exp_f32 v43, v43
    v_cvt_pk_bf16_f32 v60, v40, v41
    v_mfma_f32_32x32x16_bf16 v[64:79], a[152:155], v[56:59], v[64:79]
    v_exp_f32 v44, v44
    v_exp_f32 v45, v45
    v_cvt_pk_bf16_f32 v61, v42, v43
    v_exp_f32 v46, v46
    v_exp_f32 v47, v47
    v_cvt_pk_bf16_f32 v62, v44, v45
    v_cvt_pk_bf16_f32 v63, v46, v47
    v_mfma_f32_32x32x16_bf16 v[32:47], a[160:163], a[104:107], 0
    v_exp_f32 v16, v16
    v_exp_f32 v17, v17
    v_exp_f32 v18, v18
    v_exp_f32 v19, v19
    v_cvt_pk_bf16_f32 v48, v16, v17
    v_exp_f32 v20, v20
    v_mfma_f32_32x32x16_bf16 v[64:79], a[156:159], v[60:63], v[64:79]
    v_exp_f32 v21, v21
    v_cvt_pk_bf16_f32 v49, v18, v19
    v_exp_f32 v22, v22
    v_exp_f32 v23, v23
    v_cvt_pk_bf16_f32 v50, v20, v21
    v_cvt_pk_bf16_f32 v51, v22, v23
    v_mfma_f32_32x32x16_bf16 v[32:47], a[164:167], a[108:111], v[32:47]
    buffer_load_dwordx4 a[144:147], v2, s[28:31], s70 offen offset:0 sc1
    v_exp_f32 v24, v24
    v_exp_f32 v25, v25
    v_exp_f32 v26, v26
    v_exp_f32 v27, v27
    v_cvt_pk_bf16_f32 v52, v24, v25
    v_mfma_f32_32x32x16_bf16 a[32:47], a[168:171], v[48:51], a[32:47]
    v_exp_f32 v28, v28
    v_exp_f32 v29, v29
    v_cvt_pk_bf16_f32 v53, v26, v27
    v_exp_f32 v30, v30
    v_exp_f32 v31, v31
    v_cvt_pk_bf16_f32 v54, v28, v29
    v_cvt_pk_bf16_f32 v55, v30, v31
    v_mfma_f32_32x32x16_bf16 v[16:31], a[160:163], a[112:115], 0
    v_exp_f32 v32, v32
    v_exp_f32 v33, v33
    v_exp_f32 v34, v34
    v_exp_f32 v35, v35
    v_cvt_pk_bf16_f32 v56, v32, v33
    v_exp_f32 v36, v36
    v_mfma_f32_32x32x16_bf16 a[32:47], a[172:175], v[52:55], a[32:47]
    v_exp_f32 v37, v37
    v_cvt_pk_bf16_f32 v57, v34, v35
    v_exp_f32 v38, v38
    v_exp_f32 v39, v39
    v_cvt_pk_bf16_f32 v58, v36, v37
    v_cvt_pk_bf16_f32 v59, v38, v39
    v_mfma_f32_32x32x16_bf16 v[16:31], a[164:167], a[116:119], v[16:31]
    buffer_load_dwordx4 a[148:151], v2, s[28:31], s70 offen offset:1024 sc1
    v_exp_f32 v40, v40
    v_exp_f32 v41, v41
    v_exp_f32 v42, v42
    v_exp_f32 v43, v43
    v_cvt_pk_bf16_f32 v60, v40, v41
    v_mfma_f32_32x32x16_bf16 a[16:31], a[168:171], v[56:59], a[16:31]
    v_exp_f32 v44, v44
    v_exp_f32 v45, v45
    v_cvt_pk_bf16_f32 v61, v42, v43
    v_exp_f32 v46, v46
    v_exp_f32 v47, v47
    v_cvt_pk_bf16_f32 v62, v44, v45
    v_cvt_pk_bf16_f32 v63, v46, v47
    v_mfma_f32_32x32x16_bf16 v[32:47], a[160:163], a[120:123], 0
    v_exp_f32 v16, v16
    v_exp_f32 v17, v17
    v_exp_f32 v18, v18
    v_exp_f32 v19, v19
    v_cvt_pk_bf16_f32 v48, v16, v17
    v_exp_f32 v20, v20
    v_mfma_f32_32x32x16_bf16 a[16:31], a[172:175], v[60:63], a[16:31]
    v_exp_f32 v21, v21
    v_cvt_pk_bf16_f32 v49, v18, v19
    v_exp_f32 v22, v22
    v_exp_f32 v23, v23
    v_cvt_pk_bf16_f32 v50, v20, v21
    v_cvt_pk_bf16_f32 v51, v22, v23
    v_mfma_f32_32x32x16_bf16 v[32:47], a[164:167], a[124:127], v[32:47]
    buffer_load_dwordx4 a[152:155], v2, s[28:31], s70 offen offset:2048 sc1
    v_exp_f32 v24, v24
    v_exp_f32 v25, v25
    v_exp_f32 v26, v26
    v_exp_f32 v27, v27
    v_cvt_pk_bf16_f32 v52, v24, v25
    v_mfma_f32_32x32x16_bf16 a[0:15], a[168:171], v[48:51], a[0:15]
    v_exp_f32 v28, v28
    v_exp_f32 v29, v29
    v_cvt_pk_bf16_f32 v53, v26, v27
    v_exp_f32 v30, v30
    v_exp_f32 v31, v31
    v_cvt_pk_bf16_f32 v54, v28, v29
    v_cvt_pk_bf16_f32 v55, v30, v31
    s_waitcnt vmcnt(5)
    v_cmp_ne_u32 vcc, s83, v12
    s_nop 0
    s_cmp_eq_u64 vcc, 0
    s_cbranch_scc1 L_ph_ok
    s_mov_b32 s65, 32768
L_ph_lp:
    s_sleep 8
    buffer_load_dword v12, v8, s[40:43], 0 offen sc1
    s_waitcnt vmcnt(0)
    v_cmp_ne_u32 vcc, s83, v12
    s_nop 0
    s_cmp_eq_u64 vcc, 0
    s_cbranch_scc1 L_ph_ok
    s_sub_u32 s65, s65, 1
    s_cmp_lg_u32 s65, 0
    s_cbranch_scc1 L_ph_lp
L_ph_ok:
    s_waitcnt vmcnt(3)
    v_mfma_f32_32x32x16_bf16 v[16:31], a[128:131], a[96:99], 0
    buffer_load_dwordx4 a[192:195], v4, s[40:43], s81 offen offset:0 sc1
    v_exp_f32 v32, v32
    v_exp_f32 v33, v33
    v_exp_f32 v34, v34
    v_exp_f32 v35, v35
    v_cvt_pk_bf16_f32 v56, v32, v33
    v_mfma_f32_32x32x16_bf16 a[0:15], a[172:175], v[52:55], a[0:15]
    buffer_load_dwordx4 a[196:199], v5, s[40:43], s81 offen offset:0 sc1
    v_exp_f32 v36, v36
    v_exp_f32 v37, v37
    v_cvt_pk_bf16_f32 v57, v34, v35
    v_exp_f32 v38, v38
    v_exp_f32 v39, v39
    v_cvt_pk_bf16_f32 v58, v36, v37
    v_cvt_pk_bf16_f32 v59, v38, v39
    v_mfma_f32_32x32x16_bf16 v[16:31], a[132:135], a[100:103], v[16:31]
    buffer_load_dwordx4 a[156:159], v2, s[28:31], s70 offen offset:3072 sc1
    s_add_u32 s70, s70, 4096
    v_exp_f32 v40, v40
    v_exp_f32 v41, v41
    v_exp_f32 v42, v42
    v_exp_f32 v43, v43
    v_cvt_pk_bf16_f32 v60, v40, v41
    v_mfma_f32_32x32x16_bf16 v[64:79], a[168:171], v[56:59], v[64:79]
    v_exp_f32 v44, v44
    v_exp_f32 v45, v45
    v_cvt_pk_bf16_f32 v61, v42, v43
    v_exp_f32 v46, v46
    v_exp_f32 v47, v47
    v_cvt_pk_bf16_f32 v62, v44, v45
    v_cvt_pk_bf16_f32 v63, v46, v47
    v_mfma_f32_32x32x16_bf16 v[32:47], a[128:131], a[104:107], 0
    buffer_load_dwordx4 a[200:203], v4, s[40:43], s81 offen offset:1024 sc1
    v_exp_f32 v16, v16
    v_exp_f32 v17, v17
    v_exp_f32 v18, v18
    v_exp_f32 v19, v19
    v_cvt_pk_bf16_f32 v48, v16, v17
    v_mfma_f32_32x32x16_bf16 v[64:79], a[172:175], v[60:63], v[64:79]
    buffer_load_dwordx4 a[204:207], v5, s[40:43], s81 offen offset:1024 sc1
    v_exp_f32 v20, v20
    v_exp_f32 v21, v21
    v_cvt_pk_bf16_f32 v49, v18, v19
    v_exp_f32 v22, v22
    v_exp_f32 v23, v23
    v_cvt_pk_bf16_f32 v50, v20, v21
    v_cvt_pk_bf16_f32 v51, v22, v23
    v_mfma_f32_32x32x16_bf16 v[32:47], a[132:135], a[108:111], v[32:47]
    buffer_load_dwordx4 a[160:163], v2, s[28:31], s70 offen offset:0 sc1
    v_exp_f32 v24, v24
    v_exp_f32 v25, v25
    v_exp_f32 v26, v26
    v_exp_f32 v27, v27
    v_cvt_pk_bf16_f32 v52, v24, v25
    v_mfma_f32_32x32x16_bf16 a[32:47], a[136:139], v[48:51], a[32:47]
    v_exp_f32 v28, v28
    v_exp_f32 v29, v29
    v_cvt_pk_bf16_f32 v53, v26, v27
    v_exp_f32 v30, v30
    v_exp_f32 v31, v31
    v_cvt_pk_bf16_f32 v54, v28, v29
    v_cvt_pk_bf16_f32 v55, v30, v31
    v_mfma_f32_32x32x16_bf16 v[16:31], a[128:131], a[112:115], 0
    buffer_load_dwordx4 a[208:211], v4, s[40:43], s81 offen offset:2048 sc1
    v_exp_f32 v32, v32
    v_exp_f32 v33, v33
    v_exp_f32 v34, v34
    v_exp_f32 v35, v35
    v_cvt_pk_bf16_f32 v56, v32, v33
    v_mfma_f32_32x32x16_bf16 a[32:47], a[140:143], v[52:55], a[32:47]
    buffer_load_dwordx4 a[212:215], v5, s[40:43], s81 offen offset:2048 sc1
    v_exp_f32 v36, v36
    v_exp_f32 v37, v37
    v_cvt_pk_bf16_f32 v57, v34, v35
    v_exp_f32 v38, v38
    v_exp_f32 v39, v39
    v_cvt_pk_bf16_f32 v58, v36, v37
    v_cvt_pk_bf16_f32 v59, v38, v39
    v_mfma_f32_32x32x16_bf16 v[16:31], a[132:135], a[116:119], v[16:31]
    buffer_load_dwordx4 a[164:167], v2, s[28:31], s70 offen offset:1024 sc1
    v_exp_f32 v40, v40
    v_exp_f32 v41, v41
    v_exp_f32 v42, v42
    v_exp_f32 v43, v43
    v_cvt_pk_bf16_f32 v60, v40, v41
    v_mfma_f32_32x32x16_bf16 a[16:31], a[136:139], v[56:59], a[16:31]
    v_exp_f32 v44, v44
    v_exp_f32 v45, v45
    v_cvt_pk_bf16_f32 v61, v42, v43
    v_exp_f32 v46, v46
    v_exp_f32 v47, v47
    v_cvt_pk_bf16_f32 v62, v44, v45
    v_cvt_pk_bf16_f32 v63, v46, v47
    v_mfma_f32_32x32x16_bf16 v[32:47], a[128:131], a[120:123], 0
    buffer_load_dwordx4 a[216:219], v4, s[40:43], s81 offen offset:3072 sc1
    v_exp_f32 v16, v16
    v_exp_f32 v17, v17
    v_exp_f32 v18, v18
    v_exp_f32 v19, v19
    v_cvt_pk_bf16_f32 v48, v16, v17
    v_exp_f32 v20, v20
    v_mfma_f32_32x32x16_bf16 a[16:31], a[140:143], v[60:63], a[16:31]
    buffer_load_dwordx4 a[220:223], v5, s[40:43], s81 offen offset:3072 sc1
    s_add_u32 s81, s81, 4096
    v_exp_f32 v21, v21
    v_cvt_pk_bf16_f32 v49, v18, v19
    v_exp_f32 v22, v22
    v_exp_f32 v23, v23
    v_cvt_pk_bf16_f32 v50, v20, v21
    v_mfma_f32_32x32x16_bf16 v[32:47], a[132:135], a[124:127], v[32:47]
    buffer_load_dwordx4 a[168:171], v2, s[28:31], s70 offen offset:2048 sc1
    v_cvt_pk_bf16_f32 v51, v22, v23
    v_exp_f32 v24, v24
    v_exp_f32 v25, v25
    v_exp_f32 v26, v26
    v_exp_f32 v27, v27
    v_cvt_pk_bf16_f32 v52, v24, v25
    v_mfma_f32_32x32x16_bf16 a[0:15], a[136:139], v[48:51], a[0:15]
    v_exp_f32 v28, v28
    v_exp_f32 v29, v29
    v_cvt_pk_bf16_f32 v53, v26, v27
    v_exp_f32 v30, v30
    v_exp_f32 v31, v31
    v_cvt_pk_bf16_f32 v54, v28, v29
    v_cvt_pk_bf16_f32 v55, v30, v31
    s_waitcnt vmcnt(9)
    v_mfma_f32_32x32x16_bf16 v[16:31], a[144:147], a[96:99], 0
    buffer_load_dwordx4 a[224:227], v4, s[40:43], s81 offen offset:0 sc1
    v_exp_f32 v32, v32
    v_exp_f32 v33, v33
    v_exp_f32 v34, v34
    v_exp_f32 v35, v35
    v_cvt_pk_bf16_f32 v56, v32, v33
    v_exp_f32 v36, v36
    v_mfma_f32_32x32x16_bf16 a[0:15], a[140:143], v[52:55], a[0:15]
    buffer_load_dwordx4 a[228:231], v5, s[40:43], s81 offen offset:0 sc1
    v_exp_f32 v37, v37
    v_cvt_pk_bf16_f32 v57, v34, v35
    v_exp_f32 v38, v38
    v_exp_f32 v39, v39
    v_cvt_pk_bf16_f32 v58, v36, v37
    v_cvt_pk_bf16_f32 v59, v38, v39
    v_exp_f32 v40, v40
    v_mfma_f32_32x32x16_bf16 v[16:31], a[148:151], a[100:103], v[16:31]
    buffer_load_dwordx4 a[172:175], v2, s[28:31], s70 offen offset:3072 sc1
    s_add_u32 s70, s70, 4096
    v_exp_f32 v41, v41
    v_exp_f32 v42, v42
    v_exp_f32 v43, v43
    v_cvt_pk_bf16_f32 v60, v40, v41
    v_exp_f32 v44, v44
    v_exp_f32 v45, v45
    v_mfma_f32_32x32x16_bf16 v[64:79], a[136:139], v[56:59], v[64:79]
    ds_read_b64_tr_b16 a[176:177], v6 offset:32768
    ds_read_b64_tr_b16 a[178:179], v6 offset:33792
    ds_read_b64_tr_b16 a[180:181], v7 offset:32768
    ds_read_b64_tr_b16 a[182:183], v7 offset:33792
    v_cvt_pk_bf16_f32 v61, v42, v43
    v_exp_f32 v46, v46
    v_exp_f32 v47, v47
    v_cvt_pk_bf16_f32 v62, v44, v45
    v_cvt_pk_bf16_f32 v63, v46, v47
    v_mfma_f32_32x32x16_bf16 v[32:47], a[144:147], a[104:107], 0
    v_exp_f32 v16, v16
    v_exp_f32 v17, v17
    v_exp_f32 v18, v18
    v_exp_f32 v19, v19
    v_mfma_f32_32x32x16_bf16 v[64:79], a[140:143], v[60:63], v[64:79]
    v_cvt_pk_bf16_f32 v48, v16, v17
    v_exp_f32 v20, v20
    v_exp_f32 v21, v21
    v_cvt_pk_bf16_f32 v49, v18, v19
    v_exp_f32 v22, v22
    v_mfma_f32_32x32x16_bf16 v[32:47], a[148:151], a[108:111], v[32:47]
    buffer_load_dwordx4 a[128:131], v2, s[28:31], s70 offen offset:0 sc1
    v_exp_f32 v23, v23
    v_cvt_pk_bf16_f32 v50, v20, v21
    v_cvt_pk_bf16_f32 v51, v22, v23
    v_exp_f32 v24, v24
    s_waitcnt lgkmcnt(0)
    v_mfma_f32_32x32x16_bf16 v[80:95], a[176:179], a[192:195], 0
    ds_read_b64_tr_b16 a[184:185], v6 offset:40960
    ds_read_b64_tr_b16 a[186:187], v6 offset:41984
    v_exp_f32 v25, v25
    v_exp_f32 v26, v26
    v_mfma_f32_32x32x16_bf16 a[32:47], a[152:155], v[48:51], a[32:47]
    v_exp_f32 v27, v27
    v_cvt_pk_bf16_f32 v52, v24, v25
    v_exp_f32 v28, v28
    v_exp_f32 v29, v29
    v_mfma_f32_32x32x16_bf16 a[48:63], a[180:183], a[192:195], 0
    buffer_load_dwordx4 a[232:235], v4, s[40:43], s81 offen offset:1024 sc1
    v_cvt_pk_bf16_f32 v53, v26, v27
    v_exp_f32 v30, v30
    v_exp_f32 v31, v31
    v_cvt_pk_bf16_f32 v54, v28, v29
    v_cvt_pk_bf16_f32 v55, v30, v31
    v_mfma_f32_32x32x16_bf16 v[16:31], a[144:147], a[112:115], 0
    v_exp_f32 v32, v32
    v_exp_f32 v33, v33
    v_exp_f32 v34, v34
    v_exp_f32 v35, v35
    v_mfma_f32_32x32x16_bf16 a[32:47], a[156:159], v[52:55], a[32:47]
    v_cvt_pk_bf16_f32 v56, v32, v33
    v_exp_f32 v36, v36
    v_exp_f32 v37, v37
    v_cvt_pk_bf16_f32 v57, v34, v35
    v_exp_f32 v38, v38
    v_mfma_f32_32x32x16_bf16 v[16:31], a[148:151], a[116:119], v[16:31]
    buffer_load_dwordx4 a[132:135], v2, s[28:31], s70 offen offset:1024 sc1
    v_exp_f32 v39, v39
    v_cvt_pk_bf16_f32 v58, v36, v37
    v_cvt_pk_bf16_f32 v59, v38, v39
    v_mfma_f32_32x32x16_bf16 a[64:79], a[176:179], a[196:199], 0
    ds_read_b64_tr_b16 a[188:189], v7 offset:40960
    ds_read_b64_tr_b16 a[190:191], v7 offset:41984
    v_exp_f32 v40, v40
    v_exp_f32 v41, v41
    v_exp_f32 v42, v42
    v_mfma_f32_32x32x16_bf16 a[16:31], a[152:155], v[56:59], a[16:31]
    v_exp_f32 v43, v43
    v_cvt_pk_bf16_f32 v60, v40, v41
    v_exp_f32 v44, v44
    v_exp_f32 v45, v45
    v_cvt_pk_bf16_f32 v61, v42, v43
    v_mfma_f32_32x32x16_bf16 a[80:95], a[180:183], a[196:199], 0
    buffer_load_dwordx4 a[236:239], v5, s[40:43], s81 offen offset:1024 sc1
    v_exp_f32 v46, v46
    v_exp_f32 v47, v47
    v_cvt_pk_bf16_f32 v62, v44, v45
    v_cvt_pk_bf16_f32 v63, v46, v47
    v_mfma_f32_32x32x16_bf16 v[32:47], a[144:147], a[120:123], 0
    s_add_u32 m0, s59, 98304
    s_add_u32 s55, s55, 14336
    buffer_load_dwordx4 v14, s[20:23], s55 offen lds
    v_exp_f32 v16, v16
    v_exp_f32 v17, v17
    v_exp_f32 v18, v18
    v_mfma_f32_32x32x16_bf16 a[16:31], a[156:159], v[60:63], a[16:31]
    buffer_load_dwordx4 v15, s[20:23], s55 offen offset:1024 lds
    v_exp_f32 v19, v19
    v_cvt_pk_bf16_f32 v48, v16, v17
    v_exp_f32 v20, v20
    v_exp_f32 v21, v21
    v_mfma_f32_32x32x16_bf16 v[32:47], a[148:151], a[124:127], v[32:47]
    buffer_load_dwordx4 a[136:139], v2, s[28:31], s70 offen offset:2048 sc1
    v_cvt_pk_bf16_f32 v49, v18, v19
    v_exp_f32 v22, v22
    v_exp_f32 v23, v23
    v_cvt_pk_bf16_f32 v50, v20, v21
    s_waitcnt vmcnt(18) lgkmcnt(0)
    v_mfma_f32_32x32x16_bf16 v[80:95], a[184:187], a[200:203], v[80:95]
    ds_read_b64_tr_b16 a[176:177], v6 offset:49152
    ds_read_b64_tr_b16 a[178:179], v6 offset:50176
    v_cvt_pk_bf16_f32 v51, v22, v23
    v_exp_f32 v24, v24
    v_exp_f32 v25, v25
    v_mfma_f32_32x32x16_bf16 a[0:15], a[152:155], v[48:51], a[0:15]
    v_exp_f32 v26, v26
    v_exp_f32 v27, v27
    v_cvt_pk_bf16_f32 v52, v24, v25
    v_exp_f32 v28, v28
    v_exp_f32 v29, v29
    v_mfma_f32_32x32x16_bf16 a[48:63], a[188:191], a[200:203], a[48:63]
    buffer_load_dwordx4 a[192:195], v4, s[40:43], s81 offen offset:2048 sc1
    v_cvt_pk_bf16_f32 v53, v26, v27
    v_exp_f32 v30, v30
    v_exp_f32 v31, v31
    v_cvt_pk_bf16_f32 v54, v28, v29
    v_cvt_pk_bf16_f32 v55, v30, v31
    s_waitcnt vmcnt(8)
    v_mfma_f32_32x32x16_bf16 v[16:31], a[160:163], a[96:99], 0
    v_exp_f32 v32, v32
    v_exp_f32 v33, v33
    v_exp_f32 v34, v34
    v_mfma_f32_32x32x16_bf16 a[0:15], a[156:159], v[52:55], a[0:15]
    v_exp_f32 v35, v35
    v_cvt_pk_bf16_f32 v56, v32, v33
    v_exp_f32 v36, v36
    v_exp_f32 v37, v37
    v_cvt_pk_bf16_f32 v57, v34, v35
    v_mfma_f32_32x32x16_bf16 v[16:31], a[164:167], a[100:103], v[16:31]
    buffer_load_dwordx4 a[140:143], v2, s[28:31], s70 offen offset:3072 sc1
    s_add_u32 s70, s70, 4096
    v_exp_f32 v38, v38
    v_exp_f32 v39, v39
    v_cvt_pk_bf16_f32 v58, v36, v37
    v_cvt_pk_bf16_f32 v59, v38, v39
    v_mfma_f32_32x32x16_bf16 a[64:79], a[184:187], a[204:207], a[64:79]
    ds_read_b64_tr_b16 a[180:181], v7 offset:49152
    ds_read_b64_tr_b16 a[182:183], v7 offset:50176
    v_exp_f32 v40, v40
    v_exp_f32 v41, v41
    v_exp_f32 v42, v42
    v_mfma_f32_32x32x16_bf16 v[64:79], a[152:155], v[56:59], v[64:79]
    v_exp_f32 v43, v43
    v_cvt_pk_bf16_f32 v60, v40, v41
    v_exp_f32 v44, v44
    v_exp_f32 v45, v45
    v_mfma_f32_32x32x16_bf16 a[80:95], a[188:191], a[204:207], a[80:95]
    buffer_load_dwordx4 a[196:199], v5, s[40:43], s81 offen offset:2048 sc1
    v_cvt_pk_bf16_f32 v61, v42, v43
    v_exp_f32 v46, v46
    v_exp_f32 v47, v47
    v_cvt_pk_bf16_f32 v62, v44, v45
    v_cvt_pk_bf16_f32 v63, v46, v47
    v_mfma_f32_32x32x16_bf16 v[32:47], a[160:163], a[104:107], 0
    v_exp_f32 v16, v16
    v_exp_f32 v17, v17
    v_exp_f32 v18, v18
    v_exp_f32 v19, v19
    v_mfma_f32_32x32x16_bf16 v[64:79], a[156:159], v[60:63], v[64:79]
    v_cvt_pk_bf16_f32 v48, v16, v17
    v_exp_f32 v20, v20
    v_exp_f32 v21, v21
    v_cvt_pk_bf16_f32 v49, v18, v19
    v_exp_f32 v22, v22
    v_mfma_f32_32x32x16_bf16 v[32:47], a[164:167], a[108:111], v[32:47]
    buffer_load_dwordx4 a[144:147], v2, s[28:31], s70 offen offset:0 sc1
    v_exp_f32 v23, v23
    v_cvt_pk_bf16_f32 v50, v20, v21
    v_cvt_pk_bf16_f32 v51, v22, v23
    v_exp_f32 v24, v24
    s_waitcnt lgkmcnt(0)
    v_mfma_f32_32x32x16_bf16 v[80:95], a[176:179], a[208:211], v[80:95]
    ds_read_b64_tr_b16 a[184:185], v6 offset:57344
    ds_read_b64_tr_b16 a[186:187], v6 offset:58368
    v_exp_f32 v25, v25
    v_exp_f32 v26, v26
    v_mfma_f32_32x32x16_bf16 a[32:47], a[168:171], v[48:51], a[32:47]
    v_exp_f32 v27, v27
    v_cvt_pk_bf16_f32 v52, v24, v25
    v_exp_f32 v28, v28
    v_exp_f32 v29, v29
    v_mfma_f32_32x32x16_bf16 a[48:63], a[180:183], a[208:211], a[48:63]
    buffer_load_dwordx4 a[200:203], v4, s[40:43], s81 offen offset:3072 sc1
    v_cvt_pk_bf16_f32 v53, v26, v27
    v_exp_f32 v30, v30
    v_exp_f32 v31, v31
    v_cvt_pk_bf16_f32 v54, v28, v29
    v_cvt_pk_bf16_f32 v55, v30, v31
    v_mfma_f32_32x32x16_bf16 v[16:31], a[160:163], a[112:115], 0
    s_add_u32 m0, s59, 106496
    s_add_u32 s55, s55, 14336
    buffer_load_dwordx4 v14, s[20:23], s55 offen lds
    v_exp_f32 v32, v32
    v_exp_f32 v33, v33
    v_exp_f32 v34, v34
    v_mfma_f32_32x32x16_bf16 a[32:47], a[172:175], v[52:55], a[32:47]
    buffer_load_dwordx4 v15, s[20:23], s55 offen offset:1024 lds
    v_exp_f32 v35, v35
    v_cvt_pk_bf16_f32 v56, v32, v33
    v_exp_f32 v36, v36
    v_exp_f32 v37, v37
    v_mfma_f32_32x32x16_bf16 v[16:31], a[164:167], a[116:119], v[16:31]
    buffer_load_dwordx4 a[148:151], v2, s[28:31], s70 offen offset:1024 sc1
    v_cvt_pk_bf16_f32 v57, v34, v35
    v_exp_f32 v38, v38
    v_exp_f32 v39, v39
    v_cvt_pk_bf16_f32 v58, v36, v37
    v_mfma_f32_32x32x16_bf16 a[64:79], a[176:179], a[212:215], a[64:79]
    ds_read_b64_tr_b16 a[188:189], v7 offset:57344
    ds_read_b64_tr_b16 a[190:191], v7 offset:58368
    v_cvt_pk_bf16_f32 v59, v38, v39
    v_exp_f32 v40, v40
    v_exp_f32 v41, v41
    v_exp_f32 v42, v42
    v_mfma_f32_32x32x16_bf16 a[16:31], a[168:171], v[56:59], a[16:31]
    v_exp_f32 v43, v43
    v_cvt_pk_bf16_f32 v60, v40, v41
    v_exp_f32 v44, v44
    v_exp_f32 v45, v45
    v_cvt_pk_bf16_f32 v61, v42, v43
    v_mfma_f32_32x32x16_bf16 a[80:95], a[180:183], a[212:215], a[80:95]
    buffer_load_dwordx4 a[204:207], v5, s[40:43], s81 offen offset:3072 sc1
    s_add_u32 s81, s81, 4096
    v_exp_f32 v46, v46
    v_exp_f32 v47, v47
    v_cvt_pk_bf16_f32 v62, v44, v45
    v_cvt_pk_bf16_f32 v63, v46, v47
    v_mfma_f32_32x32x16_bf16 v[32:47], a[160:163], a[120:123], 0
    v_exp_f32 v16, v16
    v_exp_f32 v17, v17
    v_exp_f32 v18, v18
    v_exp_f32 v19, v19
    v_mfma_f32_32x32x16_bf16 a[16:31], a[172:175], v[60:63], a[16:31]
    v_cvt_pk_bf16_f32 v48, v16, v17
    v_exp_f32 v20, v20
    v_exp_f32 v21, v21
    v_cvt_pk_bf16_f32 v49, v18, v19
    v_exp_f32 v22, v22
    v_mfma_f32_32x32x16_bf16 v[32:47], a[164:167], a[124:127], v[32:47]
    buffer_load_dwordx4 a[152:155], v2, s[28:31], s70 offen offset:2048 sc1
    v_exp_f32 v23, v23
    v_cvt_pk_bf16_f32 v50, v20, v21
    v_cvt_pk_bf16_f32 v51, v22, v23
    v_exp_f32 v24, v24
    s_waitcnt lgkmcnt(0)
    v_mfma_f32_32x32x16_bf16 v[80:95], a[184:187], a[216:219], v[80:95]
    v_add_u32 v6, 0x10000, v6
    v_add_u32 v7, 0x10000, v7
    ds_read_b64_tr_b16 a[176:177], v6 offset:0
    ds_read_b64_tr_b16 a[178:179], v6 offset:1024
    v_exp_f32 v25, v25
    v_exp_f32 v26, v26
    v_mfma_f32_32x32x16_bf16 a[0:15], a[168:171], v[48:51], a[0:15]
    v_exp_f32 v27, v27
    v_cvt_pk_bf16_f32 v52, v24, v25
    v_exp_f32 v28, v28
    v_exp_f32 v29, v29
    v_mfma_f32_32x32x16_bf16 a[48:63], a[188:191], a[216:219], a[48:63]
    buffer_load_dwordx4 a[208:211], v4, s[40:43], s81 offen offset:0 sc1
    v_cvt_pk_bf16_f32 v53, v26, v27
    v_exp_f32 v30, v30
    v_exp_f32 v31, v31
    v_cvt_pk_bf16_f32 v54, v28, v29
    v_cvt_pk_bf16_f32 v55, v30, v31
    s_waitcnt vmcnt(9)
    v_mfma_f32_32x32x16_bf16 v[16:31], a[128:131], a[96:99], 0
    v_exp_f32 v32, v32
    v_exp_f32 v33, v33
    v_exp_f32 v34, v34
    v_mfma_f32_32x32x16_bf16 a[0:15], a[172:175], v[52:55], a[0:15]
    v_exp_f32 v35, v35
    v_cvt_pk_bf16_f32 v56, v32, v33
    v_exp_f32 v36, v36
    v_exp_f32 v37, v37
    v_cvt_pk_bf16_f32 v57, v34, v35
    v_mfma_f32_32x32x16_bf16 v[16:31], a[132:135], a[100:103], v[16:31]
    buffer_load_dwordx4 a[156:159], v2, s[28:31], s70 offen offset:3072 sc1
    s_add_u32 s70, s70, 4096
    v_exp_f32 v38, v38
    v_exp_f32 v39, v39
    v_cvt_pk_bf16_f32 v58, v36, v37
    v_cvt_pk_bf16_f32 v59, v38, v39
    v_mfma_f32_32x32x16_bf16 a[64:79], a[184:187], a[220:223], a[64:79]
    ds_read_b64_tr_b16 a[180:181], v7 offset:0
    ds_read_b64_tr_b16 a[182:183], v7 offset:1024
    v_exp_f32 v40, v40
    v_exp_f32 v41, v41
    v_exp_f32 v42, v42
    v_mfma_f32_32x32x16_bf16 v[64:79], a[168:171], v[56:59], v[64:79]
    v_exp_f32 v43, v43
    v_cvt_pk_bf16_f32 v60, v40, v41
    v_exp_f32 v44, v44
    v_exp_f32 v45, v45
    v_mfma_f32_32x32x16_bf16 a[80:95], a[188:191], a[220:223], a[80:95]
    buffer_load_dwordx4 a[212:215], v5, s[40:43], s81 offen offset:0 sc1
    v_cvt_pk_bf16_f32 v61, v42, v43
    v_exp_f32 v46, v46
    v_exp_f32 v47, v47
    v_cvt_pk_bf16_f32 v62, v44, v45
    v_cvt_pk_bf16_f32 v63, v46, v47
    v_mfma_f32_32x32x16_bf16 v[32:47], a[128:131], a[104:107], 0
    s_add_u32 m0, s59, 114688
    s_add_u32 s55, s55, 14336
    buffer_load_dwordx4 v14, s[20:23], s55 offen lds
    v_exp_f32 v16, v16
    v_exp_f32 v17, v17
    v_exp_f32 v18, v18
    v_mfma_f32_32x32x16_bf16 v[64:79], a[172:175], v[60:63], v[64:79]
    buffer_load_dwordx4 v15, s[20:23], s55 offen offset:1024 lds
    v_exp_f32 v19, v19
    v_cvt_pk_bf16_f32 v48, v16, v17
    v_exp_f32 v20, v20
    v_exp_f32 v21, v21
    v_mfma_f32_32x32x16_bf16 v[32:47], a[132:135], a[108:111], v[32:47]
    buffer_load_dwordx4 a[160:163], v2, s[28:31], s70 offen offset:0 sc1
    v_cvt_pk_bf16_f32 v49, v18, v19
    v_exp_f32 v22, v22
    v_exp_f32 v23, v23
    v_cvt_pk_bf16_f32 v50, v20, v21
    s_waitcnt lgkmcnt(0)
    v_mfma_f32_32x32x16_bf16 v[80:95], a[176:179], a[224:227], v[80:95]
    ds_read_b64_tr_b16 a[184:185], v6 offset:8192
    ds_read_b64_tr_b16 a[186:187], v6 offset:9216
    v_cvt_pk_bf16_f32 v51, v22, v23
    v_exp_f32 v24, v24
    v_exp_f32 v25, v25
    v_mfma_f32_32x32x16_bf16 a[32:47], a[136:139], v[48:51], a[32:47]
    v_exp_f32 v26, v26
    v_exp_f32 v27, v27
    v_cvt_pk_bf16_f32 v52, v24, v25
    v_exp_f32 v28, v28
    v_exp_f32 v29, v29
    v_mfma_f32_32x32x16_bf16 a[48:63], a[180:183], a[224:227], a[48:63]
    buffer_load_dwordx4 a[216:219], v4, s[40:43], s81 offen offset:1024 sc1
    v_cvt_pk_bf16_f32 v53, v26, v27
    v_exp_f32 v30, v30
    v_exp_f32 v31, v31
    v_cvt_pk_bf16_f32 v54, v28, v29
    v_cvt_pk_bf16_f32 v55, v30, v31
    v_mfma_f32_32x32x16_bf16 v[16:31], a[128:131], a[112:115], 0
    v_exp_f32 v32, v32
    v_exp_f32 v33, v33
    v_exp_f32 v34, v34
    v_exp_f32 v35, v35
    v_mfma_f32_32x32x16_bf16 a[32:47], a[140:143], v[52:55], a[32:47]
    v_cvt_pk_bf16_f32 v56, v32, v33
    v_exp_f32 v36, v36
    v_exp_f32 v37, v37
    v_cvt_pk_bf16_f32 v57, v34, v35
    v_exp_f32 v38, v38
    v_mfma_f32_32x32x16_bf16 v[16:31], a[132:135], a[116:119], v[16:31]
    buffer_load_dwordx4 a[164:167], v2, s[28:31], s70 offen offset:1024 sc1
    v_exp_f32 v39, v39
    v_cvt_pk_bf16_f32 v58, v36, v37
    v_cvt_pk_bf16_f32 v59, v38, v39
    v_mfma_f32_32x32x16_bf16 a[64:79], a[176:179], a[228:231], a[64:79]
    ds_read_b64_tr_b16 a[188:189], v7 offset:8192
    ds_read_b64_tr_b16 a[190:191], v7 offset:9216
    v_exp_f32 v40, v40
    v_exp_f32 v41, v41
    v_exp_f32 v42, v42
    v_mfma_f32_32x32x16_bf16 a[16:31], a[136:139], v[56:59], a[16:31]
    v_exp_f32 v43, v43
    v_cvt_pk_bf16_f32 v60, v40, v41
    v_exp_f32 v44, v44
    v_exp_f32 v45, v45
    v_cvt_pk_bf16_f32 v61, v42, v43
    v_mfma_f32_32x32x16_bf16 a[80:95], a[180:183], a[228:231], a[80:95]
    buffer_load_dwordx4 a[220:223], v5, s[40:43], s81 offen offset:1024 sc1
    v_exp_f32 v46, v46
    v_exp_f32 v47, v47
    v_cvt_pk_bf16_f32 v62, v44, v45
    v_cvt_pk_bf16_f32 v63, v46, v47
    v_mfma_f32_32x32x16_bf16 v[32:47], a[128:131], a[120:123], 0
    v_exp_f32 v16, v16
    v_exp_f32 v17, v17
    v_exp_f32 v18, v18
    v_exp_f32 v19, v19
    v_mfma_f32_32x32x16_bf16 a[16:31], a[140:143], v[60:63], a[16:31]
    v_cvt_pk_bf16_f32 v48, v16, v17
    v_exp_f32 v20, v20
    v_exp_f32 v21, v21
    v_cvt_pk_bf16_f32 v49, v18, v19
    v_exp_f32 v22, v22
    v_mfma_f32_32x32x16_bf16 v[32:47], a[132:135], a[124:127], v[32:47]
    buffer_load_dwordx4 a[168:171], v2, s[28:31], s70 offen offset:2048 sc1
    v_exp_f32 v23, v23
    v_cvt_pk_bf16_f32 v50, v20, v21
    v_cvt_pk_bf16_f32 v51, v22, v23
    v_exp_f32 v24, v24
    s_waitcnt lgkmcnt(0)
    v_mfma_f32_32x32x16_bf16 v[80:95], a[184:187], a[232:235], v[80:95]
    ds_read_b64_tr_b16 a[176:177], v6 offset:16384
    ds_read_b64_tr_b16 a[178:179], v6 offset:17408
    v_exp_f32 v25, v25
    v_exp_f32 v26, v26
    v_mfma_f32_32x32x16_bf16 a[0:15], a[136:139], v[48:51], a[0:15]
    v_exp_f32 v27, v27
    v_cvt_pk_bf16_f32 v52, v24, v25
    v_exp_f32 v28, v28
    v_exp_f32 v29, v29
    v_mfma_f32_32x32x16_bf16 a[48:63], a[188:191], a[232:235], a[48:63]
    buffer_load_dwordx4 a[224:227], v4, s[40:43], s81 offen offset:2048 sc1
    v_cvt_pk_bf16_f32 v53, v26, v27
    v_exp_f32 v30, v30
    v_exp_f32 v31, v31
    v_cvt_pk_bf16_f32 v54, v28, v29
    v_cvt_pk_bf16_f32 v55, v30, v31
    s_waitcnt vmcnt(9)
    v_mfma_f32_32x32x16_bf16 v[16:31], a[144:147], a[96:99], 0
    s_add_u32 m0, s59, 122880
    s_add_u32 s55, s55, 14336
    buffer_load_dwordx4 v14, s[20:23], s55 offen lds
    v_exp_f32 v32, v32
    v_exp_f32 v33, v33
    v_mfma_f32_32x32x16_bf16 a[0:15], a[140:143], v[52:55], a[0:15]
    buffer_load_dwordx4 v15, s[20:23], s55 offen offset:1024 lds
    v_exp_f32 v34, v34
    v_exp_f32 v35, v35
    v_cvt_pk_bf16_f32 v56, v32, v33
    v_exp_f32 v36, v36
    v_exp_f32 v37, v37
    v_mfma_f32_32x32x16_bf16 v[16:31], a[148:151], a[100:103], v[16:31]
    buffer_load_dwordx4 a[172:175], v2, s[28:31], s70 offen offset:3072 sc1
    s_add_u32 s70, s70, 4096
    v_cvt_pk_bf16_f32 v57, v34, v35
    v_exp_f32 v38, v38
    v_exp_f32 v39, v39
    v_mfma_f32_32x32x16_bf16 a[64:79], a[184:187], a[236:239], a[64:79]
    ds_read_b64_tr_b16 a[180:181], v7 offset:16384
    ds_read_b64_tr_b16 a[182:183], v7 offset:17408
    v_cvt_pk_bf16_f32 v58, v36, v37
    v_cvt_pk_bf16_f32 v59, v38, v39
    v_exp_f32 v40, v40
    v_exp_f32 v41, v41
    v_mfma_f32_32x32x16_bf16 v[64:79], a[136:139], v[56:59], v[64:79]
    v_exp_f32 v42, v42
    v_exp_f32 v43, v43
    v_cvt_pk_bf16_f32 v60, v40, v41
    v_exp_f32 v44, v44
    v_exp_f32 v45, v45
    v_mfma_f32_32x32x16_bf16 a[80:95], a[188:191], a[236:239], a[80:95]
    buffer_load_dwordx4 a[228:231], v5, s[40:43], s81 offen offset:2048 sc1
    v_cvt_pk_bf16_f32 v61, v42, v43
    v_exp_f32 v46, v46
    v_exp_f32 v47, v47
    v_cvt_pk_bf16_f32 v62, v44, v45
    v_cvt_pk_bf16_f32 v63, v46, v47
    v_mfma_f32_32x32x16_bf16 v[32:47], a[144:147], a[104:107], 0
    v_exp_f32 v16, v16
    v_exp_f32 v17, v17
    v_exp_f32 v18, v18
    v_exp_f32 v19, v19
    v_mfma_f32_32x32x16_bf16 v[64:79], a[140:143], v[60:63], v[64:79]
    v_cvt_pk_bf16_f32 v48, v16, v17
    v_exp_f32 v20, v20
    v_exp_f32 v21, v21
    v_cvt_pk_bf16_f32 v49, v18, v19
    v_exp_f32 v22, v22
    v_mfma_f32_32x32x16_bf16 v[32:47], a[148:151], a[108:111], v[32:47]
    buffer_load_dwordx4 a[128:131], v2, s[28:31], s70 offen offset:0 sc1
    v_exp_f32 v23, v23
    v_cvt_pk_bf16_f32 v50, v20, v21
    v_cvt_pk_bf16_f32 v51, v22, v23
    v_exp_f32 v24, v24
    s_waitcnt lgkmcnt(0)
    v_mfma_f32_32x32x16_bf16 v[80:95], a[176:179], a[192:195], v[80:95]
    ds_read_b64_tr_b16 a[184:185], v6 offset:24576
    ds_read_b64_tr_b16 a[186:187], v6 offset:25600
    v_exp_f32 v25, v25
    v_exp_f32 v26, v26
    v_mfma_f32_32x32x16_bf16 a[32:47], a[152:155], v[48:51], a[32:47]
    v_exp_f32 v27, v27
    v_cvt_pk_bf16_f32 v52, v24, v25
    v_exp_f32 v28, v28
    v_exp_f32 v29, v29
    v_mfma_f32_32x32x16_bf16 a[48:63], a[180:183], a[192:195], a[48:63]
    buffer_load_dwordx4 a[232:235], v4, s[40:43], s81 offen offset:3072 sc1
    v_cvt_pk_bf16_f32 v53, v26, v27
    v_exp_f32 v30, v30
    v_exp_f32 v31, v31
    v_cvt_pk_bf16_f32 v54, v28, v29
    v_cvt_pk_bf16_f32 v55, v30, v31
    v_mfma_f32_32x32x16_bf16 v[16:31], a[144:147], a[112:115], 0
    v_exp_f32 v32, v32
    v_exp_f32 v33, v33
    v_exp_f32 v34, v34
    v_exp_f32 v35, v35
    v_mfma_f32_32x32x16_bf16 a[32:47], a[156:159], v[52:55], a[32:47]
    v_cvt_pk_bf16_f32 v56, v32, v33
    v_exp_f32 v36, v36
    v_exp_f32 v37, v37
    v_cvt_pk_bf16_f32 v57, v34, v35
    v_exp_f32 v38, v38
    v_mfma_f32_32x32x16_bf16 v[16:31], a[148:151], a[116:119], v[16:31]
    buffer_load_dwordx4 a[132:135], v2, s[28:31], s70 offen offset:1024 sc1
    v_exp_f32 v39, v39
    v_cvt_pk_bf16_f32 v58, v36, v37
    v_cvt_pk_bf16_f32 v59, v38, v39
    v_exp_f32 v40, v40
    v_mfma_f32_32x32x16_bf16 a[64:79], a[176:179], a[196:199], a[64:79]
    ds_read_b64_tr_b16 a[188:189], v7 offset:24576
    ds_read_b64_tr_b16 a[190:191], v7 offset:25600
    v_exp_f32 v41, v41
    v_exp_f32 v42, v42
    v_mfma_f32_32x32x16_bf16 a[16:31], a[152:155], v[56:59], a[16:31]
    v_exp_f32 v43, v43
    v_cvt_pk_bf16_f32 v60, v40, v41
    v_exp_f32 v44, v44
    v_exp_f32 v45, v45
    v_cvt_pk_bf16_f32 v61, v42, v43
    v_mfma_f32_32x32x16_bf16 a[80:95], a[180:183], a[196:199], a[80:95]
    buffer_load_dwordx4 a[236:239], v5, s[40:43], s81 offen offset:3072 sc1
    s_add_u32 s81, s81, 4096
    v_exp_f32 v46, v46
    v_exp_f32 v47, v47
    v_cvt_pk_bf16_f32 v62, v44, v45
    v_cvt_pk_bf16_f32 v63, v46, v47
    v_mfma_f32_32x32x16_bf16 v[32:47], a[144:147], a[120:123], 0
    s_add_u32 m0, s59, 131072
    s_add_u32 s55, s55, 14336
    buffer_load_dwordx4 v14, s[20:23], s55 offen lds
    v_exp_f32 v16, v16
    v_exp_f32 v17, v17
    v_exp_f32 v18, v18
    v_mfma_f32_32x32x16_bf16 a[16:31], a[156:159], v[60:63], a[16:31]
    buffer_load_dwordx4 v15, s[20:23], s55 offen offset:1024 lds
    v_exp_f32 v19, v19
    v_cvt_pk_bf16_f32 v48, v16, v17
    v_exp_f32 v20, v20
    v_exp_f32 v21, v21
    v_mfma_f32_32x32x16_bf16 v[32:47], a[148:151], a[124:127], v[32:47]
    buffer_load_dwordx4 a[136:139], v2, s[28:31], s70 offen offset:2048 sc1
    v_cvt_pk_bf16_f32 v49, v18, v19
    v_exp_f32 v22, v22
    v_exp_f32 v23, v23
    v_cvt_pk_bf16_f32 v50, v20, v21
    v_cvt_pk_bf16_f32 v51, v22, v23
    s_waitcnt lgkmcnt(0)
    v_mfma_f32_32x32x16_bf16 v[80:95], a[184:187], a[200:203], v[80:95]
    v_add_u32 v6, 0xfffe0000, v6
    v_add_u32 v7, 0xfffe0000, v7
    ds_read_b64_tr_b16 a[176:177], v6 offset:0
    ds_read_b64_tr_b16 a[178:179], v6 offset:1024
    v_exp_f32 v24, v24
    v_exp_f32 v25, v25
    v_mfma_f32_32x32x16_bf16 a[0:15], a[152:155], v[48:51], a[0:15]
    v_exp_f32 v26, v26
    v_exp_f32 v27, v27
    v_cvt_pk_bf16_f32 v52, v24, v25
    v_exp_f32 v28, v28
    v_exp_f32 v29, v29
    v_mfma_f32_32x32x16_bf16 a[48:63], a[188:191], a[200:203], a[48:63]
    buffer_load_dwordx4 a[192:195], v4, s[40:43], s81 offen offset:0 sc1
    v_cvt_pk_bf16_f32 v53, v26, v27
    v_exp_f32 v30, v30
    v_exp_f32 v31, v31
    v_cvt_pk_bf16_f32 v54, v28, v29
    v_cvt_pk_bf16_f32 v55, v30, v31
    s_waitcnt vmcnt(9)
    v_mfma_f32_32x32x16_bf16 v[16:31], a[160:163], a[96:99], 0
    v_exp_f32 v32, v32
    v_exp_f32 v33, v33
    v_exp_f32 v34, v34
    v_mfma_f32_32x32x16_bf16 a[0:15], a[156:159], v[52:55], a[0:15]
    v_exp_f32 v35, v35
    v_cvt_pk_bf16_f32 v56, v32, v33
    v_exp_f32 v36, v36
    v_exp_f32 v37, v37
    v_cvt_pk_bf16_f32 v57, v34, v35
    v_mfma_f32_32x32x16_bf16 v[16:31], a[164:167], a[100:103], v[16:31]
    buffer_load_dwordx4 a[140:143], v2, s[28:31], s70 offen offset:3072 sc1
    s_add_u32 s70, s70, 4096
    v_exp_f32 v38, v38
    v_exp_f32 v39, v39
    v_cvt_pk_bf16_f32 v58, v36, v37
    v_cvt_pk_bf16_f32 v59, v38, v39
    v_mfma_f32_32x32x16_bf16 a[64:79], a[184:187], a[204:207], a[64:79]
    ds_read_b64_tr_b16 a[180:181], v7 offset:0
    ds_read_b64_tr_b16 a[182:183], v7 offset:1024
    v_exp_f32 v40, v40
    v_exp_f32 v41, v41
    v_exp_f32 v42, v42
    v_mfma_f32_32x32x16_bf16 v[64:79], a[152:155], v[56:59], v[64:79]
    v_exp_f32 v43, v43
    v_cvt_pk_bf16_f32 v60, v40, v41
    v_exp_f32 v44, v44
    v_exp_f32 v45, v45
    v_mfma_f32_32x32x16_bf16 a[80:95], a[188:191], a[204:207], a[80:95]
    buffer_load_dwordx4 a[196:199], v5, s[40:43], s81 offen offset:0 sc1
    v_cvt_pk_bf16_f32 v61, v42, v43
    v_exp_f32 v46, v46
    v_exp_f32 v47, v47
    v_cvt_pk_bf16_f32 v62, v44, v45
    v_cvt_pk_bf16_f32 v63, v46, v47
    v_mfma_f32_32x32x16_bf16 v[32:47], a[160:163], a[104:107], 0
    v_exp_f32 v16, v16
    v_exp_f32 v17, v17
    v_exp_f32 v18, v18
    v_exp_f32 v19, v19
    v_mfma_f32_32x32x16_bf16 v[64:79], a[156:159], v[60:63], v[64:79]
    v_cvt_pk_bf16_f32 v48, v16, v17
    v_exp_f32 v20, v20
    v_exp_f32 v21, v21
    v_cvt_pk_bf16_f32 v49, v18, v19
    v_exp_f32 v22, v22
    v_mfma_f32_32x32x16_bf16 v[32:47], a[164:167], a[108:111], v[32:47]
    buffer_load_dwordx4 a[144:147], v2, s[28:31], s70 offen offset:0 sc1
    v_exp_f32 v23, v23
    v_cvt_pk_bf16_f32 v50, v20, v21
    v_cvt_pk_bf16_f32 v51, v22, v23
    v_exp_f32 v24, v24
    s_waitcnt lgkmcnt(0)
    v_mfma_f32_32x32x16_bf16 v[80:95], a[176:179], a[208:211], v[80:95]
    ds_read_b64_tr_b16 a[184:185], v6 offset:8192
    ds_read_b64_tr_b16 a[186:187], v6 offset:9216
    v_exp_f32 v25, v25
    v_exp_f32 v26, v26
    v_mfma_f32_32x32x16_bf16 a[32:47], a[168:171], v[48:51], a[32:47]
    v_exp_f32 v27, v27
    v_cvt_pk_bf16_f32 v52, v24, v25
    v_exp_f32 v28, v28
    v_exp_f32 v29, v29
    v_mfma_f32_32x32x16_bf16 a[48:63], a[180:183], a[208:211], a[48:63]
    buffer_load_dwordx4 a[200:203], v4, s[40:43], s81 offen offset:1024 sc1
    v_cvt_pk_bf16_f32 v53, v26, v27
    v_exp_f32 v30, v30
    v_exp_f32 v31, v31
    v_cvt_pk_bf16_f32 v54, v28, v29
    v_cvt_pk_bf16_f32 v55, v30, v31
    v_mfma_f32_32x32x16_bf16 v[16:31], a[160:163], a[112:115], 0
    s_add_u32 m0, s59, 139264
    s_add_u32 s55, s55, 14336
    buffer_load_dwordx4 v14, s[20:23], s55 offen lds
    v_exp_f32 v32, v32
    v_exp_f32 v33, v33
    v_exp_f32 v34, v34
    v_mfma_f32_32x32x16_bf16 a[32:47], a[172:175], v[52:55], a[32:47]
    buffer_load_dwordx4 v15, s[20:23], s55 offen offset:1024 lds
    v_exp_f32 v35, v35
    v_cvt_pk_bf16_f32 v56, v32, v33
    v_exp_f32 v36, v36
    v_exp_f32 v37, v37
    v_mfma_f32_32x32x16_bf16 v[16:31], a[164:167], a[116:119], v[16:31]
    buffer_load_dwordx4 a[148:151], v2, s[28:31], s70 offen offset:1024 sc1
    v_cvt_pk_bf16_f32 v57, v34, v35
    v_exp_f32 v38, v38
    v_exp_f32 v39, v39
    v_cvt_pk_bf16_f32 v58, v36, v37
    v_mfma_f32_32x32x16_bf16 a[64:79], a[176:179], a[212:215], a[64:79]
    ds_read_b64_tr_b16 a[188:189], v7 offset:8192
    ds_read_b64_tr_b16 a[190:191], v7 offset:9216
    v_cvt_pk_bf16_f32 v59, v38, v39
    v_exp_f32 v40, v40
    v_exp_f32 v41, v41
    v_mfma_f32_32x32x16_bf16 a[16:31], a[168:171], v[56:59], a[16:31]
    v_exp_f32 v42, v42
    v_exp_f32 v43, v43
    v_cvt_pk_bf16_f32 v60, v40, v41
    v_exp_f32 v44, v44
    v_exp_f32 v45, v45
    v_mfma_f32_32x32x16_bf16 a[80:95], a[180:183], a[212:215], a[80:95]
    buffer_load_dwordx4 a[204:207], v5, s[40:43], s81 offen offset:1024 sc1
    v_cvt_pk_bf16_f32 v61, v42, v43
    v_exp_f32 v46, v46
    v_exp_f32 v47, v47
    v_cvt_pk_bf16_f32 v62, v44, v45
    v_cvt_pk_bf16_f32 v63, v46, v47
    v_mfma_f32_32x32x16_bf16 v[32:47], a[160:163], a[120:123], 0
    v_exp_f32 v16, v16
    v_exp_f32 v17, v17
    v_exp_f32 v18, v18
    v_exp_f32 v19, v19
    v_mfma_f32_32x32x16_bf16 a[16:31], a[172:175], v[60:63], a[16:31]
    v_cvt_pk_bf16_f32 v48, v16, v17
    v_exp_f32 v20, v20
    v_exp_f32 v21, v21
    v_cvt_pk_bf16_f32 v49, v18, v19
    v_exp_f32 v22, v22
    v_mfma_f32_32x32x16_bf16 v[32:47], a[164:167], a[124:127], v[32:47]
    buffer_load_dwordx4 a[152:155], v2, s[28:31], s70 offen offset:2048 sc1
    v_exp_f32 v23, v23
    v_cvt_pk_bf16_f32 v50, v20, v21
    v_cvt_pk_bf16_f32 v51, v22, v23
    v_exp_f32 v24, v24
    s_waitcnt lgkmcnt(0)
    v_mfma_f32_32x32x16_bf16 v[80:95], a[184:187], a[216:219], v[80:95]
    ds_read_b64_tr_b16 a[176:177], v6 offset:16384
    ds_read_b64_tr_b16 a[178:179], v6 offset:17408
    v_exp_f32 v25, v25
    v_exp_f32 v26, v26
    v_mfma_f32_32x32x16_bf16 a[0:15], a[168:171], v[48:51], a[0:15]
    v_exp_f32 v27, v27
    v_cvt_pk_bf16_f32 v52, v24, v25
    v_exp_f32 v28, v28
    v_exp_f32 v29, v29
    v_mfma_f32_32x32x16_bf16 a[48:63], a[188:191], a[216:219], a[48:63]
    buffer_load_dwordx4 a[208:211], v4, s[40:43], s81 offen offset:2048 sc1
    v_cvt_pk_bf16_f32 v53, v26, v27
    v_exp_f32 v30, v30
    v_exp_f32 v31, v31
    v_cvt_pk_bf16_f32 v54, v28, v29
    v_cvt_pk_bf16_f32 v55, v30, v31
    s_waitcnt vmcnt(9)
    v_mfma_f32_32x32x16_bf16 v[16:31], a[128:131], a[96:99], 0
    v_exp_f32 v32, v32
    v_exp_f32 v33, v33
    v_exp_f32 v34, v34
    v_mfma_f32_32x32x16_bf16 a[0:15], a[172:175], v[52:55], a[0:15]
    v_exp_f32 v35, v35
    v_cvt_pk_bf16_f32 v56, v32, v33
    v_exp_f32 v36, v36
    v_exp_f32 v37, v37
    v_cvt_pk_bf16_f32 v57, v34, v35
    v_mfma_f32_32x32x16_bf16 v[16:31], a[132:135], a[100:103], v[16:31]
    buffer_load_dwordx4 a[156:159], v2, s[28:31], s70 offen offset:3072 sc1
    s_add_u32 s70, s70, 4096
    v_exp_f32 v38, v38
    v_exp_f32 v39, v39
    v_cvt_pk_bf16_f32 v58, v36, v37
    v_cvt_pk_bf16_f32 v59, v38, v39
    v_mfma_f32_32x32x16_bf16 a[64:79], a[184:187], a[220:223], a[64:79]
    ds_read_b64_tr_b16 a[180:181], v7 offset:16384
    ds_read_b64_tr_b16 a[182:183], v7 offset:17408
    v_exp_f32 v40, v40
    v_exp_f32 v41, v41
    v_exp_f32 v42, v42
    v_mfma_f32_32x32x16_bf16 v[64:79], a[168:171], v[56:59], v[64:79]
    v_exp_f32 v43, v43
    v_cvt_pk_bf16_f32 v60, v40, v41
    v_exp_f32 v44, v44
    v_exp_f32 v45, v45
    v_mfma_f32_32x32x16_bf16 a[80:95], a[188:191], a[220:223], a[80:95]
    buffer_load_dwordx4 a[212:215], v5, s[40:43], s81 offen offset:2048 sc1
    v_cvt_pk_bf16_f32 v61, v42, v43
    v_exp_f32 v46, v46
    v_exp_f32 v47, v47
    v_cvt_pk_bf16_f32 v62, v44, v45
    v_cvt_pk_bf16_f32 v63, v46, v47
    v_mfma_f32_32x32x16_bf16 v[32:47], a[128:131], a[104:107], 0
    s_add_u32 m0, s59, 147456
    s_add_u32 s55, s55, 14336
    buffer_load_dwordx4 v14, s[20:23], s55 offen lds
    v_exp_f32 v16, v16
    v_exp_f32 v17, v17
    v_exp_f32 v18, v18
    v_mfma_f32_32x32x16_bf16 v[64:79], a[172:175], v[60:63], v[64:79]
    buffer_load_dwordx4 v15, s[20:23], s55 offen offset:1024 lds
    v_exp_f32 v19, v19
    v_cvt_pk_bf16_f32 v48, v16, v17
    v_exp_f32 v20, v20
    v_exp_f32 v21, v21
    v_mfma_f32_32x32x16_bf16 v[32:47], a[132:135], a[108:111], v[32:47]
    buffer_load_dwordx4 a[160:163], v2, s[28:31], s70 offen offset:0 sc1
    v_cvt_pk_bf16_f32 v49, v18, v19
    v_exp_f32 v22, v22
    v_exp_f32 v23, v23
    v_cvt_pk_bf16_f32 v50, v20, v21
    s_waitcnt lgkmcnt(0)
    v_mfma_f32_32x32x16_bf16 v[80:95], a[176:179], a[224:227], v[80:95]
    ds_read_b64_tr_b16 a[184:185], v6 offset:24576
    ds_read_b64_tr_b16 a[186:187], v6 offset:25600
    v_cvt_pk_bf16_f32 v51, v22, v23
    v_exp_f32 v24, v24
    v_exp_f32 v25, v25
    v_mfma_f32_32x32x16_bf16 a[32:47], a[136:139], v[48:51], a[32:47]
    v_exp_f32 v26, v26
    v_exp_f32 v27, v27
    v_cvt_pk_bf16_f32 v52, v24, v25
    v_exp_f32 v28, v28
    v_exp_f32 v29, v29
    v_mfma_f32_32x32x16_bf16 a[48:63], a[180:183], a[224:227], a[48:63]
    buffer_load_dwordx4 a[216:219], v4, s[40:43], s81 offen offset:3072 sc1
    v_cvt_pk_bf16_f32 v53, v26, v27
    v_exp_f32 v30, v30
    v_exp_f32 v31, v31
    v_cvt_pk_bf16_f32 v54, v28, v29
    v_cvt_pk_bf16_f32 v55, v30, v31
    v_mfma_f32_32x32x16_bf16 v[16:31], a[128:131], a[112:115], 0
    v_exp_f32 v32, v32
    v_exp_f32 v33, v33
    v_exp_f32 v34, v34
    v_exp_f32 v35, v35
    v_mfma_f32_32x32x16_bf16 a[32:47], a[140:143], v[52:55], a[32:47]
    v_cvt_pk_bf16_f32 v56, v32, v33
    v_exp_f32 v36, v36
    v_exp_f32 v37, v37
    v_cvt_pk_bf16_f32 v57, v34, v35
    v_exp_f32 v38, v38
    v_mfma_f32_32x32x16_bf16 v[16:31], a[132:135], a[116:119], v[16:31]
    buffer_load_dwordx4 a[164:167], v2, s[28:31], s70 offen offset:1024 sc1
    v_exp_f32 v39, v39
    v_cvt_pk_bf16_f32 v58, v36, v37
    v_cvt_pk_bf16_f32 v59, v38, v39
    v_exp_f32 v40, v40
    v_mfma_f32_32x32x16_bf16 a[64:79], a[176:179], a[228:231], a[64:79]
    ds_read_b64_tr_b16 a[188:189], v7 offset:24576
    ds_read_b64_tr_b16 a[190:191], v7 offset:25600
    v_exp_f32 v41, v41
    v_exp_f32 v42, v42
    v_mfma_f32_32x32x16_bf16 a[16:31], a[136:139], v[56:59], a[16:31]
    v_exp_f32 v43, v43
    v_cvt_pk_bf16_f32 v60, v40, v41
    v_exp_f32 v44, v44
    v_exp_f32 v45, v45
    v_cvt_pk_bf16_f32 v61, v42, v43
    v_mfma_f32_32x32x16_bf16 a[80:95], a[180:183], a[228:231], a[80:95]
    buffer_load_dwordx4 a[220:223], v5, s[40:43], s81 offen offset:3072 sc1
    s_add_u32 s81, s81, 4096
    v_exp_f32 v46, v46
    v_exp_f32 v47, v47
    v_cvt_pk_bf16_f32 v62, v44, v45
    v_cvt_pk_bf16_f32 v63, v46, v47
    v_mfma_f32_32x32x16_bf16 v[32:47], a[128:131], a[120:123], 0
    v_exp_f32 v16, v16
    v_exp_f32 v17, v17
    v_exp_f32 v18, v18
    v_exp_f32 v19, v19
    v_mfma_f32_32x32x16_bf16 a[16:31], a[140:143], v[60:63], a[16:31]
    v_cvt_pk_bf16_f32 v48, v16, v17
    v_exp_f32 v20, v20
    v_exp_f32 v21, v21
    v_cvt_pk_bf16_f32 v49, v18, v19
    v_exp_f32 v22, v22
    v_mfma_f32_32x32x16_bf16 v[32:47], a[132:135], a[124:127], v[32:47]
    buffer_load_dwordx4 a[168:171], v2, s[28:31], s70 offen offset:2048 sc1
    v_exp_f32 v23, v23
    v_cvt_pk_bf16_f32 v50, v20, v21
    v_cvt_pk_bf16_f32 v51, v22, v23
    v_exp_f32 v24, v24
    s_waitcnt lgkmcnt(0)
    v_mfma_f32_32x32x16_bf16 v[80:95], a[184:187], a[232:235], v[80:95]
    ds_read_b64_tr_b16 a[176:177], v6 offset:32768
    ds_read_b64_tr_b16 a[178:179], v6 offset:33792
    v_exp_f32 v25, v25
    v_exp_f32 v26, v26
    v_mfma_f32_32x32x16_bf16 a[0:15], a[136:139], v[48:51], a[0:15]
    v_exp_f32 v27, v27
    v_cvt_pk_bf16_f32 v52, v24, v25
    v_exp_f32 v28, v28
    v_exp_f32 v29, v29
    v_mfma_f32_32x32x16_bf16 a[48:63], a[188:191], a[232:235], a[48:63]
    buffer_load_dwordx4 a[224:227], v4, s[40:43], s81 offen offset:0 sc1
    v_cvt_pk_bf16_f32 v53, v26, v27
    v_exp_f32 v30, v30
    v_exp_f32 v31, v31
    v_cvt_pk_bf16_f32 v54, v28, v29
    v_cvt_pk_bf16_f32 v55, v30, v31
    s_waitcnt vmcnt(9)
    v_mfma_f32_32x32x16_bf16 v[16:31], a[144:147], a[96:99], 0
    s_add_u32 m0, s59, 155648
    s_add_u32 s55, s55, 14336
    buffer_load_dwordx4 v14, s[20:23], s55 offen lds
    v_exp_f32 v32, v32
    v_exp_f32 v33, v33
    v_mfma_f32_32x32x16_bf16 a[0:15], a[140:143], v[52:55], a[0:15]
    buffer_load_dwordx4 v15, s[20:23], s55 offen offset:1024 lds
    v_exp_f32 v34, v34
    v_exp_f32 v35, v35
    v_cvt_pk_bf16_f32 v56, v32, v33
    v_exp_f32 v36, v36
    v_exp_f32 v37, v37
    v_mfma_f32_32x32x16_bf16 v[16:31], a[148:151], a[100:103], v[16:31]
    buffer_load_dwordx4 a[172:175], v2, s[28:31], s70 offen offset:3072 sc1
    s_add_u32 s70, s70, 4096
    v_cvt_pk_bf16_f32 v57, v34, v35
    v_exp_f32 v38, v38
    v_exp_f32 v39, v39
    v_mfma_f32_32x32x16_bf16 a[64:79], a[184:187], a[236:239], a[64:79]
    ds_read_b64_tr_b16 a[180:181], v7 offset:32768
    ds_read_b64_tr_b16 a[182:183], v7 offset:33792
    v_cvt_pk_bf16_f32 v58, v36, v37
    v_cvt_pk_bf16_f32 v59, v38, v39
    v_exp_f32 v40, v40
    v_exp_f32 v41, v41
    v_mfma_f32_32x32x16_bf16 v[64:79], a[136:139], v[56:59], v[64:79]
    v_exp_f32 v42, v42
    v_exp_f32 v43, v43
    v_cvt_pk_bf16_f32 v60, v40, v41
    v_exp_f32 v44, v44
    v_exp_f32 v45, v45
    v_mfma_f32_32x32x16_bf16 a[80:95], a[188:191], a[236:239], a[80:95]
    buffer_load_dwordx4 a[228:231], v5, s[40:43], s81 offen offset:0 sc1
    v_cvt_pk_bf16_f32 v61, v42, v43
    v_exp_f32 v46, v46
    v_exp_f32 v47, v47
    v_cvt_pk_bf16_f32 v62, v44, v45
    v_cvt_pk_bf16_f32 v63, v46, v47
    v_mfma_f32_32x32x16_bf16 v[32:47], a[144:147], a[104:107], 0
    s_add_u32 m0, s59, 0
    s_nop 0
    buffer_load_dwordx4 v14, s[24:27], s74 offen lds
    v_exp_f32 v16, v16
    v_exp_f32 v17, v17
    v_exp_f32 v18, v18
    v_mfma_f32_32x32x16_bf16 v[64:79], a[140:143], v[60:63], v[64:79]
    buffer_load_dwordx4 v15, s[24:27], s74 offen offset:1024 lds
    v_exp_f32 v19, v19
    v_cvt_pk_bf16_f32 v48, v16, v17
    v_exp_f32 v20, v20
    v_exp_f32 v21, v21
    v_mfma_f32_32x32x16_bf16 v[32:47], a[148:151], a[108:111], v[32:47]
    buffer_load_dwordx4 a[128:131], v2, s[28:31], s70 offen offset:0 sc1
    v_cvt_pk_bf16_f32 v49, v18, v19
    v_exp_f32 v22, v22
    v_exp_f32 v23, v23
    v_cvt_pk_bf16_f32 v50, v20, v21
    s_waitcnt lgkmcnt(0)
    v_mfma_f32_32x32x16_bf16 v[80:95], a[176:179], a[192:195], v[80:95]
    ds_read_b64_tr_b16 a[184:185], v6 offset:40960
    ds_read_b64_tr_b16 a[186:187], v6 offset:41984
    v_cvt_pk_bf16_f32 v51, v22, v23
    v_exp_f32 v24, v24
    v_exp_f32 v25, v25
    v_mfma_f32_32x32x16_bf16 a[32:47], a[152:155], v[48:51], a[32:47]
    v_exp_f32 v26, v26
    v_exp_f32 v27, v27
    v_cvt_pk_bf16_f32 v52, v24, v25
    v_exp_f32 v28, v28
    v_exp_f32 v29, v29
    v_mfma_f32_32x32x16_bf16 a[48:63], a[180:183], a[192:195], a[48:63]
    buffer_load_dwordx4 a[232:235], v4, s[40:43], s81 offen offset:1024 sc1
    v_cvt_pk_bf16_f32 v53, v26, v27
    v_exp_f32 v30, v30
    v_exp_f32 v31, v31
    v_cvt_pk_bf16_f32 v54, v28, v29
    v_cvt_pk_bf16_f32 v55, v30, v31
    v_mfma_f32_32x32x16_bf16 v[16:31], a[144:147], a[112:115], 0
    s_add_u32 m0, s59, 8192
    s_add_u32 s74, s74, 57344
    buffer_load_dwordx4 v14, s[24:27], s74 offen lds
    v_exp_f32 v32, v32
    v_exp_f32 v33, v33
    v_exp_f32 v34, v34
    v_mfma_f32_32x32x16_bf16 a[32:47], a[156:159], v[52:55], a[32:47]
    buffer_load_dwordx4 v15, s[24:27], s74 offen offset:1024 lds
    v_exp_f32 v35, v35
    v_cvt_pk_bf16_f32 v56, v32, v33
    v_exp_f32 v36, v36
    v_exp_f32 v37, v37
    v_mfma_f32_32x32x16_bf16 v[16:31], a[148:151], a[116:119], v[16:31]
    buffer_load_dwordx4 a[132:135], v2, s[28:31], s70 offen offset:1024 sc1
    v_cvt_pk_bf16_f32 v57, v34, v35
    v_exp_f32 v38, v38
    v_exp_f32 v39, v39
    v_cvt_pk_bf16_f32 v58, v36, v37
    v_mfma_f32_32x32x16_bf16 a[64:79], a[176:179], a[196:199], a[64:79]
    ds_read_b64_tr_b16 a[188:189], v7 offset:40960
    ds_read_b64_tr_b16 a[190:191], v7 offset:41984
    v_cvt_pk_bf16_f32 v59, v38, v39
    v_exp_f32 v40, v40
    v_exp_f32 v41, v41
    v_mfma_f32_32x32x16_bf16 a[16:31], a[152:155], v[56:59], a[16:31]
    v_exp_f32 v42, v42
    v_exp_f32 v43, v43
    v_cvt_pk_bf16_f32 v60, v40, v41
    v_exp_f32 v44, v44
    v_exp_f32 v45, v45
    v_mfma_f32_32x32x16_bf16 a[80:95], a[180:183], a[196:199], a[80:95]
    buffer_load_dwordx4 a[236:239], v5, s[40:43], s81 offen offset:1024 sc1
    v_cvt_pk_bf16_f32 v61, v42, v43
    v_exp_f32 v46, v46
    v_exp_f32 v47, v47
    v_cvt_pk_bf16_f32 v62, v44, v45
    v_cvt_pk_bf16_f32 v63, v46, v47
    v_mfma_f32_32x32x16_bf16 v[32:47], a[144:147], a[120:123], 0
    s_add_u32 m0, s59, 16384
    s_add_u32 s74, s74, 57344
    buffer_load_dwordx4 v14, s[24:27], s74 offen lds
    v_exp_f32 v16, v16
    v_exp_f32 v17, v17
    v_exp_f32 v18, v18
    v_mfma_f32_32x32x16_bf16 a[16:31], a[156:159], v[60:63], a[16:31]
    buffer_load_dwordx4 v15, s[24:27], s74 offen offset:1024 lds
    v_exp_f32 v19, v19
    v_cvt_pk_bf16_f32 v48, v16, v17
    v_exp_f32 v20, v20
    v_exp_f32 v21, v21
    v_mfma_f32_32x32x16_bf16 v[32:47], a[148:151], a[124:127], v[32:47]
    buffer_load_dwordx4 a[136:139], v2, s[28:31], s70 offen offset:2048 sc1
    v_cvt_pk_bf16_f32 v49, v18, v19
    v_exp_f32 v22, v22
    v_exp_f32 v23, v23
    v_cvt_pk_bf16_f32 v50, v20, v21
    s_waitcnt lgkmcnt(0)
    v_mfma_f32_32x32x16_bf16 v[80:95], a[184:187], a[200:203], v[80:95]
    ds_read_b64_tr_b16 a[176:177], v6 offset:49152
    ds_read_b64_tr_b16 a[178:179], v6 offset:50176
    v_cvt_pk_bf16_f32 v51, v22, v23
    v_exp_f32 v24, v24
    v_exp_f32 v25, v25
    v_mfma_f32_32x32x16_bf16 a[0:15], a[152:155], v[48:51], a[0:15]
    v_exp_f32 v26, v26
    v_exp_f32 v27, v27
    v_cvt_pk_bf16_f32 v52, v24, v25
    v_exp_f32 v28, v28
    v_exp_f32 v29, v29
    v_mfma_f32_32x32x16_bf16 a[48:63], a[188:191], a[200:203], a[48:63]
    buffer_load_dwordx4 a[192:195], v4, s[40:43], s81 offen offset:2048 sc1
    v_cvt_pk_bf16_f32 v53, v26, v27
    v_exp_f32 v30, v30
    v_exp_f32 v31, v31
    v_cvt_pk_bf16_f32 v54, v28, v29
    v_cvt_pk_bf16_f32 v55, v30, v31
    s_waitcnt vmcnt(13)
    v_mfma_f32_32x32x16_bf16 v[16:31], a[160:163], a[96:99], 0
    s_add_u32 m0, s59, 24576
    s_add_u32 s74, s74, 57344
    buffer_load_dwordx4 v14, s[24:27], s74 offen lds
    v_exp_f32 v32, v32
    v_exp_f32 v33, v33
    v_mfma_f32_32x32x16_bf16 a[0:15], a[156:159], v[52:55], a[0:15]
    buffer_load_dwordx4 v15, s[24:27], s74 offen offset:1024 lds
    v_exp_f32 v34, v34
    v_exp_f32 v35, v35
    v_cvt_pk_bf16_f32 v56, v32, v33
    v_exp_f32 v36, v36
    v_exp_f32 v37, v37
    v_mfma_f32_32x32x16_bf16 v[16:31], a[164:167], a[100:103], v[16:31]
    buffer_load_dwordx4 a[140:143], v2, s[28:31], s70 offen offset:3072 sc1
    s_add_u32 s70, s70, 4096
    v_cvt_pk_bf16_f32 v57, v34, v35
    v_exp_f32 v38, v38
    v_exp_f32 v39, v39
    v_mfma_f32_32x32x16_bf16 a[64:79], a[184:187], a[204:207], a[64:79]
    ds_read_b64_tr_b16 a[180:181], v7 offset:49152
    ds_read_b64_tr_b16 a[182:183], v7 offset:50176
    v_cvt_pk_bf16_f32 v58, v36, v37
    v_cvt_pk_bf16_f32 v59, v38, v39
    v_exp_f32 v40, v40
    v_exp_f32 v41, v41
    v_mfma_f32_32x32x16_bf16 v[64:79], a[152:155], v[56:59], v[64:79]
    v_exp_f32 v42, v42
    v_exp_f32 v43, v43
    v_cvt_pk_bf16_f32 v60, v40, v41
    v_exp_f32 v44, v44
    v_exp_f32 v45, v45
    v_mfma_f32_32x32x16_bf16 a[80:95], a[188:191], a[204:207], a[80:95]
    buffer_load_dwordx4 a[196:199], v5, s[40:43], s81 offen offset:2048 sc1
    v_cvt_pk_bf16_f32 v61, v42, v43
    v_exp_f32 v46, v46
    v_exp_f32 v47, v47
    v_cvt_pk_bf16_f32 v62, v44, v45
    v_cvt_pk_bf16_f32 v63, v46, v47
    v_mfma_f32_32x32x16_bf16 v[32:47], a[160:163], a[104:107], 0
    v_exp_f32 v16, v16
    v_exp_f32 v17, v17
    v_exp_f32 v18, v18
    v_exp_f32 v19, v19
    v_mfma_f32_32x32x16_bf16 v[64:79], a[156:159], v[60:63], v[64:79]
    v_cvt_pk_bf16_f32 v48, v16, v17
    v_exp_f32 v20, v20
    v_exp_f32 v21, v21
    v_cvt_pk_bf16_f32 v49, v18, v19
    v_exp_f32 v22, v22
    v_mfma_f32_32x32x16_bf16 v[32:47], a[164:167], a[108:111], v[32:47]
    v_exp_f32 v23, v23
    v_cvt_pk_bf16_f32 v50, v20, v21
    v_cvt_pk_bf16_f32 v51, v22, v23
    v_exp_f32 v24, v24
    s_waitcnt lgkmcnt(0)
    v_mfma_f32_32x32x16_bf16 v[80:95], a[176:179], a[208:211], v[80:95]
    ds_read_b64_tr_b16 a[184:185], v6 offset:57344
    ds_read_b64_tr_b16 a[186:187], v6 offset:58368
    v_exp_f32 v25, v25
    v_exp_f32 v26, v26
    v_mfma_f32_32x32x16_bf16 a[32:47], a[168:171], v[48:51], a[32:47]
    v_exp_f32 v27, v27
    v_cvt_pk_bf16_f32 v52, v24, v25
    v_exp_f32 v28, v28
    v_exp_f32 v29, v29
    v_cvt_pk_bf16_f32 v53, v26, v27
    v_mfma_f32_32x32x16_bf16 a[48:63], a[180:183], a[208:211], a[48:63]
    buffer_load_dwordx4 a[200:203], v4, s[40:43], s81 offen offset:3072 sc1
    v_exp_f32 v30, v30
    v_exp_f32 v31, v31
    v_cvt_pk_bf16_f32 v54, v28, v29
    v_cvt_pk_bf16_f32 v55, v30, v31
    v_mfma_f32_32x32x16_bf16 v[16:31], a[160:163], a[112:115], 0
    v_exp_f32 v32, v32
    v_exp_f32 v33, v33
    v_exp_f32 v34, v34
    v_exp_f32 v35, v35
    v_mfma_f32_32x32x16_bf16 a[32:47], a[172:175], v[52:55], a[32:47]
    v_cvt_pk_bf16_f32 v56, v32, v33
    v_exp_f32 v36, v36
    v_exp_f32 v37, v37
    v_cvt_pk_bf16_f32 v57, v34, v35
    v_exp_f32 v38, v38
    v_mfma_f32_32x32x16_bf16 v[16:31], a[164:167], a[116:119], v[16:31]
    v_exp_f32 v39, v39
    v_cvt_pk_bf16_f32 v58, v36, v37
    v_cvt_pk_bf16_f32 v59, v38, v39
    v_exp_f32 v40, v40
    v_mfma_f32_32x32x16_bf16 a[64:79], a[176:179], a[212:215], a[64:79]
    ds_read_b64_tr_b16 a[188:189], v7 offset:57344
    ds_read_b64_tr_b16 a[190:191], v7 offset:58368
    v_exp_f32 v41, v41
    v_exp_f32 v42, v42
    v_exp_f32 v43, v43
    v_mfma_f32_32x32x16_bf16 a[16:31], a[168:171], v[56:59], a[16:31]
    v_cvt_pk_bf16_f32 v60, v40, v41
    v_exp_f32 v44, v44
    v_exp_f32 v45, v45
    v_cvt_pk_bf16_f32 v61, v42, v43
    v_mfma_f32_32x32x16_bf16 a[80:95], a[180:183], a[212:215], a[80:95]
    buffer_load_dwordx4 a[204:207], v5, s[40:43], s81 offen offset:3072 sc1
    s_add_u32 s81, s81, 4096
    v_exp_f32 v46, v46
    v_exp_f32 v47, v47
    v_cvt_pk_bf16_f32 v62, v44, v45
    v_cvt_pk_bf16_f32 v63, v46, v47
    v_mfma_f32_32x32x16_bf16 v[32:47], a[160:163], a[120:123], 0
    v_add_u32 v239, 0xffff0000, v9
    v_exp_f32 v16, v16
    v_exp_f32 v17, v17
    v_exp_f32 v18, v18
    v_exp_f32 v19, v19
    v_mfma_f32_32x32x16_bf16 a[16:31], a[172:175], v[60:63], a[16:31]
    v_cvt_pk_bf16_f32 v48, v16, v17
    v_exp_f32 v20, v20
    v_exp_f32 v21, v21
    v_cvt_pk_bf16_f32 v49, v18, v19
    v_exp_f32 v22, v22
    v_mfma_f32_32x32x16_bf16 v[32:47], a[164:167], a[124:127], v[32:47]
    v_exp_f32 v23, v23
    v_cvt_pk_bf16_f32 v50, v20, v21
    v_cvt_pk_bf16_f32 v51, v22, v23
    v_exp_f32 v24, v24
    s_waitcnt lgkmcnt(0)
    v_mfma_f32_32x32x16_bf16 v[80:95], a[184:187], a[216:219], v[80:95]
    v_add_u32 v6, 0x10000, v6
    v_add_u32 v7, 0x10000, v7
    ds_read_b64_tr_b16 a[176:177], v6 offset:0
    ds_read_b64_tr_b16 a[178:179], v6 offset:1024
    v_exp_f32 v25, v25
    v_exp_f32 v26, v26
    v_mfma_f32_32x32x16_bf16 a[0:15], a[168:171], v[48:51], a[0:15]
    v_exp_f32 v27, v27
    v_cvt_pk_bf16_f32 v52, v24, v25
    v_exp_f32 v28, v28
    v_exp_f32 v29, v29
    v_mfma_f32_32x32x16_bf16 a[48:63], a[188:191], a[216:219], a[48:63]
    buffer_load_dwordx4 a[208:211], v4, s[40:43], s81 offen offset:0 sc1
    v_cvt_pk_bf16_f32 v53, v26, v27
    v_exp_f32 v30, v30
    v_exp_f32 v31, v31
    v_cvt_pk_bf16_f32 v54, v28, v29
    v_cvt_pk_bf16_f32 v55, v30, v31
    s_waitcnt vmcnt(4)
    v_mfma_f32_32x32x16_bf16 v[16:31], a[128:131], a[96:99], 0
    v_exp_f32 v32, v32
    v_exp_f32 v33, v33
    v_exp_f32 v34, v34
    v_mfma_f32_32x32x16_bf16 a[0:15], a[172:175], v[52:55], a[0:15]
    v_exp_f32 v35, v35
    v_cvt_pk_bf16_f32 v56, v32, v33
    v_exp_f32 v36, v36
    v_exp_f32 v37, v37
    v_cvt_pk_bf16_f32 v57, v34, v35
    v_mfma_f32_32x32x16_bf16 v[16:31], a[132:135], a[100:103], v[16:31]
    v_exp_f32 v38, v38
    v_exp_f32 v39, v39
    v_cvt_pk_bf16_f32 v58, v36, v37
    v_cvt_pk_bf16_f32 v59, v38, v39
    v_mfma_f32_32x32x16_bf16 a[64:79], a[184:187], a[220:223], a[64:79]
    ds_read_b64_tr_b16 a[180:181], v7 offset:0
    ds_read_b64_tr_b16 a[182:183], v7 offset:1024
    v_exp_f32 v40, v40
    v_exp_f32 v41, v41
    v_exp_f32 v42, v42
    v_mfma_f32_32x32x16_bf16 v[64:79], a[168:171], v[56:59], v[64:79]
    v_exp_f32 v43, v43
    v_cvt_pk_bf16_f32 v60, v40, v41
    v_exp_f32 v44, v44
    v_exp_f32 v45, v45
    v_cvt_pk_bf16_f32 v61, v42, v43
    v_mfma_f32_32x32x16_bf16 a[80:95], a[188:191], a[220:223], a[80:95]
    buffer_load_dwordx4 a[212:215], v5, s[40:43], s81 offen offset:0 sc1
    v_exp_f32 v46, v46
    v_exp_f32 v47, v47
    v_cvt_pk_bf16_f32 v62, v44, v45
    v_cvt_pk_bf16_f32 v63, v46, v47
    v_mfma_f32_32x32x16_bf16 v[32:47], a[128:131], a[104:107], 0
    v_exp_f32 v16, v16
    v_exp_f32 v17, v17
    v_exp_f32 v18, v18
    v_exp_f32 v19, v19
    v_mfma_f32_32x32x16_bf16 v[64:79], a[172:175], v[60:63], v[64:79]
    v_cvt_pk_bf16_f32 v48, v16, v17
    v_exp_f32 v20, v20
    v_exp_f32 v21, v21
    v_cvt_pk_bf16_f32 v49, v18, v19
    v_exp_f32 v22, v22
    v_mfma_f32_32x32x16_bf16 v[32:47], a[132:135], a[108:111], v[32:47]
    v_exp_f32 v23, v23
    v_cvt_pk_bf16_f32 v50, v20, v21
    v_cvt_pk_bf16_f32 v51, v22, v23
    v_exp_f32 v24, v24
    s_waitcnt lgkmcnt(0)
    v_mfma_f32_32x32x16_bf16 v[80:95], a[176:179], a[224:227], v[80:95]
    ds_read_b64_tr_b16 a[184:185], v6 offset:8192
    ds_read_b64_tr_b16 a[186:187], v6 offset:9216
    v_exp_f32 v25, v25
    v_exp_f32 v26, v26
    v_mfma_f32_32x32x16_bf16 a[32:47], a[136:139], v[48:51], a[32:47]
    v_exp_f32 v27, v27
    v_cvt_pk_bf16_f32 v52, v24, v25
    v_exp_f32 v28, v28
    v_exp_f32 v29, v29
    v_cvt_pk_bf16_f32 v53, v26, v27
    v_mfma_f32_32x32x16_bf16 a[48:63], a[180:183], a[224:227], a[48:63]
    buffer_load_dwordx4 a[216:219], v4, s[40:43], s81 offen offset:1024 sc1
    v_exp_f32 v30, v30
    v_exp_f32 v31, v31
    v_cvt_pk_bf16_f32 v54, v28, v29
    v_cvt_pk_bf16_f32 v55, v30, v31
    v_mfma_f32_32x32x16_bf16 v[16:31], a[128:131], a[112:115], 0
    v_exp_f32 v32, v32
    v_exp_f32 v33, v33
    v_exp_f32 v34, v34
    v_exp_f32 v35, v35
    v_mfma_f32_32x32x16_bf16 a[32:47], a[140:143], v[52:55], a[32:47]
    v_cvt_pk_bf16_f32 v56, v32, v33
    v_exp_f32 v36, v36
    v_exp_f32 v37, v37
    v_cvt_pk_bf16_f32 v57, v34, v35
    v_exp_f32 v38, v38
    v_mfma_f32_32x32x16_bf16 v[16:31], a[132:135], a[116:119], v[16:31]
    v_exp_f32 v39, v39
    v_cvt_pk_bf16_f32 v58, v36, v37
    v_cvt_pk_bf16_f32 v59, v38, v39
    v_exp_f32 v40, v40
    v_exp_f32 v41, v41
    v_mfma_f32_32x32x16_bf16 a[64:79], a[176:179], a[228:231], a[64:79]
    ds_read_b64_tr_b16 a[188:189], v7 offset:8192
    ds_read_b64_tr_b16 a[190:191], v7 offset:9216
    v_exp_f32 v42, v42
    v_exp_f32 v43, v43
    v_cvt_pk_bf16_f32 v60, v40, v41
    v_mfma_f32_32x32x16_bf16 a[16:31], a[136:139], v[56:59], a[16:31]
    ds_write_b128 v239, a[32:35] offset:32768
    ds_write_b128 v239, a[36:39] offset:33792
    v_exp_f32 v44, v44
    v_exp_f32 v45, v45
    v_cvt_pk_bf16_f32 v61, v42, v43
    v_exp_f32 v46, v46
    v_mfma_f32_32x32x16_bf16 a[80:95], a[180:183], a[228:231], a[80:95]
    buffer_load_dwordx4 a[220:223], v5, s[40:43], s81 offen offset:1024 sc1
    ds_write_b128 v239, a[40:43] offset:40960
    ds_write_b128 v239, a[44:47] offset:41984
    v_exp_f32 v47, v47
    v_cvt_pk_bf16_f32 v62, v44, v45
    v_cvt_pk_bf16_f32 v63, v46, v47
    v_mfma_f32_32x32x16_bf16 v[32:47], a[128:131], a[120:123], 0
    v_exp_f32 v16, v16
    v_exp_f32 v17, v17
    v_exp_f32 v18, v18
    v_exp_f32 v19, v19
    v_mfma_f32_32x32x16_bf16 a[16:31], a[140:143], v[60:63], a[16:31]
    v_cvt_pk_bf16_f32 v48, v16, v17
    v_exp_f32 v20, v20
    v_exp_f32 v21, v21
    v_cvt_pk_bf16_f32 v49, v18, v19
    v_exp_f32 v22, v22
    v_mfma_f32_32x32x16_bf16 v[32:47], a[132:135], a[124:127], v[32:47]
    v_exp_f32 v23, v23
    v_cvt_pk_bf16_f32 v50, v20, v21
    v_cvt_pk_bf16_f32 v51, v22, v23
    v_exp_f32 v24, v24
    v_exp_f32 v25, v25
    s_waitcnt lgkmcnt(4)
    v_mfma_f32_32x32x16_bf16 v[80:95], a[184:187], a[232:235], v[80:95]
    ds_read_b64_tr_b16 a[176:177], v6 offset:16384
    ds_read_b64_tr_b16 a[178:179], v6 offset:17408
    v_exp_f32 v26, v26
    v_exp_f32 v27, v27
    v_cvt_pk_bf16_f32 v52, v24, v25
    v_mfma_f32_32x32x16_bf16 a[0:15], a[136:139], v[48:51], a[0:15]
    ds_write_b128 v239, a[16:19] offset:49152
    ds_write_b128 v239, a[20:23] offset:50176
    v_exp_f32 v28, v28
    v_exp_f32 v29, v29
    v_cvt_pk_bf16_f32 v53, v26, v27
    v_mfma_f32_32x32x16_bf16 a[48:63], a[188:191], a[232:235], a[48:63]
    buffer_load_dwordx4 a[224:227], v4, s[40:43], s81 offen offset:2048 sc1
    ds_write_b128 v239, a[24:27] offset:57344
    ds_write_b128 v239, a[28:31] offset:58368
    v_exp_f32 v30, v30
    v_exp_f32 v31, v31
    v_cvt_pk_bf16_f32 v54, v28, v29
    v_cvt_pk_bf16_f32 v55, v30, v31
    s_nop 1
    v_mfma_f32_32x32x16_bf16 a[0:15], a[140:143], v[52:55], a[0:15]
    v_exp_f32 v32, v32
    v_exp_f32 v33, v33
    v_exp_f32 v34, v34
    v_exp_f32 v35, v35
    v_cvt_pk_bf16_f32 v56, v32, v33
    v_mfma_f32_32x32x16_bf16 a[64:79], a[184:187], a[236:239], a[64:79]
    ds_read_b64_tr_b16 a[180:181], v7 offset:16384
    ds_read_b64_tr_b16 a[182:183], v7 offset:17408
    v_exp_f32 v36, v36
    v_exp_f32 v37, v37
    v_cvt_pk_bf16_f32 v57, v34, v35
    v_exp_f32 v38, v38
    v_exp_f32 v39, v39
    v_cvt_pk_bf16_f32 v58, v36, v37
    v_cvt_pk_bf16_f32 v59, v38, v39
    v_exp_f32 v40, v40
    v_exp_f32 v41, v41
    v_mfma_f32_32x32x16_bf16 v[64:79], a[136:139], v[56:59], v[64:79]
    ds_write_b128 v9, a[0:3] offset:0
    v_exp_f32 v42, v42
    v_exp_f32 v43, v43
    v_cvt_pk_bf16_f32 v60, v40, v41
    v_exp_f32 v44, v44
    v_mfma_f32_32x32x16_bf16 a[80:95], a[188:191], a[236:239], a[80:95]
    buffer_load_dwordx4 a[228:231], v5, s[40:43], s81 offen offset:2048 sc1
    ds_write_b128 v9, a[4:7] offset:1024
    v_exp_f32 v45, v45
    v_cvt_pk_bf16_f32 v61, v42, v43
    v_exp_f32 v46, v46
    v_exp_f32 v47, v47
    v_cvt_pk_bf16_f32 v62, v44, v45
    v_cvt_pk_bf16_f32 v63, v46, v47
    s_nop 0
    s_mov_b64 s[76:77], 0
    v_mfma_f32_32x32x16_bf16 v[64:79], a[140:143], v[60:63], v[64:79]
    s_mov_b32 s65, 0x5f800000
    ds_write_b128 v9, a[8:11] offset:8192
    ds_write_b128 v9, a[12:15] offset:9216
    v_xor_b32 v241, 2048, v9
    v_xor_b32 v242, 4096, v239
    v_xor_b32 v243, 6144, v239
    buffer_load_dwordx4 a[136:139], v4, s[40:43], s81 offen offset:3072 sc1
    buffer_load_dwordx4 a[140:143], v5, s[40:43], s81 offen offset:3072 sc1
    s_add_u32 s81, s81, 4096
    buffer_load_dwordx4 a[144:147], v4, s[40:43], s81 offen offset:0 sc1
    buffer_load_dwordx4 a[148:151], v5, s[40:43], s81 offen offset:0 sc1
    s_waitcnt vmcnt(12) lgkmcnt(4)
    v_mfma_f32_32x32x16_bf16 v[80:95], a[176:179], a[192:195], v[80:95]
    ds_read_b64_tr_b16 a[184:185], v6 offset:24576
    ds_read_b64_tr_b16 a[186:187], v6 offset:25600
    v_mfma_f32_32x32x16_bf16 a[48:63], a[180:183], a[192:195], a[48:63]
    ds_read_b64_tr_b16 a[188:189], v7 offset:24576
    ds_read_b64_tr_b16 a[190:191], v7 offset:25600
    v_lshlrev_b32 v238, 10, v1
    v_add_u32 v238, 0x3fc, v238
    v_and_b32 v238, 0x3fff, v238
    s_waitcnt lgkmcnt(4)
    s_barrier
    ds_read_b128 v[128:131], v241 offset:0
    ds_read_b128 v[132:135], v241 offset:1024
    ds_read_b128 v[136:139], v241 offset:8192
    ds_read_b128 v[140:143], v241 offset:9216
    ds_read_b128 v[144:147], v242 offset:49152
    ds_read_b128 v[148:151], v242 offset:50176
    ds_read_b128 v[152:155], v242 offset:57344
    ds_read_b128 v[156:159], v242 offset:58368
    ds_read_b128 v[160:163], v243 offset:32768
    ds_read_b128 v[164:167], v243 offset:33792
    ds_read_b128 v[168:171], v243 offset:40960
    ds_read_b128 v[172:175], v243 offset:41984
    buffer_load_dwordx4 a[152:155], v4, s[40:43], s81 offen offset:1024 sc1
    buffer_load_dwordx4 a[156:159], v5, s[40:43], s81 offen offset:1024 sc1
    v_mfma_f32_32x32x16_bf16 a[64:79], a[176:179], a[196:199], a[64:79]
    s_waitcnt lgkmcnt(8)
    v_pk_add_f32 v[76:77], v[76:77], v[140:141]
    v_pk_add_f32 v[78:79], v[78:79], v[142:143]
    v_pk_add_f32 v[64:65], v[64:65], v[128:129]
    v_pk_add_f32 v[66:67], v[66:67], v[130:131]
    v_pk_add_f32 v[68:69], v[68:69], v[132:133]
    v_pk_add_f32 v[70:71], v[70:71], v[134:135]
    v_pk_add_f32 v[72:73], v[72:73], v[136:137]
    v_pk_add_f32 v[74:75], v[74:75], v[138:139]
    buffer_load_dwordx4 a[160:163], v4, s[40:43], s81 offen offset:2048 sc1
    buffer_load_dwordx4 a[164:167], v5, s[40:43], s81 offen offset:2048 sc1
    v_mfma_f32_32x32x16_bf16 a[80:95], a[180:183], a[196:199], a[80:95]
    s_waitcnt lgkmcnt(4)
    v_pk_add_f32 v[76:77], v[76:77], v[156:157]
    v_pk_add_f32 v[78:79], v[78:79], v[158:159]
    v_pk_add_f32 v[64:65], v[64:65], v[144:145]
    v_pk_add_f32 v[66:67], v[66:67], v[146:147]
    v_pk_add_f32 v[68:69], v[68:69], v[148:149]
    v_pk_add_f32 v[70:71], v[70:71], v[150:151]
    v_pk_add_f32 v[72:73], v[72:73], v[152:153]
    v_pk_add_f32 v[74:75], v[74:75], v[154:155]
    buffer_load_dwordx4 a[168:171], v4, s[40:43], s81 offen offset:3072 sc1
    buffer_load_dwordx4 a[172:175], v5, s[40:43], s81 offen offset:3072 sc1
    s_add_u32 s81, s81, 4096
    s_waitcnt vmcnt(16)
    v_mfma_f32_32x32x16_bf16 v[80:95], a[184:187], a[200:203], v[80:95]
    ds_read_b64_tr_b16 a[176:177], v6 offset:32768
    ds_read_b64_tr_b16 a[178:179], v6 offset:33792
    s_waitcnt lgkmcnt(2)
    s_barrier
    v_pk_add_f32 v[76:77], v[76:77], v[172:173]
    v_pk_add_f32 v[78:79], v[78:79], v[174:175]
    v_pk_add_f32 v[64:65], v[64:65], v[160:161]
    v_pk_add_f32 v[66:67], v[66:67], v[162:163]
    v_pk_add_f32 v[68:69], v[68:69], v[164:165]
    v_pk_add_f32 v[70:71], v[70:71], v[166:167]
    v_pk_add_f32 v[72:73], v[72:73], v[168:169]
    v_pk_add_f32 v[74:75], v[74:75], v[170:171]
    v_mov_b32 v192, v76
    v_mov_b32 v193, v76
    v_mfma_f32_32x32x16_bf16 a[48:63], a[188:191], a[200:203], a[48:63]
    ds_read_b64_tr_b16 a[180:181], v7 offset:32768
    ds_read_b64_tr_b16 a[182:183], v7 offset:33792
    s_nop 0
    v_permlane32_swap_b32 v192, v193
    v_cmp_le_f32 vcc, 0x21800000, v193
    v_cmp_ge_f32 s[62:63], s65, v193
    v_rcp_f32 v193, v193
    s_and_b64 vcc, vcc, s[62:63]
    s_cmp_eq_u64 vcc, -1
    s_cbranch_scc0 L_fb
L_fb_ret:
    v_cmp_gt_u32 vcc, 32, v1
    v_pk_mul_f32 v[64:65], v[64:65], v[192:193] op_sel:[0,1] op_sel_hi:[1,1]
    v_pk_mul_f32 v[66:67], v[66:67], v[192:193] op_sel:[0,1] op_sel_hi:[1,1]
    v_pk_mul_f32 v[68:69], v[68:69], v[192:193] op_sel:[0,1] op_sel_hi:[1,1]
    v_pk_mul_f32 v[70:71], v[70:71], v[192:193] op_sel:[0,1] op_sel_hi:[1,1]
    v_cvt_pk_bf16_f32 v48, v64, v65
    v_cvt_pk_bf16_f32 v49, v66, v67
    v_cvt_pk_bf16_f32 v50, v68, v69
    v_cvt_pk_bf16_f32 v51, v70, v71
    buffer_store_dwordx4 v[48:51], v2, s[28:31], s75 offen sc1
    v_pk_mul_f32 v[72:73], v[72:73], v[192:193] op_sel:[0,1] op_sel_hi:[1,1]
    v_pk_mul_f32 v[74:75], v[74:75], v[192:193] op_sel:[0,1] op_sel_hi:[1,1]
    v_pk_mul_f32 v[76:77], v[76:77], v[192:193] op_sel:[0,1] op_sel_hi:[1,1]
    v_pk_mul_f32 v[78:79], v[78:79], v[192:193] op_sel:[0,1] op_sel_hi:[1,1]
    v_cvt_pk_bf16_f32 v52, v72, v73
    v_cvt_pk_bf16_f32 v53, v74, v75
    v_cvt_pk_bf16_f32 v54, v76, v77
    v_cvt_pk_bf16_f32 v55, v78, v79
    v_cndmask_b32 v54, 0, v54, vcc
    v_cndmask_b32 v55, 0, v55, vcc
    buffer_store_dwordx4 v[52:55], v2, s[28:31], s75 offen offset:1024 sc1
    v_mfma_f32_32x32x16_bf16 a[64:79], a[184:187], a[204:207], a[64:79]
    s_add_u32 m0, s59, 32768
    s_add_u32 s74, s74, 57344
    buffer_load_dwordx4 v14, s[24:27], s74 offen lds
    v_xor_b32 v241, 2048, v9
    v_mfma_f32_32x32x16_bf16 a[80:95], a[188:191], a[204:207], a[80:95]
    buffer_load_dwordx4 v15, s[24:27], s74 offen offset:1024 lds
    v_xor_b32 v242, 4096, v9
    s_waitcnt vmcnt(18) lgkmcnt(0)
    v_mfma_f32_32x32x16_bf16 v[80:95], a[176:179], a[208:211], v[80:95]
    ds_read_b64_tr_b16 a[184:185], v6 offset:40960
    ds_read_b64_tr_b16 a[186:187], v6 offset:41984
    s_add_u32 m0, s59, 40960
    s_add_u32 s74, s74, 57344
    buffer_load_dwordx4 v14, s[24:27], s74 offen lds
    v_xor_b32 v243, 6144, v9
    v_mfma_f32_32x32x16_bf16 a[48:63], a[180:183], a[208:211], a[48:63]
    ds_read_b64_tr_b16 a[188:189], v7 offset:40960
    ds_read_b64_tr_b16 a[190:191], v7 offset:41984
    buffer_load_dwordx4 v15, s[24:27], s74 offen offset:1024 lds
    v_accvgpr_read_b32 v200, a240
    v_mfma_f32_32x32x16_bf16 a[64:79], a[176:179], a[212:215], a[64:79]
    s_add_u32 m0, s59, 49152
    s_add_u32 s74, s74, 57344
    buffer_load_dwordx4 v14, s[24:27], s74 offen lds
    v_accvgpr_read_b32 v201, a241
    v_mfma_f32_32x32x16_bf16 a[80:95], a[180:183], a[212:215], a[80:95]
    buffer_load_dwordx4 v15, s[24:27], s74 offen offset:1024 lds
    v_accvgpr_read_b32 v202, a242
    s_waitcnt vmcnt(20) lgkmcnt(0)
    v_mfma_f32_32x32x16_bf16 v[80:95], a[184:187], a[216:219], v[80:95]
    ds_read_b64_tr_b16 a[176:177], v6 offset:49152
    ds_read_b64_tr_b16 a[178:179], v6 offset:50176
    v_accvgpr_read_b32 v203, a243
    v_mfma_f32_32x32x16_bf16 a[48:63], a[188:191], a[216:219], a[48:63]
    ds_read_b64_tr_b16 a[180:181], v7 offset:49152
    ds_read_b64_tr_b16 a[182:183], v7 offset:50176
    v_accvgpr_read_b32 v204, a244
    v_mfma_f32_32x32x16_bf16 a[64:79], a[184:187], a[220:223], a[64:79]
    v_accvgpr_read_b32 v205, a245
    v_mfma_f32_32x32x16_bf16 a[80:95], a[188:191], a[220:223], a[80:95]
    v_accvgpr_read_b32 v206, a246
    s_waitcnt vmcnt(18) lgkmcnt(0)
    v_mfma_f32_32x32x16_bf16 v[80:95], a[176:179], a[224:227], v[80:95]
    ds_read_b64_tr_b16 a[184:185], v6 offset:57344
    ds_read_b64_tr_b16 a[186:187], v6 offset:58368
    v_accvgpr_read_b32 v207, a247
    v_mfma_f32_32x32x16_bf16 a[48:63], a[180:183], a[224:227], a[48:63]
    ds_read_b64_tr_b16 a[188:189], v7 offset:57344
    ds_read_b64_tr_b16 a[190:191], v7 offset:58368
    v_permlane32_swap_b32 v200, v202
    v_mfma_f32_32x32x16_bf16 a[64:79], a[176:179], a[228:231], a[64:79]
    v_permlane32_swap_b32 v201, v203
    v_mfma_f32_32x32x16_bf16 a[80:95], a[180:183], a[228:231], a[80:95]
    v_permlane32_swap_b32 v204, v206
    s_waitcnt vmcnt(16) lgkmcnt(0)
    v_mfma_f32_32x32x16_bf16 v[80:95], a[184:187], a[136:139], v[80:95]
    v_add_u32 v6, 0x10000, v6
    v_add_u32 v7, 0x10000, v7
    ds_read_b64_tr_b16 a[176:177], v6 offset:0
    ds_read_b64_tr_b16 a[178:179], v6 offset:1024
    v_permlane32_swap_b32 v205, v207
    v_mfma_f32_32x32x16_bf16 a[48:63], a[188:191], a[136:139], a[48:63]
    ds_read_b64_tr_b16 a[180:181], v7 offset:0
    ds_read_b64_tr_b16 a[182:183], v7 offset:1024
    v_mfma_f32_32x32x16_bf16 a[64:79], a[184:187], a[140:143], a[64:79]
    v_mfma_f32_32x32x16_bf16 a[80:95], a[188:191], a[140:143], a[80:95]
    s_waitcnt vmcnt(14) lgkmcnt(0)
    v_mfma_f32_32x32x16_bf16 v[80:95], a[176:179], a[144:147], v[80:95]
    ds_read_b64_tr_b16 a[184:185], v6 offset:8192
    ds_read_b64_tr_b16 a[186:187], v6 offset:9216
    v_mfma_f32_32x32x16_bf16 a[48:63], a[180:183], a[144:147], a[48:63]
    ds_read_b64_tr_b16 a[188:189], v7 offset:8192
    ds_read_b64_tr_b16 a[190:191], v7 offset:9216
    v_mfma_f32_32x32x16_bf16 a[64:79], a[176:179], a[148:151], a[64:79]
    v_mfma_f32_32x32x16_bf16 a[80:95], a[180:183], a[148:151], a[80:95]
    s_waitcnt vmcnt(12) lgkmcnt(0)
    v_mfma_f32_32x32x16_bf16 v[80:95], a[184:187], a[152:155], v[80:95]
    ds_read_b64_tr_b16 a[176:177], v6 offset:16384
    ds_read_b64_tr_b16 a[178:179], v6 offset:17408
    v_mfma_f32_32x32x16_bf16 a[48:63], a[188:191], a[152:155], a[48:63]
    ds_read_b64_tr_b16 a[180:181], v7 offset:16384
    ds_read_b64_tr_b16 a[182:183], v7 offset:17408
    v_mfma_f32_32x32x16_bf16 a[64:79], a[184:187], a[156:159], a[64:79]
    v_mfma_f32_32x32x16_bf16 a[80:95], a[188:191], a[156:159], a[80:95]
    s_waitcnt vmcnt(10) lgkmcnt(0)
    v_mfma_f32_32x32x16_bf16 v[80:95], a[176:179], a[160:163], v[80:95]
    ds_read_b64_tr_b16 a[184:185], v6 offset:24576
    ds_read_b64_tr_b16 a[186:187], v6 offset:25600
    v_mfma_f32_32x32x16_bf16 a[48:63], a[180:183], a[160:163], a[48:63]
    ds_read_b64_tr_b16 a[188:189], v7 offset:24576
    ds_read_b64_tr_b16 a[190:191], v7 offset:25600
    v_mfma_f32_32x32x16_bf16 a[64:79], a[176:179], a[164:167], a[64:79]
    buffer_load_dword v12, v238, s[40:43], s82 offen sc1
    v_mfma_f32_32x32x16_bf16 a[80:95], a[180:183], a[164:167], a[80:95]
    s_waitcnt vmcnt(9) lgkmcnt(0)
    v_mfma_f32_32x32x16_bf16 v[80:95], a[184:187], a[168:171], v[80:95]
    v_mfma_f32_32x32x16_bf16 a[48:63], a[188:191], a[168:171], a[48:63]
    v_mfma_f32_32x32x16_bf16 a[64:79], a[184:187], a[172:175], a[64:79]
    v_mfma_f32_32x32x16_bf16 a[80:95], a[188:191], a[172:175], a[80:95]
    s_and_b32 s61, s46, 1
    s_mul_i32 s61, s61, 28672
    s_sub_u32 s61, s61, s59
    s_sub_u32 s61, s61, 0x20000
    v_add_u32 v6, s61, v6
    v_add_u32 v7, s61, v7
    v_and_b32 v236, 512, v2
    v_sub_u32 v237, v7, v236
    v_sub_u32 v236, v6, v236
    s_nop 2
    ds_write_b128 v9, a[48:51] offset:16384
    ds_write_b128 v9, a[52:55] offset:17408
    ds_write_b128 v9, a[56:59] offset:24576
    ds_write_b128 v9, a[60:63] offset:25600
    ds_write_b128 v9, a[64:67] offset:32768
    ds_write_b128 v9, a[68:71] offset:33792
    ds_write_b128 v9, a[72:75] offset:40960
    ds_write_b128 v9, a[76:79] offset:41984
    ds_write_b128 v9, a[80:83] offset:49152
    v_lshlrev_b32 v192, 16, v200
    v_and_b32 v193, 0xffff0000, v200
    v_pk_add_f32 v[80:81], v[80:81], v[192:193]
    v_lshlrev_b32 v192, 16, v201
    v_and_b32 v193, 0xffff0000, v201
    v_pk_add_f32 v[82:83], v[82:83], v[192:193]
    v_lshlrev_b32 v192, 16, v202
    v_and_b32 v193, 0xffff0000, v202
    v_pk_add_f32 v[84:85], v[84:85], v[192:193]
    v_lshlrev_b32 v192, 16, v203
    v_and_b32 v193, 0xffff0000, v203
    v_pk_add_f32 v[86:87], v[86:87], v[192:193]
    v_lshlrev_b32 v192, 16, v204
    v_and_b32 v193, 0xffff0000, v204
    v_pk_add_f32 v[88:89], v[88:89], v[192:193]
    v_lshlrev_b32 v192, 16, v205
    v_and_b32 v193, 0xffff0000, v205
    v_pk_add_f32 v[90:91], v[90:91], v[192:193]
    v_lshlrev_b32 v192, 16, v206
    v_and_b32 v193, 0xffff0000, v206
    v_pk_add_f32 v[92:93], v[92:93], v[192:193]
    v_lshlrev_b32 v192, 16, v207
    v_and_b32 v193, 0xffff0000, v207
    v_pk_add_f32 v[94:95], v[94:95], v[192:193]
    s_waitcnt vmcnt(0)
    v_cmp_eq_u32 vcc, -1, v12
    s_nop 0
    s_cmp_eq_u64 vcc, 0
    s_cbranch_scc1 L_po_ok
    s_mov_b32 s65, 32768
L_po_lp:
    s_sleep 1
    buffer_load_dword v12, v238, s[40:43], s82 offen sc1
    s_waitcnt vmcnt(0)
    v_cmp_eq_u32 vcc, -1, v12
    s_nop 0
    s_cmp_eq_u64 vcc, 0
    s_cbranch_scc1 L_po_ok
    s_sub_u32 s65, s65, 1
    s_cmp_lg_u32 s65, 0
    s_cbranch_scc1 L_po_lp
L_po_ok:
    s_mov_b32 s64, s82
    buffer_load_dwordx4 v[128:131], v2, s[40:43], s64 offen offset:0 sc1
    buffer_load_dwordx4 v[132:135], v2, s[40:43], s64 offen offset:1024 sc1
    buffer_load_dwordx4 v[136:139], v2, s[40:43], s64 offen offset:2048 sc1
    buffer_load_dwordx4 v[140:143], v2, s[40:43], s64 offen offset:3072 sc1
    s_add_u32 s64, s64, 4096
    ds_write_b128 v9, a[84:87] offset:50176
    buffer_load_dwordx4 v[144:147], v2, s[40:43], s64 offen offset:0 sc1
    ds_write_b128 v9, a[88:91] offset:57344
    buffer_load_dwordx4 v[148:151], v2, s[40:43], s64 offen offset:1024 sc1
    ds_write_b128 v9, a[92:95] offset:58368
    buffer_load_dwordx4 v[152:155], v2, s[40:43], s64 offen offset:2048 sc1
    s_waitcnt lgkmcnt(0)
    s_barrier
    ds_read_b128 v[16:19], v241 offset:16384
    ds_read_b128 v[20:23], v241 offset:17408
    ds_read_b128 v[24:27], v241 offset:24576
    ds_read_b128 v[28:31], v241 offset:25600
    ds_read_b128 v[32:35], v242 offset:32768
    ds_read_b128 v[36:39], v242 offset:33792
    ds_read_b128 v[40:43], v242 offset:40960
    ds_read_b128 v[44:47], v242 offset:41984
    ds_read_b128 v[48:51], v243 offset:49152
    ds_read_b128 v[52:55], v243 offset:50176
    ds_read_b128 v[56:59], v243 offset:57344
    ds_read_b128 v[60:63], v243 offset:58368
    buffer_load_dwordx4 v[156:159], v2, s[40:43], s64 offen offset:3072 sc1
    s_add_u32 s64, s64, 4096
    s_waitcnt lgkmcnt(10)
    v_pk_add_f32 v[80:81], v[80:81], v[16:17]
    v_pk_add_f32 v[82:83], v[82:83], v[18:19]
    v_pk_add_f32 v[84:85], v[84:85], v[20:21]
    v_pk_add_f32 v[86:87], v[86:87], v[22:23]
    buffer_load_dwordx4 v[160:163], v2, s[40:43], s64 offen offset:0 sc1
    s_waitcnt lgkmcnt(8)
    v_pk_add_f32 v[88:89], v[88:89], v[24:25]
    v_pk_add_f32 v[90:91], v[90:91], v[26:27]
    v_pk_add_f32 v[92:93], v[92:93], v[28:29]
    v_pk_add_f32 v[94:95], v[94:95], v[30:31]
    buffer_load_dwordx4 v[164:167], v2, s[40:43], s64 offen offset:1024 sc1
    s_waitcnt lgkmcnt(6)
    v_pk_add_f32 v[80:81], v[80:81], v[32:33]
    v_pk_add_f32 v[82:83], v[82:83], v[34:35]
    v_pk_add_f32 v[84:85], v[84:85], v[36:37]
    v_pk_add_f32 v[86:87], v[86:87], v[38:39]
    buffer_load_dwordx4 v[168:171], v2, s[40:43], s64 offen offset:2048 sc1
    s_waitcnt lgkmcnt(4)
    ds_read_b64_tr_b16 a[0:1], v6 offset:0
    ds_read_b64_tr_b16 a[2:3], v6 offset:1024
    ds_read_b64_tr_b16 a[4:5], v7 offset:0
    ds_read_b64_tr_b16 a[6:7], v7 offset:1024
    v_pk_add_f32 v[88:89], v[88:89], v[40:41]
    v_pk_add_f32 v[90:91], v[90:91], v[42:43]
    v_pk_add_f32 v[92:93], v[92:93], v[44:45]
    v_pk_add_f32 v[94:95], v[94:95], v[46:47]
    buffer_load_dwordx4 v[172:175], v2, s[40:43], s64 offen offset:3072 sc1
    s_add_u32 s64, s64, 4096
    s_waitcnt lgkmcnt(6)
    ds_read_b64_tr_b16 a[8:9], v6 offset:2048
    ds_read_b64_tr_b16 a[10:11], v6 offset:3072
    ds_read_b64_tr_b16 a[12:13], v7 offset:2048
    ds_read_b64_tr_b16 a[14:15], v7 offset:3072
    v_pk_add_f32 v[80:81], v[80:81], v[48:49]
    v_pk_add_f32 v[82:83], v[82:83], v[50:51]
    v_pk_add_f32 v[84:85], v[84:85], v[52:53]
    v_pk_add_f32 v[86:87], v[86:87], v[54:55]
    buffer_load_dwordx4 v[176:179], v2, s[40:43], s64 offen offset:0 sc1
    s_waitcnt lgkmcnt(8)
    ds_read_b64_tr_b16 a[16:17], v6 offset:3584
    ds_read_b64_tr_b16 a[18:19], v6 offset:4608
    ds_read_b64_tr_b16 a[20:21], v7 offset:3584
    ds_read_b64_tr_b16 a[22:23], v7 offset:4608
    v_pk_add_f32 v[88:89], v[88:89], v[56:57]
    v_pk_add_f32 v[90:91], v[90:91], v[58:59]
    v_pk_add_f32 v[92:93], v[92:93], v[60:61]
    v_pk_add_f32 v[94:95], v[94:95], v[62:63]
    s_waitcnt vmcnt(12) lgkmcnt(8)
    v_mfma_f32_32x32x16_bf16 v[112:127], a[4:7], v[128:131], 0
    ds_read_b64_tr_b16 a[28:29], v7 offset:5632
    ds_read_b64_tr_b16 a[30:31], v7 offset:6656
    v_mfma_f32_32x32x16_bf16 v[96:111], a[0:3], v[128:131], v[80:95]
    ds_read_b64_tr_b16 a[24:25], v6 offset:5632
    ds_read_b64_tr_b16 a[26:27], v6 offset:6656
    buffer_load_dwordx4 v[180:183], v2, s[40:43], s64 offen offset:1024 sc1
    s_waitcnt vmcnt(12) lgkmcnt(8)
    v_mfma_f32_32x32x16_bf16 v[96:111], a[8:11], v[132:135], v[96:111]
    ds_read_b64_tr_b16 a[0:1], v6 offset:7168
    ds_read_b64_tr_b16 a[2:3], v6 offset:8192
    buffer_load_dwordx4 v[184:187], v2, s[40:43], s64 offen offset:2048 sc1
    v_mfma_f32_32x32x16_bf16 v[112:127], a[12:15], v[132:135], v[112:127]
    ds_read_b64_tr_b16 a[4:5], v7 offset:7168
    ds_read_b64_tr_b16 a[6:7], v7 offset:8192
    s_waitcnt vmcnt(12) lgkmcnt(8)
    v_mfma_f32_32x32x16_bf16 v[96:111], a[16:19], v[136:139], v[96:111]
    ds_read_b64_tr_b16 a[8:9], v6 offset:9216
    ds_read_b64_tr_b16 a[10:11], v6 offset:10240
    buffer_load_dwordx4 v[188:191], v2, s[40:43], s64 offen offset:3072 sc1
    v_mfma_f32_32x32x16_bf16 v[112:127], a[20:23], v[136:139], v[112:127]
    ds_read_b64_tr_b16 a[12:13], v7 offset:9216
    ds_read_b64_tr_b16 a[14:15], v7 offset:10240
    s_waitcnt vmcnt(12) lgkmcnt(8)
    v_mfma_f32_32x32x16_bf16 v[96:111], a[24:27], v[140:143], v[96:111]
    ds_read_b64_tr_b16 a[16:17], v6 offset:10752
    ds_read_b64_tr_b16 a[18:19], v6 offset:11776
    v_mfma_f32_32x32x16_bf16 v[112:127], a[28:31], v[140:143], v[112:127]
    ds_read_b64_tr_b16 a[20:21], v7 offset:10752
    ds_read_b64_tr_b16 a[22:23], v7 offset:11776
    s_waitcnt vmcnt(11) lgkmcnt(8)
    v_mfma_f32_32x32x16_bf16 v[96:111], a[0:3], v[144:147], v[96:111]
    ds_read_b64_tr_b16 a[24:25], v6 offset:12800
    ds_read_b64_tr_b16 a[26:27], v6 offset:13824
    v_mfma_f32_32x32x16_bf16 v[112:127], a[4:7], v[144:147], v[112:127]
    ds_read_b64_tr_b16 a[28:29], v7 offset:12800
    ds_read_b64_tr_b16 a[30:31], v7 offset:13824
    s_waitcnt vmcnt(10) lgkmcnt(8)
    v_mfma_f32_32x32x16_bf16 v[96:111], a[8:11], v[148:151], v[96:111]
    ds_read_b64_tr_b16 a[0:1], v6 offset:14336
    ds_read_b64_tr_b16 a[2:3], v6 offset:15360
    v_mfma_f32_32x32x16_bf16 v[112:127], a[12:15], v[148:151], v[112:127]
    ds_read_b64_tr_b16 a[4:5], v7 offset:14336
    ds_read_b64_tr_b16 a[6:7], v7 offset:15360
    s_waitcnt vmcnt(9) lgkmcnt(8)
    v_mfma_f32_32x32x16_bf16 v[96:111], a[16:19], v[152:155], v[96:111]
    ds_read_b64_tr_b16 a[8:9], v6 offset:16384
    ds_read_b64_tr_b16 a[10:11], v6 offset:17408
    v_mfma_f32_32x32x16_bf16 v[112:127], a[20:23], v[152:155], v[112:127]
    ds_read_b64_tr_b16 a[12:13], v7 offset:16384
    ds_read_b64_tr_b16 a[14:15], v7 offset:17408
    s_waitcnt vmcnt(8) lgkmcnt(8)
    v_mfma_f32_32x32x16_bf16 v[96:111], a[24:27], v[156:159], v[96:111]
    ds_read_b64_tr_b16 a[16:17], v6 offset:17920
    ds_read_b64_tr_b16 a[18:19], v6 offset:18944
    v_mfma_f32_32x32x16_bf16 v[112:127], a[28:31], v[156:159], v[112:127]
    ds_read_b64_tr_b16 a[20:21], v7 offset:17920
    ds_read_b64_tr_b16 a[22:23], v7 offset:18944
    s_waitcnt vmcnt(7) lgkmcnt(8)
    v_mfma_f32_32x32x16_bf16 v[96:111], a[0:3], v[160:163], v[96:111]
    ds_read_b64_tr_b16 a[24:25], v6 offset:19968
    ds_read_b64_tr_b16 a[26:27], v6 offset:20992
    v_mfma_f32_32x32x16_bf16 v[112:127], a[4:7], v[160:163], v[112:127]
    ds_read_b64_tr_b16 a[28:29], v7 offset:19968
    ds_read_b64_tr_b16 a[30:31], v7 offset:20992
    s_waitcnt vmcnt(6) lgkmcnt(8)
    v_mfma_f32_32x32x16_bf16 v[96:111], a[8:11], v[164:167], v[96:111]
    ds_read_b64_tr_b16 a[0:1], v6 offset:21504
    ds_read_b64_tr_b16 a[2:3], v6 offset:22528
    v_mfma_f32_32x32x16_bf16 v[112:127], a[12:15], v[164:167], v[112:127]
    ds_read_b64_tr_b16 a[4:5], v7 offset:21504
    ds_read_b64_tr_b16 a[6:7], v7 offset:22528
    s_waitcnt vmcnt(5) lgkmcnt(8)
    v_mfma_f32_32x32x16_bf16 v[96:111], a[16:19], v[168:171], v[96:111]
    ds_read_b64_tr_b16 a[8:9], v6 offset:23552
    ds_read_b64_tr_b16 a[10:11], v6 offset:24576
    v_mfma_f32_32x32x16_bf16 v[112:127], a[20:23], v[168:171], v[112:127]
    ds_read_b64_tr_b16 a[12:13], v7 offset:23552
    ds_read_b64_tr_b16 a[14:15], v7 offset:24576
    s_waitcnt vmcnt(4) lgkmcnt(8)
    v_mfma_f32_32x32x16_bf16 v[96:111], a[24:27], v[172:175], v[96:111]
    ds_read_b64_tr_b16 a[16:17], v6 offset:25088
    ds_read_b64_tr_b16 a[18:19], v6 offset:26112
    v_mfma_f32_32x32x16_bf16 v[112:127], a[28:31], v[172:175], v[112:127]
    ds_read_b64_tr_b16 a[20:21], v7 offset:25088
    ds_read_b64_tr_b16 a[22:23], v7 offset:26112
    s_waitcnt vmcnt(3) lgkmcnt(8)
    v_mfma_f32_32x32x16_bf16 v[96:111], a[0:3], v[176:179], v[96:111]
    ds_read_b64_tr_b16 a[24:25], v6 offset:27136
    ds_read_b64_tr_b16 a[26:27], v236 offset:28160
    v_mfma_f32_32x32x16_bf16 v[112:127], a[4:7], v[176:179], v[112:127]
    ds_read_b64_tr_b16 a[28:29], v7 offset:27136
    ds_read_b64_tr_b16 a[30:31], v237 offset:28160
    s_waitcnt vmcnt(2) lgkmcnt(8)
    v_mfma_f32_32x32x16_bf16 v[96:111], a[8:11], v[180:183], v[96:111]
    v_mfma_f32_32x32x16_bf16 v[112:127], a[12:15], v[180:183], v[112:127]
    s_waitcnt vmcnt(1) lgkmcnt(4)
    v_mfma_f32_32x32x16_bf16 v[96:111], a[16:19], v[184:187], v[96:111]
    v_mfma_f32_32x32x16_bf16 v[112:127], a[20:23], v[184:187], v[112:127]
    s_waitcnt vmcnt(0) lgkmcnt(0)
    v_mfma_f32_32x32x16_bf16 v[112:127], a[28:31], v[188:191], v[112:127]
    v_mfma_f32_32x32x16_bf16 v[96:111], a[24:27], v[188:191], v[96:111]
L_gchk:
    v_xor_b32 v241, 2048, v9
    s_nop 9
    v_cmp_u_f32 vcc, v112, v112
    ds_write_b128 v9, v[112:115] offset:0
    ds_write_b128 v9, v[116:119] offset:1024
    ds_write_b128 v9, v[120:123] offset:8192
    ds_write_b128 v9, v[124:127] offset:9216
    s_andn2_b64 vcc, vcc, s[76:77]
    s_cmp_eq_u64 vcc, 0
    s_cbranch_scc0 L_retry
    s_waitcnt lgkmcnt(0)
    s_barrier
    ds_read_b128 v[16:19], v241 offset:0
    ds_read_b128 v[20:23], v241 offset:1024
    ds_read_b128 v[24:27], v241 offset:8192
    ds_read_b128 v[28:31], v241 offset:9216
    s_waitcnt lgkmcnt(3)
    v_pk_add_f32 v[96:97], v[96:97], v[16:17]
    v_pk_add_f32 v[98:99], v[98:99], v[18:19]
    v_cvt_pk_bf16_f32 v80, v96, v97
    v_cvt_pk_bf16_f32 v81, v98, v99
    s_waitcnt lgkmcnt(2)
    v_pk_add_f32 v[100:101], v[100:101], v[20:21]
    v_pk_add_f32 v[102:103], v[102:103], v[22:23]
    v_cvt_pk_bf16_f32 v82, v100, v101
    v_cvt_pk_bf16_f32 v83, v102, v103
    s_nop 1
    v_permlane32_swap_b32 v80, v82
    v_permlane32_swap_b32 v81, v83
    buffer_store_dwordx4 v[80:83], v255, s[32:35], s80 offen offset:0
    s_waitcnt lgkmcnt(1)
    v_pk_add_f32 v[104:105], v[104:105], v[24:25]
    v_pk_add_f32 v[106:107], v[106:107], v[26:27]
    v_cvt_pk_bf16_f32 v84, v104, v105
    v_cvt_pk_bf16_f32 v85, v106, v107
    s_waitcnt lgkmcnt(0)
    v_pk_add_f32 v[108:109], v[108:109], v[28:29]
    v_pk_add_f32 v[110:111], v[110:111], v[30:31]
    v_cvt_pk_bf16_f32 v86, v108, v109
    v_cvt_pk_bf16_f32 v87, v110, v111
    s_nop 1
    v_permlane32_swap_b32 v84, v86
    v_permlane32_swap_b32 v85, v87
    buffer_store_dwordx4 v[84:87], v255, s[32:35], s80 offen offset:32
L_fin:
L_end:
    s_endpgm
L_fb:
    s_mov_b32 s61, 0x300000
    v_mov_b32 v194, 0xff800000
L_fb1:
    buffer_load_dwordx4 v[200:203], v2, s[28:31], s61 offen offset:0 sc1
    buffer_load_dwordx4 v[204:207], v2, s[28:31], s61 offen offset:1024 sc1
    s_waitcnt vmcnt(0)
    v_mfma_f32_32x32x16_bf16 v[16:31], v[200:203], a[120:123], 0
    v_mfma_f32_32x32x16_bf16 v[16:31], v[204:207], a[124:127], v[16:31]
    s_add_u32 s61, s61, 4096
    s_nop 11
    v_max3_f32 v194, v194, v16, v17
    v_max3_f32 v194, v194, v18, v19
    v_max3_f32 v194, v194, v20, v21
    v_max3_f32 v194, v194, v22, v23
    v_max3_f32 v194, v194, v24, v25
    v_max3_f32 v194, v194, v26, v27
    v_max3_f32 v194, v194, v28, v29
    v_max3_f32 v194, v194, v30, v31
    s_cmp_lt_u32 s61, 0x340000
    s_cbranch_scc1 L_fb1
    v_mov_b32 v192, v194
    s_mov_b32 s61, 0x300000
    s_nop 0
    v_permlane32_swap_b32 v192, v194
    v_max_f32 v194, v194, v192
    v_mov_b32 v64, 0
    v_mov_b32 v65, 0
    v_mov_b32 v66, 0
    v_mov_b32 v67, 0
    v_mov_b32 v68, 0
    v_mov_b32 v69, 0
    v_mov_b32 v70, 0
    v_mov_b32 v71, 0
    v_mov_b32 v72, 0
    v_mov_b32 v73, 0
    v_mov_b32 v74, 0
    v_mov_b32 v75, 0
    v_mov_b32 v76, 0
    v_mov_b32 v77, 0
    v_mov_b32 v78, 0
    v_mov_b32 v79, 0
L_fb2:
    buffer_load_dwordx4 v[200:203], v2, s[28:31], s61 offen offset:0 sc1
    buffer_load_dwordx4 v[204:207], v2, s[28:31], s61 offen offset:1024 sc1
    buffer_load_dwordx4 v[208:211], v2, s[28:31], s61 offen offset:2048 sc1
    buffer_load_dwordx4 v[212:215], v2, s[28:31], s61 offen offset:3072 sc1
    s_waitcnt vmcnt(0)
    v_mfma_f32_32x32x16_bf16 v[16:31], v[200:203], a[120:123], 0
    v_mfma_f32_32x32x16_bf16 v[16:31], v[204:207], a[124:127], v[16:31]
    s_add_u32 s61, s61, 4096
    s_nop 11
    v_sub_f32 v16, v16, v194
    v_sub_f32 v17, v17, v194
    v_sub_f32 v18, v18, v194
    v_sub_f32 v19, v19, v194
    v_sub_f32 v20, v20, v194
    v_sub_f32 v21, v21, v194
    v_sub_f32 v22, v22, v194
    v_sub_f32 v23, v23, v194
    v_sub_f32 v24, v24, v194
    v_sub_f32 v25, v25, v194
    v_sub_f32 v26, v26, v194
    v_sub_f32 v27, v27, v194
    v_sub_f32 v28, v28, v194
    v_sub_f32 v29, v29, v194
    v_sub_f32 v30, v30, v194
    v_sub_f32 v31, v31, v194
    v_exp_f32 v16, v16
    v_exp_f32 v17, v17
    v_exp_f32 v18, v18
    v_exp_f32 v19, v19
    v_exp_f32 v20, v20
    v_exp_f32 v21, v21
    v_exp_f32 v22, v22
    v_exp_f32 v23, v23
    v_exp_f32 v24, v24
    v_exp_f32 v25, v25
    v_exp_f32 v26, v26
    v_exp_f32 v27, v27
    v_exp_f32 v28, v28
    v_exp_f32 v29, v29
    v_exp_f32 v30, v30
    v_exp_f32 v31, v31
    s_nop 0
    v_cvt_pk_bf16_f32 v48, v16, v17
    v_cvt_pk_bf16_f32 v49, v18, v19
    v_cvt_pk_bf16_f32 v50, v20, v21
    v_cvt_pk_bf16_f32 v51, v22, v23
    v_cvt_pk_bf16_f32 v52, v24, v25
    v_cvt_pk_bf16_f32 v53, v26, v27
    v_cvt_pk_bf16_f32 v54, v28, v29
    v_cvt_pk_bf16_f32 v55, v30, v31
    s_nop 1
    v_mfma_f32_32x32x16_bf16 v[64:79], v[208:211], v[48:51], v[64:79]
    v_mfma_f32_32x32x16_bf16 v[64:79], v[212:215], v[52:55], v[64:79]
    s_cmp_lt_u32 s61, 0x340000
    s_nop 7
    s_cbranch_scc1 L_fb2
    s_nop 7
    v_mov_b32 v192, v76
    v_mov_b32 v193, v76
    s_nop 1
    v_permlane32_swap_b32 v192, v193
    v_rcp_f32 v193, v193
    s_nop 1
    s_branch L_fb_ret
L_retry:
    s_mov_b32 s65, 4096
L_retry1:
    s_sleep 8
    s_mov_b32 s64, s82
    buffer_load_dwordx4 v[128:131], v2, s[40:43], s64 offen offset:0 sc1
    buffer_load_dwordx4 v[132:135], v2, s[40:43], s64 offen offset:1024 sc1
    buffer_load_dwordx4 v[136:139], v2, s[40:43], s64 offen offset:2048 sc1
    buffer_load_dwordx4 v[140:143], v2, s[40:43], s64 offen offset:3072 sc1
    s_add_u32 s64, s64, 4096
    buffer_load_dwordx4 v[144:147], v2, s[40:43], s64 offen offset:0 sc1
    buffer_load_dwordx4 v[148:151], v2, s[40:43], s64 offen offset:1024 sc1
    buffer_load_dwordx4 v[152:155], v2, s[40:43], s64 offen offset:2048 sc1
    buffer_load_dwordx4 v[156:159], v2, s[40:43], s64 offen offset:3072 sc1
    s_add_u32 s64, s64, 4096
    buffer_load_dwordx4 v[160:163], v2, s[40:43], s64 offen offset:0 sc1
    buffer_load_dwordx4 v[164:167], v2, s[40:43], s64 offen offset:1024 sc1
    buffer_load_dwordx4 v[168:171], v2, s[40:43], s64 offen offset:2048 sc1
    buffer_load_dwordx4 v[172:175], v2, s[40:43], s64 offen offset:3072 sc1
    s_add_u32 s64, s64, 4096
    buffer_load_dwordx4 v[176:179], v2, s[40:43], s64 offen offset:0 sc1
    buffer_load_dwordx4 v[180:183], v2, s[40:43], s64 offen offset:1024 sc1
    buffer_load_dwordx4 v[184:187], v2, s[40:43], s64 offen offset:2048 sc1
    buffer_load_dwordx4 v[188:191], v2, s[40:43], s64 offen offset:3072 sc1
    s_waitcnt vmcnt(0) lgkmcnt(0)
    v_max_u32 v192, v128, v129
    v_max3_u32 v192, v192, v130, v131
    v_max3_u32 v192, v192, v132, v133
    v_max3_u32 v192, v192, v134, v135
    v_max3_u32 v192, v192, v136, v137
    v_max3_u32 v192, v192, v138, v139
    v_max3_u32 v192, v192, v140, v141
    v_max3_u32 v192, v192, v142, v143
    v_max3_u32 v192, v192, v144, v145
    v_max3_u32 v192, v192, v146, v147
    v_max3_u32 v192, v192, v148, v149
    v_max3_u32 v192, v192, v150, v151
    v_max3_u32 v192, v192, v152, v153
    v_max3_u32 v192, v192, v154, v155
    v_max3_u32 v192, v192, v156, v157
    v_max3_u32 v192, v192, v158, v159
    v_max3_u32 v192, v192, v160, v161
    v_max3_u32 v192, v192, v162, v163
    v_max3_u32 v192, v192, v164, v165
    v_max3_u32 v192, v192, v166, v167
    v_max3_u32 v192, v192, v168, v169
    v_max3_u32 v192, v192, v170, v171
    v_max3_u32 v192, v192, v172, v173
    v_max3_u32 v192, v192, v174, v175
    v_max3_u32 v192, v192, v176, v177
    v_max3_u32 v192, v192, v178, v179
    v_max3_u32 v192, v192, v180, v181
    v_max3_u32 v192, v192, v182, v183
    v_max3_u32 v192, v192, v184, v185
    v_max3_u32 v192, v192, v186, v187
    v_max3_u32 v192, v192, v188, v189
    v_max3_u32 v192, v192, v190, v191
    v_cmp_eq_u32 vcc, -1, v192
    s_sub_u32 s65, s65, 1
    s_cmp_eq_u64 vcc, 0
    s_cbranch_scc1 L_retry2
    s_cmp_lg_u32 s65, 0
    s_cbranch_scc1 L_retry1
L_retry2:
    s_mov_b64 s[76:77], -1
    ds_read_b64_tr_b16 a[0:1], v6 offset:0
    ds_read_b64_tr_b16 a[2:3], v6 offset:1024
    ds_read_b64_tr_b16 a[4:5], v7 offset:0
    ds_read_b64_tr_b16 a[6:7], v7 offset:1024
    s_waitcnt lgkmcnt(0)
    v_mfma_f32_32x32x16_bf16 v[112:127], a[4:7], v[128:131], 0
    v_mfma_f32_32x32x16_bf16 v[96:111], a[0:3], v[128:131], v[80:95]
    ds_read_b64_tr_b16 a[8:9], v6 offset:2048
    ds_read_b64_tr_b16 a[10:11], v6 offset:3072
    ds_read_b64_tr_b16 a[12:13], v7 offset:2048
    ds_read_b64_tr_b16 a[14:15], v7 offset:3072
    s_waitcnt lgkmcnt(0)
    v_mfma_f32_32x32x16_bf16 v[112:127], a[12:15], v[132:135], v[112:127]
    v_mfma_f32_32x32x16_bf16 v[96:111], a[8:11], v[132:135], v[96:111]
    ds_read_b64_tr_b16 a[16:17], v6 offset:3584
    ds_read_b64_tr_b16 a[18:19], v6 offset:4608
    ds_read_b64_tr_b16 a[20:21], v7 offset:3584
    ds_read_b64_tr_b16 a[22:23], v7 offset:4608
    s_waitcnt lgkmcnt(0)
    v_mfma_f32_32x32x16_bf16 v[112:127], a[20:23], v[136:139], v[112:127]
    v_mfma_f32_32x32x16_bf16 v[96:111], a[16:19], v[136:139], v[96:111]
    ds_read_b64_tr_b16 a[24:25], v6 offset:5632
    ds_read_b64_tr_b16 a[26:27], v6 offset:6656
    ds_read_b64_tr_b16 a[28:29], v7 offset:5632
    ds_read_b64_tr_b16 a[30:31], v7 offset:6656
    s_waitcnt lgkmcnt(0)
    v_mfma_f32_32x32x16_bf16 v[112:127], a[28:31], v[140:143], v[112:127]
    v_mfma_f32_32x32x16_bf16 v[96:111], a[24:27], v[140:143], v[96:111]
    ds_read_b64_tr_b16 a[0:1], v6 offset:7168
    ds_read_b64_tr_b16 a[2:3], v6 offset:8192
    ds_read_b64_tr_b16 a[4:5], v7 offset:7168
    ds_read_b64_tr_b16 a[6:7], v7 offset:8192
    s_waitcnt lgkmcnt(0)
    v_mfma_f32_32x32x16_bf16 v[112:127], a[4:7], v[144:147], v[112:127]
    v_mfma_f32_32x32x16_bf16 v[96:111], a[0:3], v[144:147], v[96:111]
    ds_read_b64_tr_b16 a[8:9], v6 offset:9216
    ds_read_b64_tr_b16 a[10:11], v6 offset:10240
    ds_read_b64_tr_b16 a[12:13], v7 offset:9216
    ds_read_b64_tr_b16 a[14:15], v7 offset:10240
    s_waitcnt lgkmcnt(0)
    v_mfma_f32_32x32x16_bf16 v[112:127], a[12:15], v[148:151], v[112:127]
    v_mfma_f32_32x32x16_bf16 v[96:111], a[8:11], v[148:151], v[96:111]
    ds_read_b64_tr_b16 a[16:17], v6 offset:10752
    ds_read_b64_tr_b16 a[18:19], v6 offset:11776
    ds_read_b64_tr_b16 a[20:21], v7 offset:10752
    ds_read_b64_tr_b16 a[22:23], v7 offset:11776
    s_waitcnt lgkmcnt(0)
    v_mfma_f32_32x32x16_bf16 v[112:127], a[20:23], v[152:155], v[112:127]
    v_mfma_f32_32x32x16_bf16 v[96:111], a[16:19], v[152:155], v[96:111]
    ds_read_b64_tr_b16 a[24:25], v6 offset:12800
    ds_read_b64_tr_b16 a[26:27], v6 offset:13824
    ds_read_b64_tr_b16 a[28:29], v7 offset:12800
    ds_read_b64_tr_b16 a[30:31], v7 offset:13824
    s_waitcnt lgkmcnt(0)
    v_mfma_f32_32x32x16_bf16 v[112:127], a[28:31], v[156:159], v[112:127]
    v_mfma_f32_32x32x16_bf16 v[96:111], a[24:27], v[156:159], v[96:111]
    ds_read_b64_tr_b16 a[0:1], v6 offset:14336
    ds_read_b64_tr_b16 a[2:3], v6 offset:15360
    ds_read_b64_tr_b16 a[4:5], v7 offset:14336
    ds_read_b64_tr_b16 a[6:7], v7 offset:15360
    s_waitcnt lgkmcnt(0)
    v_mfma_f32_32x32x16_bf16 v[112:127], a[4:7], v[160:163], v[112:127]
    v_mfma_f32_32x32x16_bf16 v[96:111], a[0:3], v[160:163], v[96:111]
    ds_read_b64_tr_b16 a[8:9], v6 offset:16384
    ds_read_b64_tr_b16 a[10:11], v6 offset:17408
    ds_read_b64_tr_b16 a[12:13], v7 offset:16384
    ds_read_b64_tr_b16 a[14:15], v7 offset:17408
    s_waitcnt lgkmcnt(0)
    v_mfma_f32_32x32x16_bf16 v[112:127], a[12:15], v[164:167], v[112:127]
    v_mfma_f32_32x32x16_bf16 v[96:111], a[8:11], v[164:167], v[96:111]
    ds_read_b64_tr_b16 a[16:17], v6 offset:17920
    ds_read_b64_tr_b16 a[18:19], v6 offset:18944
    ds_read_b64_tr_b16 a[20:21], v7 offset:17920
    ds_read_b64_tr_b16 a[22:23], v7 offset:18944
    s_waitcnt lgkmcnt(0)
    v_mfma_f32_32x32x16_bf16 v[112:127], a[20:23], v[168:171], v[112:127]
    v_mfma_f32_32x32x16_bf16 v[96:111], a[16:19], v[168:171], v[96:111]
    ds_read_b64_tr_b16 a[24:25], v6 offset:19968
    ds_read_b64_tr_b16 a[26:27], v6 offset:20992
    ds_read_b64_tr_b16 a[28:29], v7 offset:19968
    ds_read_b64_tr_b16 a[30:31], v7 offset:20992
    s_waitcnt lgkmcnt(0)
    v_mfma_f32_32x32x16_bf16 v[112:127], a[28:31], v[172:175], v[112:127]
    v_mfma_f32_32x32x16_bf16 v[96:111], a[24:27], v[172:175], v[96:111]
    ds_read_b64_tr_b16 a[0:1], v6 offset:21504
    ds_read_b64_tr_b16 a[2:3], v6 offset:22528
    ds_read_b64_tr_b16 a[4:5], v7 offset:21504
    ds_read_b64_tr_b16 a[6:7], v7 offset:22528
    s_waitcnt lgkmcnt(0)
    v_mfma_f32_32x32x16_bf16 v[112:127], a[4:7], v[176:179], v[112:127]
    v_mfma_f32_32x32x16_bf16 v[96:111], a[0:3], v[176:179], v[96:111]
    ds_read_b64_tr_b16 a[8:9], v6 offset:23552
    ds_read_b64_tr_b16 a[10:11], v6 offset:24576
    ds_read_b64_tr_b16 a[12:13], v7 offset:23552
    ds_read_b64_tr_b16 a[14:15], v7 offset:24576
    s_waitcnt lgkmcnt(0)
    v_mfma_f32_32x32x16_bf16 v[112:127], a[12:15], v[180:183], v[112:127]
    v_mfma_f32_32x32x16_bf16 v[96:111], a[8:11], v[180:183], v[96:111]
    ds_read_b64_tr_b16 a[16:17], v6 offset:25088
    ds_read_b64_tr_b16 a[18:19], v6 offset:26112
    ds_read_b64_tr_b16 a[20:21], v7 offset:25088
    ds_read_b64_tr_b16 a[22:23], v7 offset:26112
    s_waitcnt lgkmcnt(0)
    v_mfma_f32_32x32x16_bf16 v[112:127], a[20:23], v[184:187], v[112:127]
    v_mfma_f32_32x32x16_bf16 v[96:111], a[16:19], v[184:187], v[96:111]
    ds_read_b64_tr_b16 a[24:25], v6 offset:27136
    ds_read_b64_tr_b16 a[26:27], v236 offset:28160
    ds_read_b64_tr_b16 a[28:29], v7 offset:27136
    ds_read_b64_tr_b16 a[30:31], v237 offset:28160
    s_waitcnt lgkmcnt(0)
    v_mfma_f32_32x32x16_bf16 v[112:127], a[28:31], v[188:191], v[112:127]
    v_mfma_f32_32x32x16_bf16 v[96:111], a[24:27], v[188:191], v[96:111]
    s_branch L_gchk
L_p2q:
    s_waitcnt vmcnt(17)
    v_mfma_f32_32x32x16_bf16 v[16:31], a[128:131], a[96:99], 0
    v_mfma_f32_32x32x16_bf16 v[16:31], a[132:135], a[100:103], v[16:31]
    s_nop 10
    v_mfma_f32_32x32x16_bf16 v[32:47], a[128:131], a[104:107], 0
    v_exp_f32 v16, v16
    v_exp_f32 v17, v17
    v_exp_f32 v18, v18
    v_exp_f32 v19, v19
    v_cvt_pk_bf16_f32 v48, v16, v17
    v_exp_f32 v20, v20
    v_exp_f32 v21, v21
    v_cvt_pk_bf16_f32 v49, v18, v19
    v_mfma_f32_32x32x16_bf16 v[32:47], a[132:135], a[108:111], v[32:47]
    v_exp_f32 v22, v22
    v_exp_f32 v23, v23
    v_cvt_pk_bf16_f32 v50, v20, v21
    v_cvt_pk_bf16_f32 v51, v22, v23
    v_exp_f32 v24, v24
    v_exp_f32 v25, v25
    v_exp_f32 v26, v26
    v_exp_f32 v27, v27
    v_mfma_f32_32x32x16_bf16 a[32:47], a[136:139], v[48:51], 0
    buffer_load_dwordx4 a[160:163], v2, s[28:31], s70 offen offset:0 sc1
    v_cvt_pk_bf16_f32 v52, v24, v25
    v_exp_f32 v28, v28
    v_exp_f32 v29, v29
    v_cvt_pk_bf16_f32 v53, v26, v27
    v_exp_f32 v30, v30
    v_exp_f32 v31, v31
    v_cvt_pk_bf16_f32 v54, v28, v29
    v_cvt_pk_bf16_f32 v55, v30, v31
    v_mfma_f32_32x32x16_bf16 v[16:31], a[128:131], a[112:115], 0
    v_exp_f32 v32, v32
    v_exp_f32 v33, v33
    v_exp_f32 v34, v34
    v_exp_f32 v35, v35
    v_cvt_pk_bf16_f32 v56, v32, v33
    v_exp_f32 v36, v36
    v_mfma_f32_32x32x16_bf16 v[16:31], a[132:135], a[116:119], v[16:31]
    v_exp_f32 v37, v37
    v_cvt_pk_bf16_f32 v57, v34, v35
    v_exp_f32 v38, v38
    v_exp_f32 v39, v39
    v_cvt_pk_bf16_f32 v58, v36, v37
    v_cvt_pk_bf16_f32 v59, v38, v39
    v_mfma_f32_32x32x16_bf16 a[32:47], a[140:143], v[52:55], a[32:47]
    buffer_load_dwordx4 a[164:167], v2, s[28:31], s70 offen offset:1024 sc1
    v_exp_f32 v40, v40
    v_exp_f32 v41, v41
    v_exp_f32 v42, v42
    v_exp_f32 v43, v43
    v_cvt_pk_bf16_f32 v60, v40, v41
    v_mfma_f32_32x32x16_bf16 a[16:31], a[136:139], v[56:59], 0
    v_exp_f32 v44, v44
    v_exp_f32 v45, v45
    v_cvt_pk_bf16_f32 v61, v42, v43
    v_exp_f32 v46, v46
    v_exp_f32 v47, v47
    v_cvt_pk_bf16_f32 v62, v44, v45
    v_cvt_pk_bf16_f32 v63, v46, v47
    v_mfma_f32_32x32x16_bf16 v[32:47], a[128:131], a[120:123], 0
    v_exp_f32 v16, v16
    v_exp_f32 v17, v17
    v_exp_f32 v18, v18
    v_exp_f32 v19, v19
    v_cvt_pk_bf16_f32 v48, v16, v17
    v_exp_f32 v20, v20
    v_mfma_f32_32x32x16_bf16 v[32:47], a[132:135], a[124:127], v[32:47]
    v_exp_f32 v21, v21
    v_cvt_pk_bf16_f32 v49, v18, v19
    v_exp_f32 v22, v22
    v_exp_f32 v23, v23
    v_cvt_pk_bf16_f32 v50, v20, v21
    v_cvt_pk_bf16_f32 v51, v22, v23
    v_mfma_f32_32x32x16_bf16 a[16:31], a[140:143], v[60:63], a[16:31]
    buffer_load_dwordx4 a[168:171], v2, s[28:31], s70 offen offset:2048 sc1
    v_exp_f32 v24, v24
    v_exp_f32 v25, v25
    v_exp_f32 v26, v26
    v_exp_f32 v27, v27
    v_cvt_pk_bf16_f32 v52, v24, v25
    v_mfma_f32_32x32x16_bf16 a[0:15], a[136:139], v[48:51], 0
    v_exp_f32 v28, v28
    v_exp_f32 v29, v29
    v_cvt_pk_bf16_f32 v53, v26, v27
    v_exp_f32 v30, v30
    v_exp_f32 v31, v31
    v_cvt_pk_bf16_f32 v54, v28, v29
    v_cvt_pk_bf16_f32 v55, v30, v31
    v_mfma_f32_32x32x16_bf16 v[16:31], a[144:147], a[96:99], 0
    v_exp_f32 v32, v32
    v_exp_f32 v33, v33
    v_exp_f32 v34, v34
    v_exp_f32 v35, v35
    v_cvt_pk_bf16_f32 v56, v32, v33
    v_mfma_f32_32x32x16_bf16 v[16:31], a[148:151], a[100:103], v[16:31]
    v_exp_f32 v36, v36
    v_exp_f32 v37, v37
    v_cvt_pk_bf16_f32 v57, v34, v35
    v_exp_f32 v38, v38
    v_exp_f32 v39, v39
    v_cvt_pk_bf16_f32 v58, v36, v37
    v_cvt_pk_bf16_f32 v59, v38, v39
    v_mfma_f32_32x32x16_bf16 a[0:15], a[140:143], v[52:55], a[0:15]
    buffer_load_dwordx4 a[172:175], v2, s[28:31], s70 offen offset:3072 sc1
    s_add_u32 s70, s70, 4096
    v_exp_f32 v40, v40
    v_exp_f32 v41, v41
    v_exp_f32 v42, v42
    v_exp_f32 v43, v43
    v_cvt_pk_bf16_f32 v60, v40, v41
    v_mfma_f32_32x32x16_bf16 v[64:79], a[136:139], v[56:59], 0
    v_exp_f32 v44, v44
    v_exp_f32 v45, v45
    v_cvt_pk_bf16_f32 v61, v42, v43
    v_exp_f32 v46, v46
    v_exp_f32 v47, v47
    v_cvt_pk_bf16_f32 v62, v44, v45
    v_cvt_pk_bf16_f32 v63, v46, v47
    v_mfma_f32_32x32x16_bf16 v[32:47], a[144:147], a[104:107], 0
    s_waitcnt vmcnt(4)
    v_mov_b32 v12, s60
    s_add_u32 s61, s68, 0x30000
    v_exp_f32 v16, v16
    v_exp_f32 v17, v17
    v_exp_f32 v18, v18
    v_exp_f32 v19, v19
    v_mfma_f32_32x32x16_bf16 v[32:47], a[148:151], a[108:111], v[32:47]
    buffer_store_dword v12, v3, s[28:31], s61 offen sc1
    v_cvt_pk_bf16_f32 v48, v16, v17
    v_exp_f32 v20, v20
    v_exp_f32 v21, v21
    v_cvt_pk_bf16_f32 v49, v18, v19
    v_exp_f32 v22, v22
    v_exp_f32 v23, v23
    v_cvt_pk_bf16_f32 v50, v20, v21
    v_mfma_f32_32x32x16_bf16 v[64:79], a[140:143], v[60:63], v[64:79]
    buffer_load_dwordx4 a[128:131], v2, s[28:31], s70 offen offset:0 sc1
    v_cvt_pk_bf16_f32 v51, v22, v23
    v_exp_f32 v24, v24
    v_exp_f32 v25, v25
    v_exp_f32 v26, v26
    v_exp_f32 v27, v27
    v_cvt_pk_bf16_f32 v52, v24, v25
    v_mfma_f32_32x32x16_bf16 a[32:47], a[152:155], v[48:51], a[32:47]
    v_exp_f32 v28, v28
    v_exp_f32 v29, v29
    v_cvt_pk_bf16_f32 v53, v26, v27
    v_exp_f32 v30, v30
    v_exp_f32 v31, v31
    v_cvt_pk_bf16_f32 v54, v28, v29
    v_cvt_pk_bf16_f32 v55, v30, v31
    v_mfma_f32_32x32x16_bf16 v[16:31], a[144:147], a[112:115], 0
    v_exp_f32 v32, v32
    v_exp_f32 v33, v33
    v_exp_f32 v34, v34
    v_exp_f32 v35, v35
    v_cvt_pk_bf16_f32 v56, v32, v33
    v_exp_f32 v36, v36
    v_mfma_f32_32x32x16_bf16 v[16:31], a[148:151], a[116:119], v[16:31]
    v_exp_f32 v37, v37
    v_cvt_pk_bf16_f32 v57, v34, v35
    v_exp_f32 v38, v38
    v_exp_f32 v39, v39
    v_cvt_pk_bf16_f32 v58, v36, v37
    v_cvt_pk_bf16_f32 v59, v38, v39
    v_mfma_f32_32x32x16_bf16 a[32:47], a[156:159], v[52:55], a[32:47]
    buffer_load_dwordx4 a[132:135], v2, s[28:31], s70 offen offset:1024 sc1
    v_exp_f32 v40, v40
    v_exp_f32 v41, v41
    v_exp_f32 v42, v42
    v_exp_f32 v43, v43
    v_cvt_pk_bf16_f32 v60, v40, v41
    v_mfma_f32_32x32x16_bf16 a[16:31], a[152:155], v[56:59], a[16:31]
    v_exp_f32 v44, v44
    v_exp_f32 v45, v45
    v_cvt_pk_bf16_f32 v61, v42, v43
    v_exp_f32 v46, v46
    v_exp_f32 v47, v47
    v_cvt_pk_bf16_f32 v62, v44, v45
    v_cvt_pk_bf16_f32 v63, v46, v47
    v_mfma_f32_32x32x16_bf16 v[32:47], a[144:147], a[120:123], 0
    v_exp_f32 v16, v16
    v_exp_f32 v17, v17
    v_exp_f32 v18, v18
    v_exp_f32 v19, v19
    v_cvt_pk_bf16_f32 v48, v16, v17
    v_exp_f32 v20, v20
    v_mfma_f32_32x32x16_bf16 v[32:47], a[148:151], a[124:127], v[32:47]
    v_exp_f32 v21, v21
    v_cvt_pk_bf16_f32 v49, v18, v19
    v_exp_f32 v22, v22
    v_exp_f32 v23, v23
    v_cvt_pk_bf16_f32 v50, v20, v21
    v_cvt_pk_bf16_f32 v51, v22, v23
    v_mfma_f32_32x32x16_bf16 a[16:31], a[156:159], v[60:63], a[16:31]
    buffer_load_dwordx4 a[136:139], v2, s[28:31], s70 offen offset:2048 sc1
    v_exp_f32 v24, v24
    v_exp_f32 v25, v25
    v_exp_f32 v26, v26
    v_exp_f32 v27, v27
    v_cvt_pk_bf16_f32 v52, v24, v25
    v_mfma_f32_32x32x16_bf16 a[0:15], a[152:155], v[48:51], a[0:15]
    v_exp_f32 v28, v28
    v_exp_f32 v29, v29
    v_cvt_pk_bf16_f32 v53, v26, v27
    v_exp_f32 v30, v30
    v_exp_f32 v31, v31
    v_cvt_pk_bf16_f32 v54, v28, v29
    v_cvt_pk_bf16_f32 v55, v30, v31
    s_waitcnt vmcnt(4)
    v_mfma_f32_32x32x16_bf16 v[16:31], a[160:163], a[96:99], 0
    v_exp_f32 v32, v32
    v_exp_f32 v33, v33
    v_exp_f32 v34, v34
    v_exp_f32 v35, v35
    v_cvt_pk_bf16_f32 v56, v32, v33
    v_mfma_f32_32x32x16_bf16 v[16:31], a[164:167], a[100:103], v[16:31]
    v_exp_f32 v36, v36
    v_exp_f32 v37, v37
    v_cvt_pk_bf16_f32 v57, v34, v35
    v_exp_f32 v38, v38
    v_exp_f32 v39, v39
    v_cvt_pk_bf16_f32 v58, v36, v37
    v_cvt_pk_bf16_f32 v59, v38, v39
    v_mfma_f32_32x32x16_bf16 a[0:15], a[156:159], v[52:55], a[0:15]
    buffer_load_dwordx4 a[140:143], v2, s[28:31], s70 offen offset:3072 sc1
    s_add_u32 s70, s70, 4096
    v_exp_f32 v40, v40
    v_exp_f32 v41, v41
    v_exp_f32 v42, v42
    v_exp_f32 v43, v43
    v_cvt_pk_bf16_f32 v60, v40, v41
    v_mfma_f32_32x32x16_bf16 v[64:79], a[152:155], v[56:59], v[64:79]
    v_exp_f32 v44, v44
    v_exp_f32 v45, v45
    v_cvt_pk_bf16_f32 v61, v42, v43
    v_exp_f32 v46, v46
    v_exp_f32 v47, v47
    v_cvt_pk_bf16_f32 v62, v44, v45
    v_cvt_pk_bf16_f32 v63, v46, v47
    v_mfma_f32_32x32x16_bf16 v[32:47], a[160:163], a[104:107], 0
    v_exp_f32 v16, v16
    v_exp_f32 v17, v17
    v_exp_f32 v18, v18
    v_exp_f32 v19, v19
    v_cvt_pk_bf16_f32 v48, v16, v17
    v_exp_f32 v20, v20
    v_mfma_f32_32x32x16_bf16 v[32:47], a[164:167], a[108:111], v[32:47]
    v_exp_f32 v21, v21
    v_cvt_pk_bf16_f32 v49, v18, v19
    v_exp_f32 v22, v22
    v_exp_f32 v23, v23
    v_cvt_pk_bf16_f32 v50, v20, v21
    v_cvt_pk_bf16_f32 v51, v22, v23
    v_mfma_f32_32x32x16_bf16 v[64:79], a[156:159], v[60:63], v[64:79]
    buffer_load_dwordx4 a[144:147], v2, s[28:31], s70 offen offset:0 sc1
    v_exp_f32 v24, v24
    v_exp_f32 v25, v25
    v_exp_f32 v26, v26
    v_exp_f32 v27, v27
    v_cvt_pk_bf16_f32 v52, v24, v25
    v_mfma_f32_32x32x16_bf16 a[32:47], a[168:171], v[48:51], a[32:47]
    v_exp_f32 v28, v28
    v_exp_f32 v29, v29
    v_cvt_pk_bf16_f32 v53, v26, v27
    v_exp_f32 v30, v30
    v_exp_f32 v31, v31
    v_cvt_pk_bf16_f32 v54, v28, v29
    v_cvt_pk_bf16_f32 v55, v30, v31
    v_mfma_f32_32x32x16_bf16 v[16:31], a[160:163], a[112:115], 0
    v_exp_f32 v32, v32
    v_exp_f32 v33, v33
    v_exp_f32 v34, v34
    v_exp_f32 v35, v35
    v_cvt_pk_bf16_f32 v56, v32, v33
    v_exp_f32 v36, v36
    v_mfma_f32_32x32x16_bf16 v[16:31], a[164:167], a[116:119], v[16:31]
    v_exp_f32 v37, v37
    v_cvt_pk_bf16_f32 v57, v34, v35
    v_exp_f32 v38, v38
    v_exp_f32 v39, v39
    v_cvt_pk_bf16_f32 v58, v36, v37
    v_cvt_pk_bf16_f32 v59, v38, v39
    v_mfma_f32_32x32x16_bf16 a[32:47], a[172:175], v[52:55], a[32:47]
    buffer_load_dwordx4 a[148:151], v2, s[28:31], s70 offen offset:1024 sc1
    v_exp_f32 v40, v40
    v_exp_f32 v41, v41
    v_exp_f32 v42, v42
    v_exp_f32 v43, v43
    v_cvt_pk_bf16_f32 v60, v40, v41
    v_mfma_f32_32x32x16_bf16 a[16:31], a[168:171], v[56:59], a[16:31]
    v_exp_f32 v44, v44
    v_exp_f32 v45, v45
    v_cvt_pk_bf16_f32 v61, v42, v43
    v_exp_f32 v46, v46
    v_exp_f32 v47, v47
    v_cvt_pk_bf16_f32 v62, v44, v45
    v_cvt_pk_bf16_f32 v63, v46, v47
    v_mfma_f32_32x32x16_bf16 v[32:47], a[160:163], a[120:123], 0
    v_exp_f32 v16, v16
    v_exp_f32 v17, v17
    v_exp_f32 v18, v18
    v_exp_f32 v19, v19
    v_cvt_pk_bf16_f32 v48, v16, v17
    v_exp_f32 v20, v20
    v_mfma_f32_32x32x16_bf16 v[32:47], a[164:167], a[124:127], v[32:47]
    v_exp_f32 v21, v21
    v_cvt_pk_bf16_f32 v49, v18, v19
    v_exp_f32 v22, v22
    v_exp_f32 v23, v23
    v_cvt_pk_bf16_f32 v50, v20, v21
    v_cvt_pk_bf16_f32 v51, v22, v23
    v_mfma_f32_32x32x16_bf16 a[16:31], a[172:175], v[60:63], a[16:31]
    buffer_load_dwordx4 a[152:155], v2, s[28:31], s70 offen offset:2048 sc1
    v_exp_f32 v24, v24
    v_exp_f32 v25, v25
    v_exp_f32 v26, v26
    v_exp_f32 v27, v27
    v_cvt_pk_bf16_f32 v52, v24, v25
    v_mfma_f32_32x32x16_bf16 a[0:15], a[168:171], v[48:51], a[0:15]
    v_exp_f32 v28, v28
    v_exp_f32 v29, v29
    v_cvt_pk_bf16_f32 v53, v26, v27
    v_exp_f32 v30, v30
    v_exp_f32 v31, v31
    v_cvt_pk_bf16_f32 v54, v28, v29
    v_cvt_pk_bf16_f32 v55, v30, v31
    s_waitcnt vmcnt(3)
    v_mfma_f32_32x32x16_bf16 v[16:31], a[128:131], a[96:99], 0
    v_exp_f32 v32, v32
    v_exp_f32 v33, v33
    v_exp_f32 v34, v34
    v_exp_f32 v35, v35
    v_cvt_pk_bf16_f32 v56, v32, v33
    v_mfma_f32_32x32x16_bf16 v[16:31], a[132:135], a[100:103], v[16:31]
    v_exp_f32 v36, v36
    v_exp_f32 v37, v37
    v_cvt_pk_bf16_f32 v57, v34, v35
    v_exp_f32 v38, v38
    v_exp_f32 v39, v39
    v_cvt_pk_bf16_f32 v58, v36, v37
    v_cvt_pk_bf16_f32 v59, v38, v39
    v_mfma_f32_32x32x16_bf16 a[0:15], a[172:175], v[52:55], a[0:15]
    buffer_load_dwordx4 a[156:159], v2, s[28:31], s70 offen offset:3072 sc1
    s_add_u32 s70, s70, 4096
    v_exp_f32 v40, v40
    v_exp_f32 v41, v41
    v_exp_f32 v42, v42
    v_exp_f32 v43, v43
    v_cvt_pk_bf16_f32 v60, v40, v41
    v_mfma_f32_32x32x16_bf16 v[64:79], a[168:171], v[56:59], v[64:79]
    v_exp_f32 v44, v44
    v_exp_f32 v45, v45
    v_cvt_pk_bf16_f32 v61, v42, v43
    v_exp_f32 v46, v46
    v_exp_f32 v47, v47
    v_cvt_pk_bf16_f32 v62, v44, v45
    v_cvt_pk_bf16_f32 v63, v46, v47
    v_mfma_f32_32x32x16_bf16 v[32:47], a[128:131], a[104:107], 0
    v_exp_f32 v16, v16
    v_exp_f32 v17, v17
    v_exp_f32 v18, v18
    v_exp_f32 v19, v19
    v_cvt_pk_bf16_f32 v48, v16, v17
    v_exp_f32 v20, v20
    v_mfma_f32_32x32x16_bf16 v[32:47], a[132:135], a[108:111], v[32:47]
    v_exp_f32 v21, v21
    v_cvt_pk_bf16_f32 v49, v18, v19
    v_exp_f32 v22, v22
    v_exp_f32 v23, v23
    v_cvt_pk_bf16_f32 v50, v20, v21
    v_cvt_pk_bf16_f32 v51, v22, v23
    v_mfma_f32_32x32x16_bf16 v[64:79], a[172:175], v[60:63], v[64:79]
    buffer_load_dwordx4 a[160:163], v2, s[28:31], s70 offen offset:0 sc1
    v_exp_f32 v24, v24
    v_exp_f32 v25, v25
    v_exp_f32 v26, v26
    v_exp_f32 v27, v27
    v_cvt_pk_bf16_f32 v52, v24, v25
    v_mfma_f32_32x32x16_bf16 a[32:47], a[136:139], v[48:51], a[32:47]
    v_exp_f32 v28, v28
    v_exp_f32 v29, v29
    v_cvt_pk_bf16_f32 v53, v26, v27
    v_exp_f32 v30, v30
    v_exp_f32 v31, v31
    v_cvt_pk_bf16_f32 v54, v28, v29
    v_cvt_pk_bf16_f32 v55, v30, v31
    v_mfma_f32_32x32x16_bf16 v[16:31], a[128:131], a[112:115], 0
    v_exp_f32 v32, v32
    v_exp_f32 v33, v33
    v_exp_f32 v34, v34
    v_exp_f32 v35, v35
    v_cvt_pk_bf16_f32 v56, v32, v33
    v_exp_f32 v36, v36
    v_mfma_f32_32x32x16_bf16 v[16:31], a[132:135], a[116:119], v[16:31]
    v_exp_f32 v37, v37
    v_cvt_pk_bf16_f32 v57, v34, v35
    v_exp_f32 v38, v38
    v_exp_f32 v39, v39
    v_cvt_pk_bf16_f32 v58, v36, v37
    v_cvt_pk_bf16_f32 v59, v38, v39
    v_mfma_f32_32x32x16_bf16 a[32:47], a[140:143], v[52:55], a[32:47]
    buffer_load_dwordx4 a[164:167], v2, s[28:31], s70 offen offset:1024 sc1
    v_exp_f32 v40, v40
    v_exp_f32 v41, v41
    v_exp_f32 v42, v42
    v_exp_f32 v43, v43
    v_cvt_pk_bf16_f32 v60, v40, v41
    v_mfma_f32_32x32x16_bf16 a[16:31], a[136:139], v[56:59], a[16:31]
    v_exp_f32 v44, v44
    v_exp_f32 v45, v45
    v_cvt_pk_bf16_f32 v61, v42, v43
    v_exp_f32 v46, v46
    v_exp_f32 v47, v47
    v_cvt_pk_bf16_f32 v62, v44, v45
    v_cvt_pk_bf16_f32 v63, v46, v47
    v_mfma_f32_32x32x16_bf16 v[32:47], a[128:131], a[120:123], 0
    v_exp_f32 v16, v16
    v_exp_f32 v17, v17
    v_exp_f32 v18, v18
    v_exp_f32 v19, v19
    v_cvt_pk_bf16_f32 v48, v16, v17
    v_exp_f32 v20, v20
    v_mfma_f32_32x32x16_bf16 v[32:47], a[132:135], a[124:127], v[32:47]
    v_exp_f32 v21, v21
    v_cvt_pk_bf16_f32 v49, v18, v19
    v_exp_f32 v22, v22
    v_exp_f32 v23, v23
    v_cvt_pk_bf16_f32 v50, v20, v21
    v_cvt_pk_bf16_f32 v51, v22, v23
    v_mfma_f32_32x32x16_bf16 a[16:31], a[140:143], v[60:63], a[16:31]
    buffer_load_dwordx4 a[168:171], v2, s[28:31], s70 offen offset:2048 sc1
    v_exp_f32 v24, v24
    v_exp_f32 v25, v25
    v_exp_f32 v26, v26
    v_exp_f32 v27, v27
    v_cvt_pk_bf16_f32 v52, v24, v25
    v_mfma_f32_32x32x16_bf16 a[0:15], a[136:139], v[48:51], a[0:15]
    v_exp_f32 v28, v28
    v_exp_f32 v29, v29
    v_cvt_pk_bf16_f32 v53, v26, v27
    v_exp_f32 v30, v30
    v_exp_f32 v31, v31
    v_cvt_pk_bf16_f32 v54, v28, v29
    v_cvt_pk_bf16_f32 v55, v30, v31
    s_waitcnt vmcnt(3)
    v_mfma_f32_32x32x16_bf16 v[16:31], a[144:147], a[96:99], 0
    v_exp_f32 v32, v32
    v_exp_f32 v33, v33
    v_exp_f32 v34, v34
    v_exp_f32 v35, v35
    v_cvt_pk_bf16_f32 v56, v32, v33
    v_mfma_f32_32x32x16_bf16 v[16:31], a[148:151], a[100:103], v[16:31]
    v_exp_f32 v36, v36
    v_exp_f32 v37, v37
    v_cvt_pk_bf16_f32 v57, v34, v35
    v_exp_f32 v38, v38
    v_exp_f32 v39, v39
    v_cvt_pk_bf16_f32 v58, v36, v37
    v_cvt_pk_bf16_f32 v59, v38, v39
    v_mfma_f32_32x32x16_bf16 a[0:15], a[140:143], v[52:55], a[0:15]
    buffer_load_dwordx4 a[172:175], v2, s[28:31], s70 offen offset:3072 sc1
    s_add_u32 s70, s70, 4096
    v_exp_f32 v40, v40
    v_exp_f32 v41, v41
    v_exp_f32 v42, v42
    v_exp_f32 v43, v43
    v_cvt_pk_bf16_f32 v60, v40, v41
    v_mfma_f32_32x32x16_bf16 v[64:79], a[136:139], v[56:59], v[64:79]
    v_exp_f32 v44, v44
    v_exp_f32 v45, v45
    v_cvt_pk_bf16_f32 v61, v42, v43
    v_exp_f32 v46, v46
    v_exp_f32 v47, v47
    v_cvt_pk_bf16_f32 v62, v44, v45
    v_cvt_pk_bf16_f32 v63, v46, v47
    v_mfma_f32_32x32x16_bf16 v[32:47], a[144:147], a[104:107], 0
    v_exp_f32 v16, v16
    v_exp_f32 v17, v17
    v_exp_f32 v18, v18
    v_exp_f32 v19, v19
    v_cvt_pk_bf16_f32 v48, v16, v17
    v_exp_f32 v20, v20
    v_mfma_f32_32x32x16_bf16 v[32:47], a[148:151], a[108:111], v[32:47]
    v_exp_f32 v21, v21
    v_cvt_pk_bf16_f32 v49, v18, v19
    v_exp_f32 v22, v22
    v_exp_f32 v23, v23
    v_cvt_pk_bf16_f32 v50, v20, v21
    v_cvt_pk_bf16_f32 v51, v22, v23
    v_mfma_f32_32x32x16_bf16 v[64:79], a[140:143], v[60:63], v[64:79]
    buffer_load_dwordx4 a[128:131], v2, s[28:31], s70 offen offset:0 sc1
    v_exp_f32 v24, v24
    v_exp_f32 v25, v25
    v_exp_f32 v26, v26
    v_exp_f32 v27, v27
    v_cvt_pk_bf16_f32 v52, v24, v25
    v_mfma_f32_32x32x16_bf16 a[32:47], a[152:155], v[48:51], a[32:47]
    v_exp_f32 v28, v28
    v_exp_f32 v29, v29
    v_cvt_pk_bf16_f32 v53, v26, v27
    v_exp_f32 v30, v30
    v_exp_f32 v31, v31
    v_cvt_pk_bf16_f32 v54, v28, v29
    v_cvt_pk_bf16_f32 v55, v30, v31
    v_mfma_f32_32x32x16_bf16 v[16:31], a[144:147], a[112:115], 0
    v_exp_f32 v32, v32
    v_exp_f32 v33, v33
    v_exp_f32 v34, v34
    v_exp_f32 v35, v35
    v_cvt_pk_bf16_f32 v56, v32, v33
    v_exp_f32 v36, v36
    v_mfma_f32_32x32x16_bf16 v[16:31], a[148:151], a[116:119], v[16:31]
    v_exp_f32 v37, v37
    v_cvt_pk_bf16_f32 v57, v34, v35
    v_exp_f32 v38, v38
    v_exp_f32 v39, v39
    v_cvt_pk_bf16_f32 v58, v36, v37
    v_cvt_pk_bf16_f32 v59, v38, v39
    v_mfma_f32_32x32x16_bf16 a[32:47], a[156:159], v[52:55], a[32:47]
    buffer_load_dwordx4 a[132:135], v2, s[28:31], s70 offen offset:1024 sc1
    v_exp_f32 v40, v40
    v_exp_f32 v41, v41
    v_exp_f32 v42, v42
    v_exp_f32 v43, v43
    v_cvt_pk_bf16_f32 v60, v40, v41
    v_mfma_f32_32x32x16_bf16 a[16:31], a[152:155], v[56:59], a[16:31]
    v_exp_f32 v44, v44
    v_exp_f32 v45, v45
    v_cvt_pk_bf16_f32 v61, v42, v43
    v_exp_f32 v46, v46
    v_exp_f32 v47, v47
    v_cvt_pk_bf16_f32 v62, v44, v45
    v_cvt_pk_bf16_f32 v63, v46, v47
    v_mfma_f32_32x32x16_bf16 v[32:47], a[144:147], a[120:123], 0
    v_exp_f32 v16, v16
    v_exp_f32 v17, v17
    v_exp_f32 v18, v18
    v_exp_f32 v19, v19
    v_cvt_pk_bf16_f32 v48, v16, v17
    v_exp_f32 v20, v20
    v_mfma_f32_32x32x16_bf16 v[32:47], a[148:151], a[124:127], v[32:47]
    v_exp_f32 v21, v21
    v_cvt_pk_bf16_f32 v49, v18, v19
    v_exp_f32 v22, v22
    v_exp_f32 v23, v23
    v_cvt_pk_bf16_f32 v50, v20, v21
    v_cvt_pk_bf16_f32 v51, v22, v23
    v_mfma_f32_32x32x16_bf16 a[16:31], a[156:159], v[60:63], a[16:31]
    buffer_load_dwordx4 a[136:139], v2, s[28:31], s70 offen offset:2048 sc1
    v_exp_f32 v24, v24
    v_exp_f32 v25, v25
    v_exp_f32 v26, v26
    v_exp_f32 v27, v27
    v_cvt_pk_bf16_f32 v52, v24, v25
    v_mfma_f32_32x32x16_bf16 a[0:15], a[152:155], v[48:51], a[0:15]
    v_exp_f32 v28, v28
    v_exp_f32 v29, v29
    v_cvt_pk_bf16_f32 v53, v26, v27
    v_exp_f32 v30, v30
    v_exp_f32 v31, v31
    v_cvt_pk_bf16_f32 v54, v28, v29
    v_cvt_pk_bf16_f32 v55, v30, v31
    s_waitcnt vmcnt(3)
    v_mfma_f32_32x32x16_bf16 v[16:31], a[160:163], a[96:99], 0
    v_exp_f32 v32, v32
    v_exp_f32 v33, v33
    v_exp_f32 v34, v34
    v_exp_f32 v35, v35
    v_cvt_pk_bf16_f32 v56, v32, v33
    v_mfma_f32_32x32x16_bf16 v[16:31], a[164:167], a[100:103], v[16:31]
    v_exp_f32 v36, v36
    v_exp_f32 v37, v37
    v_cvt_pk_bf16_f32 v57, v34, v35
    v_exp_f32 v38, v38
    v_exp_f32 v39, v39
    v_cvt_pk_bf16_f32 v58, v36, v37
    v_cvt_pk_bf16_f32 v59, v38, v39
    v_mfma_f32_32x32x16_bf16 a[0:15], a[156:159], v[52:55], a[0:15]
    buffer_load_dwordx4 a[140:143], v2, s[28:31], s70 offen offset:3072 sc1
    s_add_u32 s70, s70, 4096
    v_exp_f32 v40, v40
    v_exp_f32 v41, v41
    v_exp_f32 v42, v42
    v_exp_f32 v43, v43
    v_cvt_pk_bf16_f32 v60, v40, v41
    v_mfma_f32_32x32x16_bf16 v[64:79], a[152:155], v[56:59], v[64:79]
    v_exp_f32 v44, v44
    v_exp_f32 v45, v45
    v_cvt_pk_bf16_f32 v61, v42, v43
    v_exp_f32 v46, v46
    v_exp_f32 v47, v47
    v_cvt_pk_bf16_f32 v62, v44, v45
    v_cvt_pk_bf16_f32 v63, v46, v47
    v_mfma_f32_32x32x16_bf16 v[32:47], a[160:163], a[104:107], 0
    v_exp_f32 v16, v16
    v_exp_f32 v17, v17
    v_exp_f32 v18, v18
    v_exp_f32 v19, v19
    v_cvt_pk_bf16_f32 v48, v16, v17
    v_exp_f32 v20, v20
    v_mfma_f32_32x32x16_bf16 v[32:47], a[164:167], a[108:111], v[32:47]
    v_exp_f32 v21, v21
    v_cvt_pk_bf16_f32 v49, v18, v19
    v_exp_f32 v22, v22
    v_exp_f32 v23, v23
    v_cvt_pk_bf16_f32 v50, v20, v21
    v_cvt_pk_bf16_f32 v51, v22, v23
    v_mfma_f32_32x32x16_bf16 v[64:79], a[156:159], v[60:63], v[64:79]
    buffer_load_dwordx4 a[144:147], v2, s[28:31], s70 offen offset:0 sc1
    v_exp_f32 v24, v24
    v_exp_f32 v25, v25
    v_exp_f32 v26, v26
    v_exp_f32 v27, v27
    v_cvt_pk_bf16_f32 v52, v24, v25
    v_mfma_f32_32x32x16_bf16 a[32:47], a[168:171], v[48:51], a[32:47]
    v_exp_f32 v28, v28
    v_exp_f32 v29, v29
    v_cvt_pk_bf16_f32 v53, v26, v27
    v_exp_f32 v30, v30
    v_exp_f32 v31, v31
    v_cvt_pk_bf16_f32 v54, v28, v29
    v_cvt_pk_bf16_f32 v55, v30, v31
    v_mfma_f32_32x32x16_bf16 v[16:31], a[160:163], a[112:115], 0
    v_exp_f32 v32, v32
    v_exp_f32 v33, v33
    v_exp_f32 v34, v34
    v_exp_f32 v35, v35
    v_cvt_pk_bf16_f32 v56, v32, v33
    v_exp_f32 v36, v36
    v_mfma_f32_32x32x16_bf16 v[16:31], a[164:167], a[116:119], v[16:31]
    v_exp_f32 v37, v37
    v_cvt_pk_bf16_f32 v57, v34, v35
    v_exp_f32 v38, v38
    v_exp_f32 v39, v39
    v_cvt_pk_bf16_f32 v58, v36, v37
    v_cvt_pk_bf16_f32 v59, v38, v39
    v_mfma_f32_32x32x16_bf16 a[32:47], a[172:175], v[52:55], a[32:47]
    buffer_load_dwordx4 a[148:151], v2, s[28:31], s70 offen offset:1024 sc1
    v_exp_f32 v40, v40
    v_exp_f32 v41, v41
    v_exp_f32 v42, v42
    v_exp_f32 v43, v43
    v_cvt_pk_bf16_f32 v60, v40, v41
    v_mfma_f32_32x32x16_bf16 a[16:31], a[168:171], v[56:59], a[16:31]
    v_exp_f32 v44, v44
    v_exp_f32 v45, v45
    v_cvt_pk_bf16_f32 v61, v42, v43
    v_exp_f32 v46, v46
    v_exp_f32 v47, v47
    v_cvt_pk_bf16_f32 v62, v44, v45
    v_cvt_pk_bf16_f32 v63, v46, v47
    v_mfma_f32_32x32x16_bf16 v[32:47], a[160:163], a[120:123], 0
    v_exp_f32 v16, v16
    v_exp_f32 v17, v17
    v_exp_f32 v18, v18
    v_exp_f32 v19, v19
    v_cvt_pk_bf16_f32 v48, v16, v17
    v_exp_f32 v20, v20
    v_mfma_f32_32x32x16_bf16 v[32:47], a[164:167], a[124:127], v[32:47]
    v_exp_f32 v21, v21
    v_cvt_pk_bf16_f32 v49, v18, v19
    v_exp_f32 v22, v22
    v_exp_f32 v23, v23
    v_cvt_pk_bf16_f32 v50, v20, v21
    v_cvt_pk_bf16_f32 v51, v22, v23
    v_mfma_f32_32x32x16_bf16 a[16:31], a[172:175], v[60:63], a[16:31]
    buffer_load_dwordx4 a[152:155], v2, s[28:31], s70 offen offset:2048 sc1
    v_exp_f32 v24, v24
    v_exp_f32 v25, v25
    v_exp_f32 v26, v26
    v_exp_f32 v27, v27
    v_cvt_pk_bf16_f32 v52, v24, v25
    v_mfma_f32_32x32x16_bf16 a[0:15], a[168:171], v[48:51], a[0:15]
    v_exp_f32 v28, v28
    v_exp_f32 v29, v29
    v_cvt_pk_bf16_f32 v53, v26, v27
    v_exp_f32 v30, v30
    v_exp_f32 v31, v31
    v_cvt_pk_bf16_f32 v54, v28, v29
    v_cvt_pk_bf16_f32 v55, v30, v31
    s_waitcnt vmcnt(3)
    v_mfma_f32_32x32x16_bf16 v[16:31], a[128:131], a[96:99], 0
    v_exp_f32 v32, v32
    v_exp_f32 v33, v33
    v_exp_f32 v34, v34
    v_exp_f32 v35, v35
    v_cvt_pk_bf16_f32 v56, v32, v33
    v_mfma_f32_32x32x16_bf16 v[16:31], a[132:135], a[100:103], v[16:31]
    v_exp_f32 v36, v36
    v_exp_f32 v37, v37
    v_cvt_pk_bf16_f32 v57, v34, v35
    v_exp_f32 v38, v38
    v_exp_f32 v39, v39
    v_cvt_pk_bf16_f32 v58, v36, v37
    v_cvt_pk_bf16_f32 v59, v38, v39
    v_mfma_f32_32x32x16_bf16 a[0:15], a[172:175], v[52:55], a[0:15]
    buffer_load_dwordx4 a[156:159], v2, s[28:31], s70 offen offset:3072 sc1
    s_add_u32 s70, s70, 4096
    v_exp_f32 v40, v40
    v_exp_f32 v41, v41
    v_exp_f32 v42, v42
    v_exp_f32 v43, v43
    v_cvt_pk_bf16_f32 v60, v40, v41
    v_mfma_f32_32x32x16_bf16 v[64:79], a[168:171], v[56:59], v[64:79]
    v_exp_f32 v44, v44
    v_exp_f32 v45, v45
    v_cvt_pk_bf16_f32 v61, v42, v43
    v_exp_f32 v46, v46
    v_exp_f32 v47, v47
    v_cvt_pk_bf16_f32 v62, v44, v45
    v_cvt_pk_bf16_f32 v63, v46, v47
    v_mfma_f32_32x32x16_bf16 v[32:47], a[128:131], a[104:107], 0
    v_exp_f32 v16, v16
    v_exp_f32 v17, v17
    v_exp_f32 v18, v18
    v_exp_f32 v19, v19
    v_cvt_pk_bf16_f32 v48, v16, v17
    v_exp_f32 v20, v20
    v_mfma_f32_32x32x16_bf16 v[32:47], a[132:135], a[108:111], v[32:47]
    v_exp_f32 v21, v21
    v_cvt_pk_bf16_f32 v49, v18, v19
    v_exp_f32 v22, v22
    v_exp_f32 v23, v23
    v_cvt_pk_bf16_f32 v50, v20, v21
    v_cvt_pk_bf16_f32 v51, v22, v23
    v_mfma_f32_32x32x16_bf16 v[64:79], a[172:175], v[60:63], v[64:79]
    buffer_load_dwordx4 a[160:163], v2, s[28:31], s70 offen offset:0 sc1
    v_exp_f32 v24, v24
    v_exp_f32 v25, v25
    v_exp_f32 v26, v26
    v_exp_f32 v27, v27
    v_cvt_pk_bf16_f32 v52, v24, v25
    v_mfma_f32_32x32x16_bf16 a[32:47], a[136:139], v[48:51], a[32:47]
    v_exp_f32 v28, v28
    v_exp_f32 v29, v29
    v_cvt_pk_bf16_f32 v53, v26, v27
    v_exp_f32 v30, v30
    v_exp_f32 v31, v31
    v_cvt_pk_bf16_f32 v54, v28, v29
    v_cvt_pk_bf16_f32 v55, v30, v31
    v_mfma_f32_32x32x16_bf16 v[16:31], a[128:131], a[112:115], 0
    v_exp_f32 v32, v32
    v_exp_f32 v33, v33
    v_exp_f32 v34, v34
    v_exp_f32 v35, v35
    v_cvt_pk_bf16_f32 v56, v32, v33
    v_exp_f32 v36, v36
    v_mfma_f32_32x32x16_bf16 v[16:31], a[132:135], a[116:119], v[16:31]
    v_exp_f32 v37, v37
    v_cvt_pk_bf16_f32 v57, v34, v35
    v_exp_f32 v38, v38
    v_exp_f32 v39, v39
    v_cvt_pk_bf16_f32 v58, v36, v37
    v_cvt_pk_bf16_f32 v59, v38, v39
    v_mfma_f32_32x32x16_bf16 a[32:47], a[140:143], v[52:55], a[32:47]
    buffer_load_dwordx4 a[164:167], v2, s[28:31], s70 offen offset:1024 sc1
    v_exp_f32 v40, v40
    v_exp_f32 v41, v41
    v_exp_f32 v42, v42
    v_exp_f32 v43, v43
    v_cvt_pk_bf16_f32 v60, v40, v41
    v_mfma_f32_32x32x16_bf16 a[16:31], a[136:139], v[56:59], a[16:31]
    v_exp_f32 v44, v44
    v_exp_f32 v45, v45
    v_cvt_pk_bf16_f32 v61, v42, v43
    v_exp_f32 v46, v46
    v_exp_f32 v47, v47
    v_cvt_pk_bf16_f32 v62, v44, v45
    v_cvt_pk_bf16_f32 v63, v46, v47
    v_mfma_f32_32x32x16_bf16 v[32:47], a[128:131], a[120:123], 0
    v_exp_f32 v16, v16
    v_exp_f32 v17, v17
    v_exp_f32 v18, v18
    v_exp_f32 v19, v19
    v_cvt_pk_bf16_f32 v48, v16, v17
    v_exp_f32 v20, v20
    v_mfma_f32_32x32x16_bf16 v[32:47], a[132:135], a[124:127], v[32:47]
    v_exp_f32 v21, v21
    v_cvt_pk_bf16_f32 v49, v18, v19
    v_exp_f32 v22, v22
    v_exp_f32 v23, v23
    v_cvt_pk_bf16_f32 v50, v20, v21
    v_cvt_pk_bf16_f32 v51, v22, v23
    v_mfma_f32_32x32x16_bf16 a[16:31], a[140:143], v[60:63], a[16:31]
    buffer_load_dwordx4 a[168:171], v2, s[28:31], s70 offen offset:2048 sc1
    v_exp_f32 v24, v24
    v_exp_f32 v25, v25
    v_exp_f32 v26, v26
    v_exp_f32 v27, v27
    v_cvt_pk_bf16_f32 v52, v24, v25
    v_mfma_f32_32x32x16_bf16 a[0:15], a[136:139], v[48:51], a[0:15]
    v_exp_f32 v28, v28
    v_exp_f32 v29, v29
    v_cvt_pk_bf16_f32 v53, v26, v27
    v_exp_f32 v30, v30
    v_exp_f32 v31, v31
    v_cvt_pk_bf16_f32 v54, v28, v29
    v_cvt_pk_bf16_f32 v55, v30, v31
    s_waitcnt vmcnt(3)
    v_mfma_f32_32x32x16_bf16 v[16:31], a[144:147], a[96:99], 0
    v_exp_f32 v32, v32
    v_exp_f32 v33, v33
    v_exp_f32 v34, v34
    v_exp_f32 v35, v35
    v_cvt_pk_bf16_f32 v56, v32, v33
    v_mfma_f32_32x32x16_bf16 v[16:31], a[148:151], a[100:103], v[16:31]
    v_exp_f32 v36, v36
    v_exp_f32 v37, v37
    v_cvt_pk_bf16_f32 v57, v34, v35
    v_exp_f32 v38, v38
    v_exp_f32 v39, v39
    v_cvt_pk_bf16_f32 v58, v36, v37
    v_cvt_pk_bf16_f32 v59, v38, v39
    v_mfma_f32_32x32x16_bf16 a[0:15], a[140:143], v[52:55], a[0:15]
    buffer_load_dwordx4 a[172:175], v2, s[28:31], s70 offen offset:3072 sc1
    s_add_u32 s70, s70, 4096
    v_exp_f32 v40, v40
    v_exp_f32 v41, v41
    v_exp_f32 v42, v42
    v_exp_f32 v43, v43
    v_cvt_pk_bf16_f32 v60, v40, v41
    v_mfma_f32_32x32x16_bf16 v[64:79], a[136:139], v[56:59], v[64:79]
    v_exp_f32 v44, v44
    v_exp_f32 v45, v45
    v_cvt_pk_bf16_f32 v61, v42, v43
    v_exp_f32 v46, v46
    v_exp_f32 v47, v47
    v_cvt_pk_bf16_f32 v62, v44, v45
    v_cvt_pk_bf16_f32 v63, v46, v47
    v_mfma_f32_32x32x16_bf16 v[32:47], a[144:147], a[104:107], 0
    v_exp_f32 v16, v16
    v_exp_f32 v17, v17
    v_exp_f32 v18, v18
    v_exp_f32 v19, v19
    v_cvt_pk_bf16_f32 v48, v16, v17
    v_exp_f32 v20, v20
    v_mfma_f32_32x32x16_bf16 v[32:47], a[148:151], a[108:111], v[32:47]
    v_exp_f32 v21, v21
    v_cvt_pk_bf16_f32 v49, v18, v19
    v_exp_f32 v22, v22
    v_exp_f32 v23, v23
    v_cvt_pk_bf16_f32 v50, v20, v21
    v_cvt_pk_bf16_f32 v51, v22, v23
    v_mfma_f32_32x32x16_bf16 v[64:79], a[140:143], v[60:63], v[64:79]
    buffer_load_dwordx4 a[128:131], v2, s[28:31], s70 offen offset:0 sc1
    v_exp_f32 v24, v24
    v_exp_f32 v25, v25
    v_exp_f32 v26, v26
    v_exp_f32 v27, v27
    v_cvt_pk_bf16_f32 v52, v24, v25
    v_mfma_f32_32x32x16_bf16 a[32:47], a[152:155], v[48:51], a[32:47]
    v_exp_f32 v28, v28
    v_exp_f32 v29, v29
    v_cvt_pk_bf16_f32 v53, v26, v27
    v_exp_f32 v30, v30
    v_exp_f32 v31, v31
    v_cvt_pk_bf16_f32 v54, v28, v29
    v_cvt_pk_bf16_f32 v55, v30, v31
    v_mfma_f32_32x32x16_bf16 v[16:31], a[144:147], a[112:115], 0
    v_exp_f32 v32, v32
    v_exp_f32 v33, v33
    v_exp_f32 v34, v34
    v_exp_f32 v35, v35
    v_cvt_pk_bf16_f32 v56, v32, v33
    v_exp_f32 v36, v36
    v_mfma_f32_32x32x16_bf16 v[16:31], a[148:151], a[116:119], v[16:31]
    v_exp_f32 v37, v37
    v_cvt_pk_bf16_f32 v57, v34, v35
    v_exp_f32 v38, v38
    v_exp_f32 v39, v39
    v_cvt_pk_bf16_f32 v58, v36, v37
    v_cvt_pk_bf16_f32 v59, v38, v39
    v_mfma_f32_32x32x16_bf16 a[32:47], a[156:159], v[52:55], a[32:47]
    buffer_load_dwordx4 a[132:135], v2, s[28:31], s70 offen offset:1024 sc1
    v_exp_f32 v40, v40
    v_exp_f32 v41, v41
    v_exp_f32 v42, v42
    v_exp_f32 v43, v43
    v_cvt_pk_bf16_f32 v60, v40, v41
    v_mfma_f32_32x32x16_bf16 a[16:31], a[152:155], v[56:59], a[16:31]
    v_exp_f32 v44, v44
    v_exp_f32 v45, v45
    v_cvt_pk_bf16_f32 v61, v42, v43
    v_exp_f32 v46, v46
    v_exp_f32 v47, v47
    v_cvt_pk_bf16_f32 v62, v44, v45
    v_cvt_pk_bf16_f32 v63, v46, v47
    v_mfma_f32_32x32x16_bf16 v[32:47], a[144:147], a[120:123], 0
    v_exp_f32 v16, v16
    v_exp_f32 v17, v17
    v_exp_f32 v18, v18
    v_exp_f32 v19, v19
    v_cvt_pk_bf16_f32 v48, v16, v17
    v_exp_f32 v20, v20
    v_mfma_f32_32x32x16_bf16 v[32:47], a[148:151], a[124:127], v[32:47]
    v_exp_f32 v21, v21
    v_cvt_pk_bf16_f32 v49, v18, v19
    v_exp_f32 v22, v22
    v_exp_f32 v23, v23
    v_cvt_pk_bf16_f32 v50, v20, v21
    v_cvt_pk_bf16_f32 v51, v22, v23
    v_mfma_f32_32x32x16_bf16 a[16:31], a[156:159], v[60:63], a[16:31]
    buffer_load_dwordx4 a[136:139], v2, s[28:31], s70 offen offset:2048 sc1
    v_exp_f32 v24, v24
    v_exp_f32 v25, v25
    v_exp_f32 v26, v26
    v_exp_f32 v27, v27
    v_cvt_pk_bf16_f32 v52, v24, v25
    v_mfma_f32_32x32x16_bf16 a[0:15], a[152:155], v[48:51], a[0:15]
    v_exp_f32 v28, v28
    v_exp_f32 v29, v29
    v_cvt_pk_bf16_f32 v53, v26, v27
    v_exp_f32 v30, v30
    v_exp_f32 v31, v31
    v_cvt_pk_bf16_f32 v54, v28, v29
    v_cvt_pk_bf16_f32 v55, v30, v31
    s_waitcnt vmcnt(3)
    v_mfma_f32_32x32x16_bf16 v[16:31], a[160:163], a[96:99], 0
    v_exp_f32 v32, v32
    v_exp_f32 v33, v33
    v_exp_f32 v34, v34
    v_exp_f32 v35, v35
    v_cvt_pk_bf16_f32 v56, v32, v33
    v_mfma_f32_32x32x16_bf16 v[16:31], a[164:167], a[100:103], v[16:31]
    v_exp_f32 v36, v36
    v_exp_f32 v37, v37
    v_cvt_pk_bf16_f32 v57, v34, v35
    v_exp_f32 v38, v38
    v_exp_f32 v39, v39
    v_cvt_pk_bf16_f32 v58, v36, v37
    v_cvt_pk_bf16_f32 v59, v38, v39
    v_mfma_f32_32x32x16_bf16 a[0:15], a[156:159], v[52:55], a[0:15]
    buffer_load_dwordx4 a[140:143], v2, s[28:31], s70 offen offset:3072 sc1
    s_add_u32 s70, s70, 4096
    v_exp_f32 v40, v40
    v_exp_f32 v41, v41
    v_exp_f32 v42, v42
    v_exp_f32 v43, v43
    v_cvt_pk_bf16_f32 v60, v40, v41
    v_mfma_f32_32x32x16_bf16 v[64:79], a[152:155], v[56:59], v[64:79]
    v_exp_f32 v44, v44
    v_exp_f32 v45, v45
    v_cvt_pk_bf16_f32 v61, v42, v43
    v_exp_f32 v46, v46
    v_exp_f32 v47, v47
    v_cvt_pk_bf16_f32 v62, v44, v45
    v_cvt_pk_bf16_f32 v63, v46, v47
    v_mfma_f32_32x32x16_bf16 v[32:47], a[160:163], a[104:107], 0
    v_exp_f32 v16, v16
    v_exp_f32 v17, v17
    v_exp_f32 v18, v18
    v_exp_f32 v19, v19
    v_cvt_pk_bf16_f32 v48, v16, v17
    v_exp_f32 v20, v20
    v_mfma_f32_32x32x16_bf16 v[32:47], a[164:167], a[108:111], v[32:47]
    v_exp_f32 v21, v21
    v_cvt_pk_bf16_f32 v49, v18, v19
    v_exp_f32 v22, v22
    v_exp_f32 v23, v23
    v_cvt_pk_bf16_f32 v50, v20, v21
    v_cvt_pk_bf16_f32 v51, v22, v23
    v_mfma_f32_32x32x16_bf16 v[64:79], a[156:159], v[60:63], v[64:79]
    buffer_load_dwordx4 a[144:147], v2, s[28:31], s70 offen offset:0 sc1
    v_exp_f32 v24, v24
    v_exp_f32 v25, v25
    v_exp_f32 v26, v26
    v_exp_f32 v27, v27
    v_cvt_pk_bf16_f32 v52, v24, v25
    v_mfma_f32_32x32x16_bf16 a[32:47], a[168:171], v[48:51], a[32:47]
    v_exp_f32 v28, v28
    v_exp_f32 v29, v29
    v_cvt_pk_bf16_f32 v53, v26, v27
    v_exp_f32 v30, v30
    v_exp_f32 v31, v31
    v_cvt_pk_bf16_f32 v54, v28, v29
    v_cvt_pk_bf16_f32 v55, v30, v31
    v_mfma_f32_32x32x16_bf16 v[16:31], a[160:163], a[112:115], 0
    v_exp_f32 v32, v32
    v_exp_f32 v33, v33
    v_exp_f32 v34, v34
    v_exp_f32 v35, v35
    v_cvt_pk_bf16_f32 v56, v32, v33
    v_exp_f32 v36, v36
    v_mfma_f32_32x32x16_bf16 v[16:31], a[164:167], a[116:119], v[16:31]
    v_exp_f32 v37, v37
    v_cvt_pk_bf16_f32 v57, v34, v35
    v_exp_f32 v38, v38
    v_exp_f32 v39, v39
    v_cvt_pk_bf16_f32 v58, v36, v37
    v_cvt_pk_bf16_f32 v59, v38, v39
    v_mfma_f32_32x32x16_bf16 a[32:47], a[172:175], v[52:55], a[32:47]
    buffer_load_dwordx4 a[148:151], v2, s[28:31], s70 offen offset:1024 sc1
    v_exp_f32 v40, v40
    v_exp_f32 v41, v41
    v_exp_f32 v42, v42
    v_exp_f32 v43, v43
    v_cvt_pk_bf16_f32 v60, v40, v41
    v_mfma_f32_32x32x16_bf16 a[16:31], a[168:171], v[56:59], a[16:31]
    v_exp_f32 v44, v44
    v_exp_f32 v45, v45
    v_cvt_pk_bf16_f32 v61, v42, v43
    v_exp_f32 v46, v46
    v_exp_f32 v47, v47
    v_cvt_pk_bf16_f32 v62, v44, v45
    v_cvt_pk_bf16_f32 v63, v46, v47
    v_mfma_f32_32x32x16_bf16 v[32:47], a[160:163], a[120:123], 0
    v_exp_f32 v16, v16
    v_exp_f32 v17, v17
    v_exp_f32 v18, v18
    v_exp_f32 v19, v19
    v_cvt_pk_bf16_f32 v48, v16, v17
    v_exp_f32 v20, v20
    v_mfma_f32_32x32x16_bf16 v[32:47], a[164:167], a[124:127], v[32:47]
    v_exp_f32 v21, v21
    v_cvt_pk_bf16_f32 v49, v18, v19
    v_exp_f32 v22, v22
    v_exp_f32 v23, v23
    v_cvt_pk_bf16_f32 v50, v20, v21
    v_cvt_pk_bf16_f32 v51, v22, v23
    v_mfma_f32_32x32x16_bf16 a[16:31], a[172:175], v[60:63], a[16:31]
    buffer_load_dwordx4 a[152:155], v2, s[28:31], s70 offen offset:2048 sc1
    v_exp_f32 v24, v24
    v_exp_f32 v25, v25
    v_exp_f32 v26, v26
    v_exp_f32 v27, v27
    v_cvt_pk_bf16_f32 v52, v24, v25
    v_mfma_f32_32x32x16_bf16 a[0:15], a[168:171], v[48:51], a[0:15]
    v_exp_f32 v28, v28
    v_exp_f32 v29, v29
    v_cvt_pk_bf16_f32 v53, v26, v27
    v_exp_f32 v30, v30
    v_exp_f32 v31, v31
    v_cvt_pk_bf16_f32 v54, v28, v29
    v_cvt_pk_bf16_f32 v55, v30, v31
    s_waitcnt vmcnt(3)
    v_mfma_f32_32x32x16_bf16 v[16:31], a[128:131], a[96:99], 0
    v_exp_f32 v32, v32
    v_exp_f32 v33, v33
    v_exp_f32 v34, v34
    v_exp_f32 v35, v35
    v_cvt_pk_bf16_f32 v56, v32, v33
    v_mfma_f32_32x32x16_bf16 v[16:31], a[132:135], a[100:103], v[16:31]
    v_exp_f32 v36, v36
    v_exp_f32 v37, v37
    v_cvt_pk_bf16_f32 v57, v34, v35
    v_exp_f32 v38, v38
    v_exp_f32 v39, v39
    v_cvt_pk_bf16_f32 v58, v36, v37
    v_cvt_pk_bf16_f32 v59, v38, v39
    v_mfma_f32_32x32x16_bf16 a[0:15], a[172:175], v[52:55], a[0:15]
    buffer_load_dwordx4 a[156:159], v2, s[28:31], s70 offen offset:3072 sc1
    s_add_u32 s70, s70, 4096
    v_exp_f32 v40, v40
    v_exp_f32 v41, v41
    v_exp_f32 v42, v42
    v_exp_f32 v43, v43
    v_cvt_pk_bf16_f32 v60, v40, v41
    v_mfma_f32_32x32x16_bf16 v[64:79], a[168:171], v[56:59], v[64:79]
    v_exp_f32 v44, v44
    v_exp_f32 v45, v45
    v_cvt_pk_bf16_f32 v61, v42, v43
    v_exp_f32 v46, v46
    v_exp_f32 v47, v47
    v_cvt_pk_bf16_f32 v62, v44, v45
    v_cvt_pk_bf16_f32 v63, v46, v47
    v_mfma_f32_32x32x16_bf16 v[32:47], a[128:131], a[104:107], 0
    v_exp_f32 v16, v16
    v_exp_f32 v17, v17
    v_exp_f32 v18, v18
    v_exp_f32 v19, v19
    v_cvt_pk_bf16_f32 v48, v16, v17
    v_exp_f32 v20, v20
    v_mfma_f32_32x32x16_bf16 v[32:47], a[132:135], a[108:111], v[32:47]
    v_exp_f32 v21, v21
    v_cvt_pk_bf16_f32 v49, v18, v19
    v_exp_f32 v22, v22
    v_exp_f32 v23, v23
    v_cvt_pk_bf16_f32 v50, v20, v21
    v_cvt_pk_bf16_f32 v51, v22, v23
    v_mfma_f32_32x32x16_bf16 v[64:79], a[172:175], v[60:63], v[64:79]
    buffer_load_dwordx4 a[160:163], v2, s[28:31], s70 offen offset:0 sc1
    v_exp_f32 v24, v24
    v_exp_f32 v25, v25
    v_exp_f32 v26, v26
    v_exp_f32 v27, v27
    v_cvt_pk_bf16_f32 v52, v24, v25
    v_mfma_f32_32x32x16_bf16 a[32:47], a[136:139], v[48:51], a[32:47]
    v_exp_f32 v28, v28
    v_exp_f32 v29, v29
    v_cvt_pk_bf16_f32 v53, v26, v27
    v_exp_f32 v30, v30
    v_exp_f32 v31, v31
    v_cvt_pk_bf16_f32 v54, v28, v29
    v_cvt_pk_bf16_f32 v55, v30, v31
    v_mfma_f32_32x32x16_bf16 v[16:31], a[128:131], a[112:115], 0
    v_exp_f32 v32, v32
    v_exp_f32 v33, v33
    v_exp_f32 v34, v34
    v_exp_f32 v35, v35
    v_cvt_pk_bf16_f32 v56, v32, v33
    v_exp_f32 v36, v36
    v_mfma_f32_32x32x16_bf16 v[16:31], a[132:135], a[116:119], v[16:31]
    v_exp_f32 v37, v37
    v_cvt_pk_bf16_f32 v57, v34, v35
    v_exp_f32 v38, v38
    v_exp_f32 v39, v39
    v_cvt_pk_bf16_f32 v58, v36, v37
    v_cvt_pk_bf16_f32 v59, v38, v39
    v_mfma_f32_32x32x16_bf16 a[32:47], a[140:143], v[52:55], a[32:47]
    buffer_load_dwordx4 a[164:167], v2, s[28:31], s70 offen offset:1024 sc1
    v_exp_f32 v40, v40
    v_exp_f32 v41, v41
    v_exp_f32 v42, v42
    v_exp_f32 v43, v43
    v_cvt_pk_bf16_f32 v60, v40, v41
    v_mfma_f32_32x32x16_bf16 a[16:31], a[136:139], v[56:59], a[16:31]
    v_exp_f32 v44, v44
    v_exp_f32 v45, v45
    v_cvt_pk_bf16_f32 v61, v42, v43
    v_exp_f32 v46, v46
    v_exp_f32 v47, v47
    v_cvt_pk_bf16_f32 v62, v44, v45
    v_cvt_pk_bf16_f32 v63, v46, v47
    v_mfma_f32_32x32x16_bf16 v[32:47], a[128:131], a[120:123], 0
    v_exp_f32 v16, v16
    v_exp_f32 v17, v17
    v_exp_f32 v18, v18
    v_exp_f32 v19, v19
    v_cvt_pk_bf16_f32 v48, v16, v17
    v_exp_f32 v20, v20
    v_mfma_f32_32x32x16_bf16 v[32:47], a[132:135], a[124:127], v[32:47]
    v_exp_f32 v21, v21
    v_cvt_pk_bf16_f32 v49, v18, v19
    v_exp_f32 v22, v22
    v_exp_f32 v23, v23
    v_cvt_pk_bf16_f32 v50, v20, v21
    v_cvt_pk_bf16_f32 v51, v22, v23
    v_mfma_f32_32x32x16_bf16 a[16:31], a[140:143], v[60:63], a[16:31]
    buffer_load_dwordx4 a[168:171], v2, s[28:31], s70 offen offset:2048 sc1
    v_exp_f32 v24, v24
    v_exp_f32 v25, v25
    v_exp_f32 v26, v26
    v_exp_f32 v27, v27
    v_cvt_pk_bf16_f32 v52, v24, v25
    v_mfma_f32_32x32x16_bf16 a[0:15], a[136:139], v[48:51], a[0:15]
    v_exp_f32 v28, v28
    v_exp_f32 v29, v29
    v_cvt_pk_bf16_f32 v53, v26, v27
    v_exp_f32 v30, v30
    v_exp_f32 v31, v31
    v_cvt_pk_bf16_f32 v54, v28, v29
    v_cvt_pk_bf16_f32 v55, v30, v31
    s_waitcnt vmcnt(3)
    v_mfma_f32_32x32x16_bf16 v[16:31], a[144:147], a[96:99], 0
    v_exp_f32 v32, v32
    v_exp_f32 v33, v33
    v_exp_f32 v34, v34
    v_exp_f32 v35, v35
    v_cvt_pk_bf16_f32 v56, v32, v33
    v_mfma_f32_32x32x16_bf16 v[16:31], a[148:151], a[100:103], v[16:31]
    v_exp_f32 v36, v36
    v_exp_f32 v37, v37
    v_cvt_pk_bf16_f32 v57, v34, v35
    v_exp_f32 v38, v38
    v_exp_f32 v39, v39
    v_cvt_pk_bf16_f32 v58, v36, v37
    v_cvt_pk_bf16_f32 v59, v38, v39
    v_mfma_f32_32x32x16_bf16 a[0:15], a[140:143], v[52:55], a[0:15]
    buffer_load_dwordx4 a[172:175], v2, s[28:31], s70 offen offset:3072 sc1
    s_add_u32 s70, s70, 4096
    v_exp_f32 v40, v40
    v_exp_f32 v41, v41
    v_exp_f32 v42, v42
    v_exp_f32 v43, v43
    v_cvt_pk_bf16_f32 v60, v40, v41
    v_mfma_f32_32x32x16_bf16 v[64:79], a[136:139], v[56:59], v[64:79]
    v_exp_f32 v44, v44
    v_exp_f32 v45, v45
    v_cvt_pk_bf16_f32 v61, v42, v43
    v_exp_f32 v46, v46
    v_exp_f32 v47, v47
    v_cvt_pk_bf16_f32 v62, v44, v45
    v_cvt_pk_bf16_f32 v63, v46, v47
    v_mfma_f32_32x32x16_bf16 v[32:47], a[144:147], a[104:107], 0
    v_exp_f32 v16, v16
    v_exp_f32 v17, v17
    v_exp_f32 v18, v18
    v_exp_f32 v19, v19
    v_cvt_pk_bf16_f32 v48, v16, v17
    v_exp_f32 v20, v20
    v_mfma_f32_32x32x16_bf16 v[32:47], a[148:151], a[108:111], v[32:47]
    v_exp_f32 v21, v21
    v_cvt_pk_bf16_f32 v49, v18, v19
    v_exp_f32 v22, v22
    v_exp_f32 v23, v23
    v_cvt_pk_bf16_f32 v50, v20, v21
    v_cvt_pk_bf16_f32 v51, v22, v23
    v_mfma_f32_32x32x16_bf16 v[64:79], a[140:143], v[60:63], v[64:79]
    buffer_load_dwordx4 a[128:131], v2, s[28:31], s70 offen offset:0 sc1
    v_exp_f32 v24, v24
    v_exp_f32 v25, v25
    v_exp_f32 v26, v26
    v_exp_f32 v27, v27
    v_cvt_pk_bf16_f32 v52, v24, v25
    v_mfma_f32_32x32x16_bf16 a[32:47], a[152:155], v[48:51], a[32:47]
    v_exp_f32 v28, v28
    v_exp_f32 v29, v29
    v_cvt_pk_bf16_f32 v53, v26, v27
    v_exp_f32 v30, v30
    v_exp_f32 v31, v31
    v_cvt_pk_bf16_f32 v54, v28, v29
    v_cvt_pk_bf16_f32 v55, v30, v31
    v_mfma_f32_32x32x16_bf16 v[16:31], a[144:147], a[112:115], 0
    v_exp_f32 v32, v32
    v_exp_f32 v33, v33
    v_exp_f32 v34, v34
    v_exp_f32 v35, v35
    v_cvt_pk_bf16_f32 v56, v32, v33
    v_exp_f32 v36, v36
    v_mfma_f32_32x32x16_bf16 v[16:31], a[148:151], a[116:119], v[16:31]
    v_exp_f32 v37, v37
    v_cvt_pk_bf16_f32 v57, v34, v35
    v_exp_f32 v38, v38
    v_exp_f32 v39, v39
    v_cvt_pk_bf16_f32 v58, v36, v37
    v_cvt_pk_bf16_f32 v59, v38, v39
    v_mfma_f32_32x32x16_bf16 a[32:47], a[156:159], v[52:55], a[32:47]
    buffer_load_dwordx4 a[132:135], v2, s[28:31], s70 offen offset:1024 sc1
    v_exp_f32 v40, v40
    v_exp_f32 v41, v41
    v_exp_f32 v42, v42
    v_exp_f32 v43, v43
    v_cvt_pk_bf16_f32 v60, v40, v41
    v_mfma_f32_32x32x16_bf16 a[16:31], a[152:155], v[56:59], a[16:31]
    v_exp_f32 v44, v44
    v_exp_f32 v45, v45
    v_cvt_pk_bf16_f32 v61, v42, v43
    v_exp_f32 v46, v46
    v_exp_f32 v47, v47
    v_cvt_pk_bf16_f32 v62, v44, v45
    v_cvt_pk_bf16_f32 v63, v46, v47
    v_mfma_f32_32x32x16_bf16 v[32:47], a[144:147], a[120:123], 0
    v_exp_f32 v16, v16
    v_exp_f32 v17, v17
    v_exp_f32 v18, v18
    v_exp_f32 v19, v19
    v_cvt_pk_bf16_f32 v48, v16, v17
    v_exp_f32 v20, v20
    v_mfma_f32_32x32x16_bf16 v[32:47], a[148:151], a[124:127], v[32:47]
    v_exp_f32 v21, v21
    v_cvt_pk_bf16_f32 v49, v18, v19
    v_exp_f32 v22, v22
    v_exp_f32 v23, v23
    v_cvt_pk_bf16_f32 v50, v20, v21
    v_cvt_pk_bf16_f32 v51, v22, v23
    v_mfma_f32_32x32x16_bf16 a[16:31], a[156:159], v[60:63], a[16:31]
    buffer_load_dwordx4 a[136:139], v2, s[28:31], s70 offen offset:2048 sc1
    v_exp_f32 v24, v24
    v_exp_f32 v25, v25
    v_exp_f32 v26, v26
    v_exp_f32 v27, v27
    v_cvt_pk_bf16_f32 v52, v24, v25
    v_mfma_f32_32x32x16_bf16 a[0:15], a[152:155], v[48:51], a[0:15]
    v_exp_f32 v28, v28
    v_exp_f32 v29, v29
    v_cvt_pk_bf16_f32 v53, v26, v27
    v_exp_f32 v30, v30
    v_exp_f32 v31, v31
    v_cvt_pk_bf16_f32 v54, v28, v29
    v_cvt_pk_bf16_f32 v55, v30, v31
    s_waitcnt vmcnt(3)
    v_mfma_f32_32x32x16_bf16 v[16:31], a[160:163], a[96:99], 0
    v_exp_f32 v32, v32
    v_exp_f32 v33, v33
    v_exp_f32 v34, v34
    v_exp_f32 v35, v35
    v_cvt_pk_bf16_f32 v56, v32, v33
    v_mfma_f32_32x32x16_bf16 v[16:31], a[164:167], a[100:103], v[16:31]
    v_exp_f32 v36, v36
    v_exp_f32 v37, v37
    v_cvt_pk_bf16_f32 v57, v34, v35
    v_exp_f32 v38, v38
    v_exp_f32 v39, v39
    v_cvt_pk_bf16_f32 v58, v36, v37
    v_cvt_pk_bf16_f32 v59, v38, v39
    v_mfma_f32_32x32x16_bf16 a[0:15], a[156:159], v[52:55], a[0:15]
    buffer_load_dwordx4 a[140:143], v2, s[28:31], s70 offen offset:3072 sc1
    s_add_u32 s70, s70, 4096
    v_exp_f32 v40, v40
    v_exp_f32 v41, v41
    v_exp_f32 v42, v42
    v_exp_f32 v43, v43
    v_cvt_pk_bf16_f32 v60, v40, v41
    v_mfma_f32_32x32x16_bf16 v[64:79], a[152:155], v[56:59], v[64:79]
    v_exp_f32 v44, v44
    v_exp_f32 v45, v45
    v_cvt_pk_bf16_f32 v61, v42, v43
    v_exp_f32 v46, v46
    v_exp_f32 v47, v47
    v_cvt_pk_bf16_f32 v62, v44, v45
    v_cvt_pk_bf16_f32 v63, v46, v47
    v_mfma_f32_32x32x16_bf16 v[32:47], a[160:163], a[104:107], 0
    v_exp_f32 v16, v16
    v_exp_f32 v17, v17
    v_exp_f32 v18, v18
    v_exp_f32 v19, v19
    v_cvt_pk_bf16_f32 v48, v16, v17
    v_exp_f32 v20, v20
    v_mfma_f32_32x32x16_bf16 v[32:47], a[164:167], a[108:111], v[32:47]
    v_exp_f32 v21, v21
    v_cvt_pk_bf16_f32 v49, v18, v19
    v_exp_f32 v22, v22
    v_exp_f32 v23, v23
    v_cvt_pk_bf16_f32 v50, v20, v21
    v_cvt_pk_bf16_f32 v51, v22, v23
    v_mfma_f32_32x32x16_bf16 v[64:79], a[156:159], v[60:63], v[64:79]
    buffer_load_dwordx4 a[144:147], v2, s[28:31], s70 offen offset:0 sc1
    v_exp_f32 v24, v24
    v_exp_f32 v25, v25
    v_exp_f32 v26, v26
    v_exp_f32 v27, v27
    v_cvt_pk_bf16_f32 v52, v24, v25
    v_mfma_f32_32x32x16_bf16 a[32:47], a[168:171], v[48:51], a[32:47]
    v_exp_f32 v28, v28
    v_exp_f32 v29, v29
    v_cvt_pk_bf16_f32 v53, v26, v27
    v_exp_f32 v30, v30
    v_exp_f32 v31, v31
    v_cvt_pk_bf16_f32 v54, v28, v29
    v_cvt_pk_bf16_f32 v55, v30, v31
    v_mfma_f32_32x32x16_bf16 v[16:31], a[160:163], a[112:115], 0
    v_exp_f32 v32, v32
    v_exp_f32 v33, v33
    v_exp_f32 v34, v34
    v_exp_f32 v35, v35
    v_cvt_pk_bf16_f32 v56, v32, v33
    v_exp_f32 v36, v36
    v_mfma_f32_32x32x16_bf16 v[16:31], a[164:167], a[116:119], v[16:31]
    v_exp_f32 v37, v37
    v_cvt_pk_bf16_f32 v57, v34, v35
    v_exp_f32 v38, v38
    v_exp_f32 v39, v39
    v_cvt_pk_bf16_f32 v58, v36, v37
    v_cvt_pk_bf16_f32 v59, v38, v39
    v_mfma_f32_32x32x16_bf16 a[32:47], a[172:175], v[52:55], a[32:47]
    buffer_load_dwordx4 a[148:151], v2, s[28:31], s70 offen offset:1024 sc1
    v_exp_f32 v40, v40
    v_exp_f32 v41, v41
    v_exp_f32 v42, v42
    v_exp_f32 v43, v43
    v_cvt_pk_bf16_f32 v60, v40, v41
    v_mfma_f32_32x32x16_bf16 a[16:31], a[168:171], v[56:59], a[16:31]
    v_exp_f32 v44, v44
    v_exp_f32 v45, v45
    v_cvt_pk_bf16_f32 v61, v42, v43
    v_exp_f32 v46, v46
    v_exp_f32 v47, v47
    v_cvt_pk_bf16_f32 v62, v44, v45
    v_cvt_pk_bf16_f32 v63, v46, v47
    v_mfma_f32_32x32x16_bf16 v[32:47], a[160:163], a[120:123], 0
    v_exp_f32 v16, v16
    v_exp_f32 v17, v17
    v_exp_f32 v18, v18
    v_exp_f32 v19, v19
    v_cvt_pk_bf16_f32 v48, v16, v17
    v_exp_f32 v20, v20
    v_mfma_f32_32x32x16_bf16 v[32:47], a[164:167], a[124:127], v[32:47]
    v_exp_f32 v21, v21
    v_cvt_pk_bf16_f32 v49, v18, v19
    v_exp_f32 v22, v22
    v_exp_f32 v23, v23
    v_cvt_pk_bf16_f32 v50, v20, v21
    v_cvt_pk_bf16_f32 v51, v22, v23
    v_mfma_f32_32x32x16_bf16 a[16:31], a[172:175], v[60:63], a[16:31]
    buffer_load_dwordx4 a[152:155], v2, s[28:31], s70 offen offset:2048 sc1
    v_exp_f32 v24, v24
    v_exp_f32 v25, v25
    v_exp_f32 v26, v26
    v_exp_f32 v27, v27
    v_cvt_pk_bf16_f32 v52, v24, v25
    v_mfma_f32_32x32x16_bf16 a[0:15], a[168:171], v[48:51], a[0:15]
    v_exp_f32 v28, v28
    v_exp_f32 v29, v29
    v_cvt_pk_bf16_f32 v53, v26, v27
    v_exp_f32 v30, v30
    v_exp_f32 v31, v31
    v_cvt_pk_bf16_f32 v54, v28, v29
    v_cvt_pk_bf16_f32 v55, v30, v31
    s_waitcnt vmcnt(3)
    v_mfma_f32_32x32x16_bf16 v[16:31], a[128:131], a[96:99], 0
    v_exp_f32 v32, v32
    v_exp_f32 v33, v33
    v_exp_f32 v34, v34
    v_exp_f32 v35, v35
    v_cvt_pk_bf16_f32 v56, v32, v33
    v_mfma_f32_32x32x16_bf16 v[16:31], a[132:135], a[100:103], v[16:31]
    v_exp_f32 v36, v36
    v_exp_f32 v37, v37
    v_cvt_pk_bf16_f32 v57, v34, v35
    v_exp_f32 v38, v38
    v_exp_f32 v39, v39
    v_cvt_pk_bf16_f32 v58, v36, v37
    v_cvt_pk_bf16_f32 v59, v38, v39
    v_mfma_f32_32x32x16_bf16 a[0:15], a[172:175], v[52:55], a[0:15]
    buffer_load_dwordx4 a[156:159], v2, s[28:31], s70 offen offset:3072 sc1
    s_add_u32 s70, s70, 4096
    v_exp_f32 v40, v40
    v_exp_f32 v41, v41
    v_exp_f32 v42, v42
    v_exp_f32 v43, v43
    v_cvt_pk_bf16_f32 v60, v40, v41
    v_mfma_f32_32x32x16_bf16 v[64:79], a[168:171], v[56:59], v[64:79]
    v_exp_f32 v44, v44
    v_exp_f32 v45, v45
    v_cvt_pk_bf16_f32 v61, v42, v43
    v_exp_f32 v46, v46
    v_exp_f32 v47, v47
    v_cvt_pk_bf16_f32 v62, v44, v45
    v_cvt_pk_bf16_f32 v63, v46, v47
    v_mfma_f32_32x32x16_bf16 v[32:47], a[128:131], a[104:107], 0
    v_exp_f32 v16, v16
    v_exp_f32 v17, v17
    v_exp_f32 v18, v18
    v_exp_f32 v19, v19
    v_cvt_pk_bf16_f32 v48, v16, v17
    v_exp_f32 v20, v20
    v_mfma_f32_32x32x16_bf16 v[32:47], a[132:135], a[108:111], v[32:47]
    v_exp_f32 v21, v21
    v_cvt_pk_bf16_f32 v49, v18, v19
    v_exp_f32 v22, v22
    v_exp_f32 v23, v23
    v_cvt_pk_bf16_f32 v50, v20, v21
    v_cvt_pk_bf16_f32 v51, v22, v23
    v_mfma_f32_32x32x16_bf16 v[64:79], a[172:175], v[60:63], v[64:79]
    buffer_load_dwordx4 a[160:163], v2, s[28:31], s70 offen offset:0 sc1
    v_exp_f32 v24, v24
    v_exp_f32 v25, v25
    v_exp_f32 v26, v26
    v_exp_f32 v27, v27
    v_cvt_pk_bf16_f32 v52, v24, v25
    v_mfma_f32_32x32x16_bf16 a[32:47], a[136:139], v[48:51], a[32:47]
    v_exp_f32 v28, v28
    v_exp_f32 v29, v29
    v_cvt_pk_bf16_f32 v53, v26, v27
    v_exp_f32 v30, v30
    v_exp_f32 v31, v31
    v_cvt_pk_bf16_f32 v54, v28, v29
    v_cvt_pk_bf16_f32 v55, v30, v31
    v_mfma_f32_32x32x16_bf16 v[16:31], a[128:131], a[112:115], 0
    v_exp_f32 v32, v32
    v_exp_f32 v33, v33
    v_exp_f32 v34, v34
    v_exp_f32 v35, v35
    v_cvt_pk_bf16_f32 v56, v32, v33
    v_exp_f32 v36, v36
    v_mfma_f32_32x32x16_bf16 v[16:31], a[132:135], a[116:119], v[16:31]
    v_exp_f32 v37, v37
    v_cvt_pk_bf16_f32 v57, v34, v35
    v_exp_f32 v38, v38
    v_exp_f32 v39, v39
    v_cvt_pk_bf16_f32 v58, v36, v37
    v_cvt_pk_bf16_f32 v59, v38, v39
    v_mfma_f32_32x32x16_bf16 a[32:47], a[140:143], v[52:55], a[32:47]
    buffer_load_dwordx4 a[164:167], v2, s[28:31], s70 offen offset:1024 sc1
    v_exp_f32 v40, v40
    v_exp_f32 v41, v41
    v_exp_f32 v42, v42
    v_exp_f32 v43, v43
    v_cvt_pk_bf16_f32 v60, v40, v41
    v_mfma_f32_32x32x16_bf16 a[16:31], a[136:139], v[56:59], a[16:31]
    v_exp_f32 v44, v44
    v_exp_f32 v45, v45
    v_cvt_pk_bf16_f32 v61, v42, v43
    v_exp_f32 v46, v46
    v_exp_f32 v47, v47
    v_cvt_pk_bf16_f32 v62, v44, v45
    v_cvt_pk_bf16_f32 v63, v46, v47
    v_mfma_f32_32x32x16_bf16 v[32:47], a[128:131], a[120:123], 0
    v_exp_f32 v16, v16
    v_exp_f32 v17, v17
    v_exp_f32 v18, v18
    v_exp_f32 v19, v19
    v_cvt_pk_bf16_f32 v48, v16, v17
    v_exp_f32 v20, v20
    v_mfma_f32_32x32x16_bf16 v[32:47], a[132:135], a[124:127], v[32:47]
    v_exp_f32 v21, v21
    v_cvt_pk_bf16_f32 v49, v18, v19
    v_exp_f32 v22, v22
    v_exp_f32 v23, v23
    v_cvt_pk_bf16_f32 v50, v20, v21
    v_cvt_pk_bf16_f32 v51, v22, v23
    v_mfma_f32_32x32x16_bf16 a[16:31], a[140:143], v[60:63], a[16:31]
    buffer_load_dwordx4 a[168:171], v2, s[28:31], s70 offen offset:2048 sc1
    v_exp_f32 v24, v24
    v_exp_f32 v25, v25
    v_exp_f32 v26, v26
    v_exp_f32 v27, v27
    v_cvt_pk_bf16_f32 v52, v24, v25
    v_mfma_f32_32x32x16_bf16 a[0:15], a[136:139], v[48:51], a[0:15]
    v_exp_f32 v28, v28
    v_exp_f32 v29, v29
    v_cvt_pk_bf16_f32 v53, v26, v27
    v_exp_f32 v30, v30
    v_exp_f32 v31, v31
    v_cvt_pk_bf16_f32 v54, v28, v29
    v_cvt_pk_bf16_f32 v55, v30, v31
    s_waitcnt vmcnt(3)
    v_mfma_f32_32x32x16_bf16 v[16:31], a[144:147], a[96:99], 0
    v_exp_f32 v32, v32
    v_exp_f32 v33, v33
    v_exp_f32 v34, v34
    v_exp_f32 v35, v35
    v_cvt_pk_bf16_f32 v56, v32, v33
    v_mfma_f32_32x32x16_bf16 v[16:31], a[148:151], a[100:103], v[16:31]
    v_exp_f32 v36, v36
    v_exp_f32 v37, v37
    v_cvt_pk_bf16_f32 v57, v34, v35
    v_exp_f32 v38, v38
    v_exp_f32 v39, v39
    v_cvt_pk_bf16_f32 v58, v36, v37
    v_cvt_pk_bf16_f32 v59, v38, v39
    v_mfma_f32_32x32x16_bf16 a[0:15], a[140:143], v[52:55], a[0:15]
    buffer_load_dwordx4 a[172:175], v2, s[28:31], s70 offen offset:3072 sc1
    s_add_u32 s70, s70, 4096
    v_exp_f32 v40, v40
    v_exp_f32 v41, v41
    v_exp_f32 v42, v42
    v_exp_f32 v43, v43
    v_cvt_pk_bf16_f32 v60, v40, v41
    v_mfma_f32_32x32x16_bf16 v[64:79], a[136:139], v[56:59], v[64:79]
    v_exp_f32 v44, v44
    v_exp_f32 v45, v45
    v_cvt_pk_bf16_f32 v61, v42, v43
    v_exp_f32 v46, v46
    v_exp_f32 v47, v47
    v_cvt_pk_bf16_f32 v62, v44, v45
    v_cvt_pk_bf16_f32 v63, v46, v47
    v_mfma_f32_32x32x16_bf16 v[32:47], a[144:147], a[104:107], 0
    v_exp_f32 v16, v16
    v_exp_f32 v17, v17
    v_exp_f32 v18, v18
    v_exp_f32 v19, v19
    v_cvt_pk_bf16_f32 v48, v16, v17
    v_exp_f32 v20, v20
    v_mfma_f32_32x32x16_bf16 v[32:47], a[148:151], a[108:111], v[32:47]
    v_exp_f32 v21, v21
    v_cvt_pk_bf16_f32 v49, v18, v19
    v_exp_f32 v22, v22
    v_exp_f32 v23, v23
    v_cvt_pk_bf16_f32 v50, v20, v21
    v_cvt_pk_bf16_f32 v51, v22, v23
    v_mfma_f32_32x32x16_bf16 v[64:79], a[140:143], v[60:63], v[64:79]
    buffer_load_dwordx4 a[128:131], v2, s[28:31], s70 offen offset:0 sc1
    v_exp_f32 v24, v24
    v_exp_f32 v25, v25
    v_exp_f32 v26, v26
    v_exp_f32 v27, v27
    v_cvt_pk_bf16_f32 v52, v24, v25
    v_mfma_f32_32x32x16_bf16 a[32:47], a[152:155], v[48:51], a[32:47]
    v_exp_f32 v28, v28
    v_exp_f32 v29, v29
    v_cvt_pk_bf16_f32 v53, v26, v27
    v_exp_f32 v30, v30
    v_exp_f32 v31, v31
    v_cvt_pk_bf16_f32 v54, v28, v29
    v_cvt_pk_bf16_f32 v55, v30, v31
    v_mfma_f32_32x32x16_bf16 v[16:31], a[144:147], a[112:115], 0
    v_exp_f32 v32, v32
    v_exp_f32 v33, v33
    v_exp_f32 v34, v34
    v_exp_f32 v35, v35
    v_cvt_pk_bf16_f32 v56, v32, v33
    v_exp_f32 v36, v36
    v_mfma_f32_32x32x16_bf16 v[16:31], a[148:151], a[116:119], v[16:31]
    v_exp_f32 v37, v37
    v_cvt_pk_bf16_f32 v57, v34, v35
    v_exp_f32 v38, v38
    v_exp_f32 v39, v39
    v_cvt_pk_bf16_f32 v58, v36, v37
    v_cvt_pk_bf16_f32 v59, v38, v39
    v_mfma_f32_32x32x16_bf16 a[32:47], a[156:159], v[52:55], a[32:47]
    buffer_load_dwordx4 a[132:135], v2, s[28:31], s70 offen offset:1024 sc1
    v_exp_f32 v40, v40
    v_exp_f32 v41, v41
    v_exp_f32 v42, v42
    v_exp_f32 v43, v43
    v_cvt_pk_bf16_f32 v60, v40, v41
    v_mfma_f32_32x32x16_bf16 a[16:31], a[152:155], v[56:59], a[16:31]
    v_exp_f32 v44, v44
    v_exp_f32 v45, v45
    v_cvt_pk_bf16_f32 v61, v42, v43
    v_exp_f32 v46, v46
    v_exp_f32 v47, v47
    v_cvt_pk_bf16_f32 v62, v44, v45
    v_cvt_pk_bf16_f32 v63, v46, v47
    v_mfma_f32_32x32x16_bf16 v[32:47], a[144:147], a[120:123], 0
    v_exp_f32 v16, v16
    v_exp_f32 v17, v17
    v_exp_f32 v18, v18
    v_exp_f32 v19, v19
    v_cvt_pk_bf16_f32 v48, v16, v17
    v_exp_f32 v20, v20
    v_mfma_f32_32x32x16_bf16 v[32:47], a[148:151], a[124:127], v[32:47]
    v_exp_f32 v21, v21
    v_cvt_pk_bf16_f32 v49, v18, v19
    v_exp_f32 v22, v22
    v_exp_f32 v23, v23
    v_cvt_pk_bf16_f32 v50, v20, v21
    v_cvt_pk_bf16_f32 v51, v22, v23
    v_mfma_f32_32x32x16_bf16 a[16:31], a[156:159], v[60:63], a[16:31]
    buffer_load_dwordx4 a[136:139], v2, s[28:31], s70 offen offset:2048 sc1
    v_exp_f32 v24, v24
    v_exp_f32 v25, v25
    v_exp_f32 v26, v26
    v_exp_f32 v27, v27
    v_cvt_pk_bf16_f32 v52, v24, v25
    v_mfma_f32_32x32x16_bf16 a[0:15], a[152:155], v[48:51], a[0:15]
    v_exp_f32 v28, v28
    v_exp_f32 v29, v29
    v_cvt_pk_bf16_f32 v53, v26, v27
    v_exp_f32 v30, v30
    v_exp_f32 v31, v31
    v_cvt_pk_bf16_f32 v54, v28, v29
    v_cvt_pk_bf16_f32 v55, v30, v31
    s_waitcnt vmcnt(3)
    v_mfma_f32_32x32x16_bf16 v[16:31], a[160:163], a[96:99], 0
    v_exp_f32 v32, v32
    v_exp_f32 v33, v33
    v_exp_f32 v34, v34
    v_exp_f32 v35, v35
    v_cvt_pk_bf16_f32 v56, v32, v33
    v_mfma_f32_32x32x16_bf16 v[16:31], a[164:167], a[100:103], v[16:31]
    v_exp_f32 v36, v36
    v_exp_f32 v37, v37
    v_cvt_pk_bf16_f32 v57, v34, v35
    v_exp_f32 v38, v38
    v_exp_f32 v39, v39
    v_cvt_pk_bf16_f32 v58, v36, v37
    v_cvt_pk_bf16_f32 v59, v38, v39
    v_mfma_f32_32x32x16_bf16 a[0:15], a[156:159], v[52:55], a[0:15]
    buffer_load_dwordx4 a[140:143], v2, s[28:31], s70 offen offset:3072 sc1
    s_add_u32 s70, s70, 4096
    v_exp_f32 v40, v40
    v_exp_f32 v41, v41
    v_exp_f32 v42, v42
    v_exp_f32 v43, v43
    v_cvt_pk_bf16_f32 v60, v40, v41
    v_mfma_f32_32x32x16_bf16 v[64:79], a[152:155], v[56:59], v[64:79]
    v_exp_f32 v44, v44
    v_exp_f32 v45, v45
    v_cvt_pk_bf16_f32 v61, v42, v43
    v_exp_f32 v46, v46
    v_exp_f32 v47, v47
    v_cvt_pk_bf16_f32 v62, v44, v45
    v_cvt_pk_bf16_f32 v63, v46, v47
    v_mfma_f32_32x32x16_bf16 v[32:47], a[160:163], a[104:107], 0
    v_exp_f32 v16, v16
    v_exp_f32 v17, v17
    v_exp_f32 v18, v18
    v_exp_f32 v19, v19
    v_cvt_pk_bf16_f32 v48, v16, v17
    v_exp_f32 v20, v20
    v_mfma_f32_32x32x16_bf16 v[32:47], a[164:167], a[108:111], v[32:47]
    v_exp_f32 v21, v21
    v_cvt_pk_bf16_f32 v49, v18, v19
    v_exp_f32 v22, v22
    v_exp_f32 v23, v23
    v_cvt_pk_bf16_f32 v50, v20, v21
    v_cvt_pk_bf16_f32 v51, v22, v23
    v_mfma_f32_32x32x16_bf16 v[64:79], a[156:159], v[60:63], v[64:79]
    v_exp_f32 v24, v24
    v_exp_f32 v25, v25
    v_exp_f32 v26, v26
    v_exp_f32 v27, v27
    v_cvt_pk_bf16_f32 v52, v24, v25
    v_exp_f32 v28, v28
    v_mfma_f32_32x32x16_bf16 a[32:47], a[168:171], v[48:51], a[32:47]
    v_exp_f32 v29, v29
    v_cvt_pk_bf16_f32 v53, v26, v27
    v_exp_f32 v30, v30
    v_exp_f32 v31, v31
    v_cvt_pk_bf16_f32 v54, v28, v29
    v_cvt_pk_bf16_f32 v55, v30, v31
    v_mfma_f32_32x32x16_bf16 v[16:31], a[160:163], a[112:115], 0
    v_exp_f32 v32, v32
    v_exp_f32 v33, v33
    v_exp_f32 v34, v34
    v_exp_f32 v35, v35
    v_cvt_pk_bf16_f32 v56, v32, v33
    v_exp_f32 v36, v36
    v_mfma_f32_32x32x16_bf16 v[16:31], a[164:167], a[116:119], v[16:31]
    v_exp_f32 v37, v37
    v_cvt_pk_bf16_f32 v57, v34, v35
    v_exp_f32 v38, v38
    v_exp_f32 v39, v39
    v_cvt_pk_bf16_f32 v58, v36, v37
    v_cvt_pk_bf16_f32 v59, v38, v39
    v_mfma_f32_32x32x16_bf16 a[32:47], a[172:175], v[52:55], a[32:47]
    v_exp_f32 v40, v40
    v_exp_f32 v41, v41
    v_exp_f32 v42, v42
    v_exp_f32 v43, v43
    v_cvt_pk_bf16_f32 v60, v40, v41
    v_exp_f32 v44, v44
    v_mfma_f32_32x32x16_bf16 a[16:31], a[168:171], v[56:59], a[16:31]
    v_exp_f32 v45, v45
    v_cvt_pk_bf16_f32 v61, v42, v43
    v_exp_f32 v46, v46
    v_exp_f32 v47, v47
    v_cvt_pk_bf16_f32 v62, v44, v45
    v_cvt_pk_bf16_f32 v63, v46, v47
    v_mfma_f32_32x32x16_bf16 v[32:47], a[160:163], a[120:123], 0
    v_add_u32 v239, 0xffff0000, v9
    v_exp_f32 v16, v16
    v_exp_f32 v17, v17
    v_exp_f32 v18, v18
    v_exp_f32 v19, v19
    v_cvt_pk_bf16_f32 v48, v16, v17
    v_mfma_f32_32x32x16_bf16 v[32:47], a[164:167], a[124:127], v[32:47]
    v_exp_f32 v20, v20
    v_exp_f32 v21, v21
    v_cvt_pk_bf16_f32 v49, v18, v19
    v_exp_f32 v22, v22
    v_exp_f32 v23, v23
    v_cvt_pk_bf16_f32 v50, v20, v21
    v_cvt_pk_bf16_f32 v51, v22, v23
    v_mfma_f32_32x32x16_bf16 a[16:31], a[172:175], v[60:63], a[16:31]
    v_exp_f32 v24, v24
    v_exp_f32 v25, v25
    v_exp_f32 v26, v26
    v_exp_f32 v27, v27
    v_cvt_pk_bf16_f32 v52, v24, v25
    v_mfma_f32_32x32x16_bf16 a[0:15], a[168:171], v[48:51], a[0:15]
    v_exp_f32 v28, v28
    v_exp_f32 v29, v29
    v_cvt_pk_bf16_f32 v53, v26, v27
    v_exp_f32 v30, v30
    v_exp_f32 v31, v31
    v_cvt_pk_bf16_f32 v54, v28, v29
    v_cvt_pk_bf16_f32 v55, v30, v31
    s_waitcnt vmcnt(0)
    v_mfma_f32_32x32x16_bf16 v[16:31], a[128:131], a[96:99], 0
    v_exp_f32 v32, v32
    v_exp_f32 v33, v33
    v_exp_f32 v34, v34
    v_exp_f32 v35, v35
    v_cvt_pk_bf16_f32 v56, v32, v33
    v_mfma_f32_32x32x16_bf16 v[16:31], a[132:135], a[100:103], v[16:31]
    v_exp_f32 v36, v36
    v_exp_f32 v37, v37
    v_cvt_pk_bf16_f32 v57, v34, v35
    v_exp_f32 v38, v38
    v_exp_f32 v39, v39
    v_cvt_pk_bf16_f32 v58, v36, v37
    v_cvt_pk_bf16_f32 v59, v38, v39
    v_mfma_f32_32x32x16_bf16 a[0:15], a[172:175], v[52:55], a[0:15]
    v_exp_f32 v40, v40
    v_exp_f32 v41, v41
    v_exp_f32 v42, v42
    v_exp_f32 v43, v43
    v_cvt_pk_bf16_f32 v60, v40, v41
    v_mfma_f32_32x32x16_bf16 v[64:79], a[168:171], v[56:59], v[64:79]
    v_exp_f32 v44, v44
    v_exp_f32 v45, v45
    v_cvt_pk_bf16_f32 v61, v42, v43
    v_exp_f32 v46, v46
    v_exp_f32 v47, v47
    v_cvt_pk_bf16_f32 v62, v44, v45
    v_cvt_pk_bf16_f32 v63, v46, v47
    v_mfma_f32_32x32x16_bf16 v[32:47], a[128:131], a[104:107], 0
    v_exp_f32 v16, v16
    v_exp_f32 v17, v17
    v_exp_f32 v18, v18
    v_exp_f32 v19, v19
    v_cvt_pk_bf16_f32 v48, v16, v17
    v_exp_f32 v20, v20
    v_mfma_f32_32x32x16_bf16 v[32:47], a[132:135], a[108:111], v[32:47]
    v_exp_f32 v21, v21
    v_cvt_pk_bf16_f32 v49, v18, v19
    v_exp_f32 v22, v22
    v_exp_f32 v23, v23
    v_cvt_pk_bf16_f32 v50, v20, v21
    v_cvt_pk_bf16_f32 v51, v22, v23
    v_mfma_f32_32x32x16_bf16 v[64:79], a[172:175], v[60:63], v[64:79]
    v_exp_f32 v24, v24
    v_exp_f32 v25, v25
    v_exp_f32 v26, v26
    v_exp_f32 v27, v27
    v_cvt_pk_bf16_f32 v52, v24, v25
    v_exp_f32 v28, v28
    v_mfma_f32_32x32x16_bf16 a[32:47], a[136:139], v[48:51], a[32:47]
    v_exp_f32 v29, v29
    v_cvt_pk_bf16_f32 v53, v26, v27
    v_exp_f32 v30, v30
    v_exp_f32 v31, v31
    v_cvt_pk_bf16_f32 v54, v28, v29
    v_cvt_pk_bf16_f32 v55, v30, v31
    v_mfma_f32_32x32x16_bf16 v[16:31], a[128:131], a[112:115], 0
    v_exp_f32 v32, v32
    v_exp_f32 v33, v33
    v_exp_f32 v34, v34
    v_exp_f32 v35, v35
    v_cvt_pk_bf16_f32 v56, v32, v33
    v_exp_f32 v36, v36
    v_mfma_f32_32x32x16_bf16 v[16:31], a[132:135], a[116:119], v[16:31]
    v_exp_f32 v37, v37
    v_cvt_pk_bf16_f32 v57, v34, v35
    v_exp_f32 v38, v38
    v_exp_f32 v39, v39
    v_cvt_pk_bf16_f32 v58, v36, v37
    v_cvt_pk_bf16_f32 v59, v38, v39
    v_mfma_f32_32x32x16_bf16 a[32:47], a[140:143], v[52:55], a[32:47]
    v_exp_f32 v40, v40
    v_exp_f32 v41, v41
    v_exp_f32 v42, v42
    v_exp_f32 v43, v43
    v_cvt_pk_bf16_f32 v60, v40, v41
    v_exp_f32 v44, v44
    v_mfma_f32_32x32x16_bf16 a[16:31], a[136:139], v[56:59], a[16:31]
    v_exp_f32 v45, v45
    v_cvt_pk_bf16_f32 v61, v42, v43
    v_exp_f32 v46, v46
    v_exp_f32 v47, v47
    v_cvt_pk_bf16_f32 v62, v44, v45
    v_cvt_pk_bf16_f32 v63, v46, v47
    v_mfma_f32_32x32x16_bf16 v[32:47], a[128:131], a[120:123], 0
    v_exp_f32 v16, v16
    v_exp_f32 v17, v17
    v_exp_f32 v18, v18
    v_exp_f32 v19, v19
    v_cvt_pk_bf16_f32 v48, v16, v17
    v_exp_f32 v20, v20
    v_mfma_f32_32x32x16_bf16 v[32:47], a[132:135], a[124:127], v[32:47]
    v_exp_f32 v21, v21
    v_cvt_pk_bf16_f32 v49, v18, v19
    v_exp_f32 v22, v22
    v_exp_f32 v23, v23
    v_cvt_pk_bf16_f32 v50, v20, v21
    v_cvt_pk_bf16_f32 v51, v22, v23
    v_mfma_f32_32x32x16_bf16 a[16:31], a[140:143], v[60:63], a[16:31]
    v_exp_f32 v24, v24
    v_exp_f32 v25, v25
    v_exp_f32 v26, v26
    v_exp_f32 v27, v27
    v_cvt_pk_bf16_f32 v52, v24, v25
    v_exp_f32 v28, v28
    v_mfma_f32_32x32x16_bf16 a[0:15], a[136:139], v[48:51], a[0:15]
    v_exp_f32 v29, v29
    v_cvt_pk_bf16_f32 v53, v26, v27
    v_exp_f32 v30, v30
    v_exp_f32 v31, v31
    v_cvt_pk_bf16_f32 v54, v28, v29
    v_cvt_pk_bf16_f32 v55, v30, v31
    s_nop 1
    v_mfma_f32_32x32x16_bf16 a[0:15], a[140:143], v[52:55], a[0:15]
    v_exp_f32 v32, v32
    v_exp_f32 v33, v33
    v_exp_f32 v34, v34
    v_exp_f32 v35, v35
    v_cvt_pk_bf16_f32 v56, v32, v33
    v_exp_f32 v36, v36
    v_exp_f32 v37, v37
    v_cvt_pk_bf16_f32 v57, v34, v35
    v_exp_f32 v38, v38
    v_exp_f32 v39, v39
    v_cvt_pk_bf16_f32 v58, v36, v37
    v_cvt_pk_bf16_f32 v59, v38, v39
    v_exp_f32 v40, v40
    v_exp_f32 v41, v41
    v_mfma_f32_32x32x16_bf16 v[64:79], a[136:139], v[56:59], v[64:79]
    v_exp_f32 v42, v42
    v_exp_f32 v43, v43
    v_cvt_pk_bf16_f32 v60, v40, v41
    v_exp_f32 v44, v44
    v_exp_f32 v45, v45
    v_cvt_pk_bf16_f32 v61, v42, v43
    v_exp_f32 v46, v46
    v_exp_f32 v47, v47
    v_cvt_pk_bf16_f32 v62, v44, v45
    v_cvt_pk_bf16_f32 v63, v46, v47
    s_nop 0
    s_mov_b64 s[76:77], 0
    v_mfma_f32_32x32x16_bf16 v[64:79], a[140:143], v[60:63], v[64:79]
    s_mov_b32 s65, 0x5f800000
    ds_write_b128 v239, a[32:35] offset:32768
    ds_write_b128 v239, a[36:39] offset:33792
    ds_write_b128 v239, a[40:43] offset:40960
    ds_write_b128 v239, a[44:47] offset:41984
    ds_write_b128 v239, a[16:19] offset:49152
    ds_write_b128 v239, a[20:23] offset:50176
    ds_write_b128 v239, a[24:27] offset:57344
    ds_write_b128 v239, a[28:31] offset:58368
    ds_write_b128 v9, a[0:3] offset:0
    ds_write_b128 v9, a[4:7] offset:1024
    ds_write_b128 v9, a[8:11] offset:8192
    ds_write_b128 v9, a[12:15] offset:9216
    v_xor_b32 v241, 2048, v9
    v_xor_b32 v242, 4096, v239
    v_xor_b32 v243, 6144, v239
    v_lshlrev_b32 v238, 10, v1
    v_add_u32 v238, 0x3fc, v238
    v_and_b32 v238, 0x3fff, v238
    s_waitcnt lgkmcnt(0)
    s_barrier
    ds_read_b128 v[128:131], v241 offset:0
    ds_read_b128 v[132:135], v241 offset:1024
    ds_read_b128 v[136:139], v241 offset:8192
    ds_read_b128 v[140:143], v241 offset:9216
    ds_read_b128 v[144:147], v242 offset:49152
    ds_read_b128 v[148:151], v242 offset:50176
    ds_read_b128 v[152:155], v242 offset:57344
    ds_read_b128 v[156:159], v242 offset:58368
    ds_read_b128 v[160:163], v243 offset:32768
    ds_read_b128 v[164:167], v243 offset:33792
    ds_read_b128 v[168:171], v243 offset:40960
    ds_read_b128 v[172:175], v243 offset:41984
    s_waitcnt lgkmcnt(8)
    v_pk_add_f32 v[76:77], v[76:77], v[140:141]
    v_pk_add_f32 v[78:79], v[78:79], v[142:143]
    v_pk_add_f32 v[64:65], v[64:65], v[128:129]
    v_pk_add_f32 v[66:67], v[66:67], v[130:131]
    v_pk_add_f32 v[68:69], v[68:69], v[132:133]
    v_pk_add_f32 v[70:71], v[70:71], v[134:135]
    v_pk_add_f32 v[72:73], v[72:73], v[136:137]
    v_pk_add_f32 v[74:75], v[74:75], v[138:139]
    s_waitcnt lgkmcnt(4)
    v_pk_add_f32 v[76:77], v[76:77], v[156:157]
    v_pk_add_f32 v[78:79], v[78:79], v[158:159]
    v_pk_add_f32 v[64:65], v[64:65], v[144:145]
    v_pk_add_f32 v[66:67], v[66:67], v[146:147]
    v_pk_add_f32 v[68:69], v[68:69], v[148:149]
    v_pk_add_f32 v[70:71], v[70:71], v[150:151]
    v_pk_add_f32 v[72:73], v[72:73], v[152:153]
    v_pk_add_f32 v[74:75], v[74:75], v[154:155]
    s_waitcnt lgkmcnt(0)
    v_pk_add_f32 v[76:77], v[76:77], v[172:173]
    v_pk_add_f32 v[78:79], v[78:79], v[174:175]
    v_pk_add_f32 v[64:65], v[64:65], v[160:161]
    v_pk_add_f32 v[66:67], v[66:67], v[162:163]
    v_pk_add_f32 v[68:69], v[68:69], v[164:165]
    v_pk_add_f32 v[70:71], v[70:71], v[166:167]
    v_pk_add_f32 v[72:73], v[72:73], v[168:169]
    v_pk_add_f32 v[74:75], v[74:75], v[170:171]
    v_mov_b32 v192, v76
    v_mov_b32 v193, v76
    s_nop 1
    v_permlane32_swap_b32 v192, v193
    v_cmp_le_f32 vcc, 0x21800000, v193
    v_cmp_ge_f32 s[62:63], s65, v193
    v_rcp_f32 v193, v193
    s_and_b64 vcc, vcc, s[62:63]
    s_cmp_eq_u64 vcc, -1
    s_cbranch_scc0 L_fbq
L_fb_retq:
    v_cmp_gt_u32 vcc, 32, v1
    v_pk_mul_f32 v[64:65], v[64:65], v[192:193] op_sel:[0,1] op_sel_hi:[1,1]
    v_pk_mul_f32 v[66:67], v[66:67], v[192:193] op_sel:[0,1] op_sel_hi:[1,1]
    v_pk_mul_f32 v[68:69], v[68:69], v[192:193] op_sel:[0,1] op_sel_hi:[1,1]
    v_pk_mul_f32 v[70:71], v[70:71], v[192:193] op_sel:[0,1] op_sel_hi:[1,1]
    v_cvt_pk_bf16_f32 v48, v64, v65
    v_cvt_pk_bf16_f32 v49, v66, v67
    v_cvt_pk_bf16_f32 v50, v68, v69
    v_cvt_pk_bf16_f32 v51, v70, v71
    buffer_store_dwordx4 v[48:51], v2, s[28:31], s75 offen sc1
    v_pk_mul_f32 v[72:73], v[72:73], v[192:193] op_sel:[0,1] op_sel_hi:[1,1]
    v_pk_mul_f32 v[74:75], v[74:75], v[192:193] op_sel:[0,1] op_sel_hi:[1,1]
    v_pk_mul_f32 v[76:77], v[76:77], v[192:193] op_sel:[0,1] op_sel_hi:[1,1]
    v_pk_mul_f32 v[78:79], v[78:79], v[192:193] op_sel:[0,1] op_sel_hi:[1,1]
    v_cvt_pk_bf16_f32 v52, v72, v73
    v_cvt_pk_bf16_f32 v53, v74, v75
    v_cvt_pk_bf16_f32 v54, v76, v77
    v_cvt_pk_bf16_f32 v55, v78, v79
    v_cndmask_b32 v54, 0, v54, vcc
    v_cndmask_b32 v55, 0, v55, vcc
    buffer_store_dwordx4 v[52:55], v2, s[28:31], s75 offen offset:1024 sc1
    s_branch L_fin
L_fbq:
    s_mov_b32 s61, 0x300000
    v_mov_b32 v194, 0xff800000
L_fb1q:
    buffer_load_dwordx4 v[200:203], v2, s[28:31], s61 offen offset:0 sc1
    buffer_load_dwordx4 v[204:207], v2, s[28:31], s61 offen offset:1024 sc1
    s_waitcnt vmcnt(0)
    v_mfma_f32_32x32x16_bf16 v[16:31], v[200:203], a[120:123], 0
    v_mfma_f32_32x32x16_bf16 v[16:31], v[204:207], a[124:127], v[16:31]
    s_add_u32 s61, s61, 4096
    s_nop 11
    v_max3_f32 v194, v194, v16, v17
    v_max3_f32 v194, v194, v18, v19
    v_max3_f32 v194, v194, v20, v21
    v_max3_f32 v194, v194, v22, v23
    v_max3_f32 v194, v194, v24, v25
    v_max3_f32 v194, v194, v26, v27
    v_max3_f32 v194, v194, v28, v29
    v_max3_f32 v194, v194, v30, v31
    s_cmp_lt_u32 s61, 0x340000
    s_cbranch_scc1 L_fb1q
    v_mov_b32 v192, v194
    s_mov_b32 s61, 0x300000
    s_nop 0
    v_permlane32_swap_b32 v192, v194
    v_max_f32 v194, v194, v192
    v_mov_b32 v64, 0
    v_mov_b32 v65, 0
    v_mov_b32 v66, 0
    v_mov_b32 v67, 0
    v_mov_b32 v68, 0
    v_mov_b32 v69, 0
    v_mov_b32 v70, 0
    v_mov_b32 v71, 0
    v_mov_b32 v72, 0
    v_mov_b32 v73, 0
    v_mov_b32 v74, 0
    v_mov_b32 v75, 0
    v_mov_b32 v76, 0
    v_mov_b32 v77, 0
    v_mov_b32 v78, 0
    v_mov_b32 v79, 0
L_fb2q:
    buffer_load_dwordx4 v[200:203], v2, s[28:31], s61 offen offset:0 sc1
    buffer_load_dwordx4 v[204:207], v2, s[28:31], s61 offen offset:1024 sc1
    buffer_load_dwordx4 v[208:211], v2, s[28:31], s61 offen offset:2048 sc1
    buffer_load_dwordx4 v[212:215], v2, s[28:31], s61 offen offset:3072 sc1
    s_waitcnt vmcnt(0)
    v_mfma_f32_32x32x16_bf16 v[16:31], v[200:203], a[120:123], 0
    v_mfma_f32_32x32x16_bf16 v[16:31], v[204:207], a[124:127], v[16:31]
    s_add_u32 s61, s61, 4096
    s_nop 11
    v_sub_f32 v16, v16, v194
    v_sub_f32 v17, v17, v194
    v_sub_f32 v18, v18, v194
    v_sub_f32 v19, v19, v194
    v_sub_f32 v20, v20, v194
    v_sub_f32 v21, v21, v194
    v_sub_f32 v22, v22, v194
    v_sub_f32 v23, v23, v194
    v_sub_f32 v24, v24, v194
    v_sub_f32 v25, v25, v194
    v_sub_f32 v26, v26, v194
    v_sub_f32 v27, v27, v194
    v_sub_f32 v28, v28, v194
    v_sub_f32 v29, v29, v194
    v_sub_f32 v30, v30, v194
    v_sub_f32 v31, v31, v194
    v_exp_f32 v16, v16
    v_exp_f32 v17, v17
    v_exp_f32 v18, v18
    v_exp_f32 v19, v19
    v_exp_f32 v20, v20
    v_exp_f32 v21, v21
    v_exp_f32 v22, v22
    v_exp_f32 v23, v23
    v_exp_f32 v24, v24
    v_exp_f32 v25, v25
    v_exp_f32 v26, v26
    v_exp_f32 v27, v27
    v_exp_f32 v28, v28
    v_exp_f32 v29, v29
    v_exp_f32 v30, v30
    v_exp_f32 v31, v31
    s_nop 0
    v_cvt_pk_bf16_f32 v48, v16, v17
    v_cvt_pk_bf16_f32 v49, v18, v19
    v_cvt_pk_bf16_f32 v50, v20, v21
    v_cvt_pk_bf16_f32 v51, v22, v23
    v_cvt_pk_bf16_f32 v52, v24, v25
    v_cvt_pk_bf16_f32 v53, v26, v27
    v_cvt_pk_bf16_f32 v54, v28, v29
    v_cvt_pk_bf16_f32 v55, v30, v31
    s_nop 1
    v_mfma_f32_32x32x16_bf16 v[64:79], v[208:211], v[48:51], v[64:79]
    v_mfma_f32_32x32x16_bf16 v[64:79], v[212:215], v[52:55], v[64:79]
    s_cmp_lt_u32 s61, 0x340000
    s_nop 7
    s_cbranch_scc1 L_fb2q
    s_nop 7
    v_mov_b32 v192, v76
    v_mov_b32 v193, v76
    s_nop 1
    v_permlane32_swap_b32 v192, v193
    v_rcp_f32 v193, v193
    s_nop 1
    s_branch L_fb_retq
L_codeend:
.section .rodata,"a"
.p2align 6
.amdhsa_kernel parallel_sum__grouped_kv_mqa__glu_gated_swiglu__prompt_kernel
  .amdhsa_next_free_vgpr 512
  .amdhsa_next_free_sgpr 102
  .amdhsa_accum_offset 256
  .amdhsa_group_segment_fixed_size 0
  .amdhsa_kernarg_size 96
  .amdhsa_user_sgpr_count 2
  .amdhsa_user_sgpr_kernarg_segment_ptr 1
  .amdhsa_system_sgpr_workgroup_id_x 1
.end_amdhsa_kernel
```
